```python
import torch

def _softmax(x, axis=-1):
    return torch.softmax(x, dim=axis)
def _gelu(x):
    return torch.nn.functional.gelu(x, approximate="tanh")
def _silu(x):
    return torch.nn.functional.silu(x)
def _sigmoid(x):
    return torch.sigmoid(x)
def _layernorm(x, axis=-1, eps=1e-5):
    m = x.mean(dim=axis, keepdim=True)
    v = x.var(dim=axis, keepdim=True, unbiased=False)
    return (x - m) / torch.sqrt(v + eps)
def _scatter_add(tgt, idx, src, axis=0):
    return tgt.clone().index_add_(axis, idx, src)
def _segment_sum(src, seg, n):
    out = torch.zeros((n,) + src.shape[1:], dtype=src.dtype)
    return out.index_add_(0, seg, src)
def _pad(x, pw):
    flat = tuple(v for pair in reversed(pw) for v in pair)
    return torch.nn.functional.pad(x, flat)

kernel_name = 'standalone__mha_softmax__near_ridge'

def setup_inputs():

    _w = (lambda a: (lambda t: t.to(torch.bfloat16) if t.is_floating_point() else t)(torch.as_tensor(a)))
    B, H, Sq, Sk, D = 8, 32, 1312, 512, 128
    return {
        "q": _w((lambda *s: torch.randn(*s, dtype=torch.bfloat16) * 0.8)(B, H, Sq, D)),
        "k": _w((lambda *s: torch.randn(*s, dtype=torch.bfloat16) * 0.8)(B, H, Sk, D)),
        "v": _w((lambda *s: torch.randn(*s, dtype=torch.bfloat16) * 0.05)(B, H, Sk, D)),
    }

def reference(q, k, v):
    scale = q.shape[-1] ** -0.5
    scores = torch.einsum("bhqd,bhkd->bhqk", q, k) * scale
    p = _softmax(scores, axis=-1)
    return torch.einsum("bhqk,bhkd->bhqd", p, v)
```

```asm
; @launch grid=(256,1,1) block=(256,1,1) lds=163840
.amdgcn_target "amdgcn-amd-amdhsa--gfx950"
.text
.globl standalone__mha_softmax__near_ridge_kernel
.p2align 8
.type standalone__mha_softmax__near_ridge_kernel,@function
standalone__mha_softmax__near_ridge_kernel:
    s_cmp_ge_u32 s2, 256
    s_cbranch_scc1 L_end
    s_load_dwordx8 s[52:59], s[0:1], 0
    v_lshrrev_b32 v2, 6, v0
    v_and_b32 v1, 63, v0
    v_readfirstlane_b32 s24, v2
    v_lshrrev_b32 v4, 4, v1
    v_and_b32 v2, 15, v1
    v_lshlrev_b32 v2, 8, v2
    v_mul_u32_u24 v3, 16, v4
    v_add_u32 v230, v2, v3
    v_and_b32 v3, 1, v4
    v_lshlrev_b32 v3, 2, v3
    v_xor_b32 v3, v3, v1
    v_and_b32 v3, 7, v3
    v_lshrrev_b32 v2, 3, v1
    v_lshlrev_b32 v2, 8, v2
    v_lshl_add_u32 v234, v3, 4, v2
    v_and_b32 v2, 15, v1
    v_xor_b32 v3, v2, v4
    v_lshlrev_b32 v3, 4, v3
    v_lshl_add_u32 v8, v4, 8, v3
    v_xor_b32 v9, 64, v8
    v_xor_b32 v10, 128, v8
    v_xor_b32 v11, 192, v8
    s_mul_i32 s5, s24, 20480
    s_add_u32 s5, s5, 49152
    s_mul_i32 s43, s2, 335872
    s_lshl_b32 s44, s2, 17
    s_lshl_b32 s42, s24, 10
    s_lshl_b32 s41, s24, 11
    s_lshr_b32 s40, s24, 1
    s_lshl_b32 s40, s40, 12
    s_and_b32 s45, s24, 1
    s_lshl_b32 s45, s45, 7
    s_add_u32 s40, s40, s45
    s_lshl_b32 s30, s24, 14
    s_add_u32 s31, s30, 4096
    s_add_u32 s32, s30, 8192
    s_add_u32 s33, s30, 12288
    s_lshl_b32 s34, s24, 12
    s_add_u32 s34, s34, 327680
    s_mov_b32 s35, s30
    s_mov_b32 s36, s31
    s_mov_b32 s37, s32
    s_mov_b32 s38, s33
    s_mov_b32 s39, s34
    s_lshl_b32 s28, s24, 6
    s_xor_b32 s46, s28, 64
    s_xor_b32 s47, s28, 128
    s_xor_b32 s48, s28, 192
    s_waitcnt lgkmcnt(0)
    s_add_u32 s12, s54, s44
    s_addc_u32 s13, s55, 0
    s_mov_b32 s14, 131072
    s_mov_b32 s15, 0x20000
    s_add_u32 s8, s52, s43
    s_addc_u32 s9, s53, 0
    s_mov_b32 s10, 335872
    s_mov_b32 s11, 0x20000
    s_add_u32 s16, s56, s44
    s_addc_u32 s17, s57, 0
    s_mov_b32 s18, 131072
    s_mov_b32 s19, 0x20000
    s_add_u32 s20, s58, s43
    s_addc_u32 s21, s59, 0
    s_mov_b32 s22, 335872
    s_mov_b32 s23, 0x20000
    buffer_load_dwordx4 v[236:239], v234, s[12:15], s40 offen offset:0 nt
    buffer_load_dwordx4 v[240:243], v234, s[12:15], s40 offen offset:2048 nt
    s_add_u32 m0, s5, 0
    s_nop 0
    buffer_load_dwordx4 v8, s[8:11], s35 offen offset:0 nt lds
    buffer_load_dwordx4 v9, s[8:11], s35 offen offset:1024 nt lds
    buffer_load_dwordx4 v10, s[8:11], s35 offen offset:2048 nt lds
    buffer_load_dwordx4 v11, s[8:11], s35 offen offset:3072 nt lds
    s_add_u32 m0, s5, 4096
    s_nop 0
    buffer_load_dwordx4 v8, s[8:11], s36 offen offset:0 nt lds
    buffer_load_dwordx4 v9, s[8:11], s36 offen offset:1024 nt lds
    buffer_load_dwordx4 v10, s[8:11], s36 offen offset:2048 nt lds
    buffer_load_dwordx4 v11, s[8:11], s36 offen offset:3072 nt lds
    s_add_u32 s40, s40, 8192
    buffer_load_dwordx4 v[244:247], v234, s[12:15], s40 offen offset:0 nt
    buffer_load_dwordx4 v[248:251], v234, s[12:15], s40 offen offset:2048 nt
    s_getpc_b64 s[50:51]
L_pf:
    s_lshr_b32 s45, s2, 3
    s_lshl_b32 s45, s45, 11
    v_lshl_add_u32 v5, v1, 5, s45
    v_min_u32 v5, L_end - L_pf, v5
    global_load_dword v255, v5, s[50:51]
    s_mov_b32 s25, 0x3e0293ee
    s_mov_b32 s26, 0xffff0000
    s_mov_b32 s27, 0
    s_mov_b32 s29, 3
    s_lshl_b32 s49, s24, 15
    s_sub_u32 s49, s49, 131072
    s_lshl_b32 s45, s24, 11
    v_lshlrev_b32 v3, 1, v4
    v_xor_b32 v2, v3, v1
    v_lshlrev_b32 v2, 4, v2
    v_add_u32 v228, 131072, v2
    v_bfe_u32 v2, v234, 4, 2
    v_lshlrev_b32 v3, 1, v2
    v_lshrrev_b32 v5, 3, v1
    v_xor_b32 v3, v3, v5
    v_lshl_add_u32 v3, v2, 4, v3
    v_bfe_u32 v2, v234, 6, 1
    v_lshl_add_u32 v3, v2, 6, v3
    v_lshlrev_b32 v3, 4, v3
    v_add_u32 v3, 131072, v3
    v_add_u32 v254, s45, v3
    v_add_u32 v228, s42, v228
    v_xor_b32 v229, 1024, v228
    v_xor_b32 v235, 2048, v228
    v_xor_b32 v231, 3072, v228
    s_sub_u32 s49, s49, s42
    v_lshrrev_b32 v2, 2, v1
    v_lshlrev_b32 v2, 7, v2
    v_and_b32 v3, 3, v1
    v_lshl_add_u32 v2, v3, 4, v2
    v_bfe_u32 v3, v1, 3, 1
    v_lshl_add_u32 v224, v3, 6, v2
    v_xor_b32 v225, 64, v224
    v_mov_b32 v179, 0
    v_mov_b32 v226, 0
    v_mov_b32 v227, -1
    v_lshrrev_b32 v2, 4, v1
    v_xor_b32 v2, v2, v1
    v_bfe_u32 v2, v2, 1, 1
    v_add_u32 v2, -1, v2
    v_and_b32 v2, 0x3f803f80, v2
    v_accvgpr_write_b32 a252, v2
    v_accvgpr_write_b32 a253, v2
    v_accvgpr_write_b32 a254, v2
    v_accvgpr_write_b32 a255, v2
    v_and_b32 v3, 1, v1
    v_mul_u32_u24 v3, 0xaaaa, v3
    v_add_u32 v233, 0x4444, v3
    v_accvgpr_write_b32 a240, 0
    v_accvgpr_write_b32 a241, 0
    v_accvgpr_write_b32 a242, 0
    v_accvgpr_write_b32 a243, 0
    v_accvgpr_write_b32 a244, 0
    v_accvgpr_write_b32 a245, 0
    v_accvgpr_write_b32 a246, 0
    v_accvgpr_write_b32 a247, 0
    v_accvgpr_write_b32 a248, 0
    v_accvgpr_write_b32 a249, 0
    v_accvgpr_write_b32 a250, 0
    v_accvgpr_write_b32 a251, 0
    v_and_b32 v2, 15, v1
    v_mul_u32_u24 v3, 1, v4
    v_xor_b32 v3, v3, v2
    v_lshlrev_b32 v3, 4, v3
    v_lshl_add_u32 v3, v2, 8, v3
    v_xor_b32 v12, s28, v3
    v_xor_b32 v13, s46, v3
    v_xor_b32 v14, s47, v3
    v_xor_b32 v15, s48, v3
    v_add_u32 v12, s5, v12
    v_add_u32 v13, s5, v13
    v_add_u32 v14, s5, v14
    v_add_u32 v15, s5, v15
    s_mov_b64 vcc, 0
    s_branch L_body
.p2align 12
L_body:
    s_waitcnt vmcnt(11)
    v_lshlrev_b32 v252, 16, v236
    v_and_b32 v236, s26, v236
    v_mul_f32 v252, s25, v252
    v_mul_f32 v236, s25, v236
    v_cvt_pk_bf16_f32 v236, v252, v236
    v_lshlrev_b32 v253, 16, v237
    v_and_b32 v237, s26, v237
    v_mul_f32 v253, s25, v253
    v_mul_f32 v237, s25, v237
    v_cvt_pk_bf16_f32 v237, v253, v237
    v_lshlrev_b32 v252, 16, v238
    v_and_b32 v238, s26, v238
    v_mul_f32 v252, s25, v252
    v_mul_f32 v238, s25, v238
    v_cvt_pk_bf16_f32 v238, v252, v238
    v_lshlrev_b32 v253, 16, v239
    v_and_b32 v239, s26, v239
    v_mul_f32 v253, s25, v253
    v_mul_f32 v239, s25, v239
    v_cvt_pk_bf16_f32 v239, v253, v239
    v_lshlrev_b32 v252, 16, v240
    v_and_b32 v240, s26, v240
    v_mul_f32 v252, s25, v252
    v_mul_f32 v240, s25, v240
    v_cvt_pk_bf16_f32 v240, v252, v240
    v_lshlrev_b32 v253, 16, v241
    v_and_b32 v241, s26, v241
    v_mul_f32 v253, s25, v253
    v_mul_f32 v241, s25, v241
    v_cvt_pk_bf16_f32 v241, v253, v241
    v_lshlrev_b32 v252, 16, v242
    v_and_b32 v242, s26, v242
    v_mul_f32 v252, s25, v252
    v_mul_f32 v242, s25, v242
    v_cvt_pk_bf16_f32 v242, v252, v242
    v_lshlrev_b32 v253, 16, v243
    v_and_b32 v243, s26, v243
    v_mul_f32 v253, s25, v253
    v_mul_f32 v243, s25, v243
    v_cvt_pk_bf16_f32 v243, v253, v243
    ds_write_b128 v254, v[236:239] offset:0
    ds_write_b128 v254, v[240:243] offset:128
    s_add_u32 m0, s5, 8192
    s_nop 0
    buffer_load_dwordx4 v8, s[8:11], s37 offen offset:0 nt lds
    buffer_load_dwordx4 v9, s[8:11], s37 offen offset:1024 nt lds
    buffer_load_dwordx4 v10, s[8:11], s37 offen offset:2048 nt lds
    buffer_load_dwordx4 v11, s[8:11], s37 offen offset:3072 nt lds
    s_waitcnt lgkmcnt(0)
    s_barrier
    s_add_u32 m0, s5, 12288
    s_nop 0
    buffer_load_dwordx4 v8, s[8:11], s38 offen offset:0 nt lds
    buffer_load_dwordx4 v9, s[8:11], s38 offen offset:1024 nt lds
    buffer_load_dwordx4 v10, s[8:11], s38 offen offset:2048 nt lds
    buffer_load_dwordx4 v11, s[8:11], s38 offen offset:3072 nt lds
    s_add_u32 s35, s30, 65536
    s_add_u32 s36, s31, 65536
    s_add_u32 s37, s32, 65536
    s_add_u32 s38, s33, 65536
    ds_read_b128 a[80:83], v228 offset:0
    ds_read_b128 a[212:215], v229 offset:0
    ds_read_b128 a[216:219], v235 offset:0
    ds_read_b128 a[220:223], v231 offset:0
    ds_read_b128 a[84:87], v228 offset:4096
    ds_read_b128 a[228:231], v229 offset:4096
    ds_read_b128 a[232:235], v235 offset:4096
    ds_read_b128 a[236:239], v231 offset:4096
    s_waitcnt vmcnt(15)
    ds_read_b128 a[0:3], v12 offset:0
    ds_read_b128 a[4:7], v13 offset:0
    ds_read_b128 a[8:11], v14 offset:0
    ds_read_b128 a[12:15], v15 offset:0
    s_waitcnt lgkmcnt(3)
    v_mfma_f32_16x16x32_bf16 v[200:203], a[80:83], a[0:3], 0
    s_waitcnt lgkmcnt(2)
    s_add_u32 m0, s5, 16384
    s_nop 0
    buffer_load_dwordx4 v8, s[8:11], s39 offen offset:0 nt lds
    buffer_load_dwordx4 v9, s[8:11], s39 offen offset:1024 nt lds
    buffer_load_dwordx4 v10, s[8:11], s39 offen offset:2048 nt lds
    buffer_load_dwordx4 v11, s[8:11], s39 offen offset:3072 nt lds
    v_mfma_f32_16x16x32_bf16 v[200:203], a[212:215], a[4:7], v[200:203]
    s_waitcnt lgkmcnt(1)
    v_mfma_f32_16x16x32_bf16 v[200:203], a[216:219], a[8:11], v[200:203]
    s_waitcnt lgkmcnt(0)
    v_mfma_f32_16x16x32_bf16 v[200:203], a[220:223], a[12:15], v[200:203]
    v_mfma_f32_16x16x32_bf16 v[204:207], a[84:87], a[0:3], 0
    v_mfma_f32_16x16x32_bf16 v[204:207], a[228:231], a[4:7], v[204:207]
    v_mfma_f32_16x16x32_bf16 v[204:207], a[232:235], a[8:11], v[204:207]
    v_mfma_f32_16x16x32_bf16 v[204:207], a[236:239], a[12:15], v[204:207]
    s_mov_b64 vcc, -1
    s_cmp_eq_u32 s24, 0
    s_cbranch_scc1 L_pad0
    s_cmp_eq_u32 s24, 1
    s_cbranch_scc1 L_pad1
    s_cmp_eq_u32 s24, 2
    s_cbranch_scc1 L_pad2
    s_branch L_pad3
L_back:
    s_mov_b64 vcc, 0
    s_waitcnt vmcnt(15)
    ds_read_b128 a[16:19], v12 offset:4096
    ds_read_b128 a[20:23], v13 offset:4096
    ds_read_b128 a[24:27], v14 offset:4096
    v_exp_f32 v200, v200
    v_exp_f32 v201, v201
    v_exp_f32 v202, v202
    v_exp_f32 v203, v203
    v_cvt_pk_bf16_f32 v160, v200, v201
    v_cvt_pk_bf16_f32 v161, v202, v203
    ds_read_b128 a[28:31], v15 offset:4096
    s_waitcnt lgkmcnt(3)
    v_mfma_f32_16x16x32_bf16 v[200:203], a[80:83], a[16:19], 0
    s_waitcnt lgkmcnt(2)
    s_add_u32 m0, s42, 0
    v_exp_f32 v204, v204
    buffer_load_dwordx4 v234, s[16:19], s41 offen offset:0 nt lds
    s_add_u32 m0, s42, 32640
    v_exp_f32 v205, v205
    buffer_load_dwordx4 v234, s[16:19], s41 offen offset:128 nt lds
    s_add_u32 s40, s40, 8192
    buffer_load_dwordx4 v[236:239], v234, s[12:15], s40 offen offset:0 nt
    buffer_load_dwordx4 v[240:243], v234, s[12:15], s40 offen offset:2048 nt
    v_mfma_f32_16x16x32_bf16 v[200:203], a[212:215], a[20:23], v[200:203]
    s_waitcnt lgkmcnt(1)
    v_exp_f32 v206, v206
    v_mfma_f32_16x16x32_bf16 v[200:203], a[216:219], a[24:27], v[200:203]
    s_waitcnt lgkmcnt(0)
    v_exp_f32 v207, v207
    v_mfma_f32_16x16x32_bf16 v[200:203], a[220:223], a[28:31], v[200:203]
    v_cvt_pk_bf16_f32 v162, v204, v205
    v_cvt_pk_bf16_f32 v163, v206, v207
    v_mfma_f32_16x16x32_bf16 v[204:207], a[84:87], a[16:19], 0
    s_waitcnt vmcnt(18)
    v_lshlrev_b32 v252, 16, v244
    v_and_b32 v244, s26, v244
    v_mfma_f32_16x16x32_bf16 v[204:207], a[228:231], a[20:23], v[204:207]
    v_lshlrev_b32 v253, 16, v245
    v_mul_f32 v252, s25, v252
    v_mfma_f32_16x16x32_bf16 v[204:207], a[232:235], a[24:27], v[204:207]
    v_exp_f32 v200, v200
    v_mfma_f32_16x16x32_bf16 v[204:207], a[236:239], a[28:31], v[204:207]
    s_waitcnt vmcnt(17)
    v_exp_f32 v201, v201
    v_exp_f32 v202, v202
    v_exp_f32 v203, v203
    v_cvt_pk_bf16_f32 v164, v200, v201
    v_cvt_pk_bf16_f32 v165, v202, v203
    v_and_b32 v245, s26, v245
    v_mul_f32 v244, s25, v244
    v_mul_f32 v253, s25, v253
    v_cvt_pk_bf16_f32 v244, v252, v244
    v_lshlrev_b32 v252, 16, v246
    v_and_b32 v246, s26, v246
    v_mul_f32 v245, s25, v245
    v_mul_f32 v252, s25, v252
    v_cvt_pk_bf16_f32 v245, v253, v245
    v_lshlrev_b32 v253, 16, v247
    v_and_b32 v247, s26, v247
    v_mul_f32 v246, s25, v246
    v_mul_f32 v253, s25, v253
    v_cvt_pk_bf16_f32 v246, v252, v246
    v_lshlrev_b32 v252, 16, v248
    v_and_b32 v248, s26, v248
    v_mul_f32 v247, s25, v247
    v_mul_f32 v252, s25, v252
    v_cvt_pk_bf16_f32 v247, v253, v247
    v_lshlrev_b32 v253, 16, v249
    v_and_b32 v249, s26, v249
    v_mul_f32 v248, s25, v248
    v_mul_f32 v253, s25, v253
    v_cvt_pk_bf16_f32 v248, v252, v248
    v_lshlrev_b32 v252, 16, v250
    v_and_b32 v250, s26, v250
    v_mul_f32 v249, s25, v249
    v_mul_f32 v252, s25, v252
    v_cvt_pk_bf16_f32 v249, v253, v249
    v_lshlrev_b32 v253, 16, v251
    v_and_b32 v251, s26, v251
    v_mul_f32 v250, s25, v250
    v_mul_f32 v253, s25, v253
    v_cvt_pk_bf16_f32 v250, v252, v250
    v_mul_f32 v251, s25, v251
    v_cvt_pk_bf16_f32 v251, v253, v251
    ds_write_b64 v254, v[244:245] offset:8192
    ds_write_b64 v254, v[246:247] offset:8200
    ds_write_b64 v254, v[248:249] offset:8320
    ds_write_b64 v254, v[250:251] offset:8328
    s_waitcnt vmcnt(12)
    ds_read_b128 a[32:35], v12 offset:8192
    ds_read_b128 a[36:39], v13 offset:8192
    ds_read_b128 a[40:43], v14 offset:8192
    ds_read_b128 a[44:47], v15 offset:8192
    s_waitcnt lgkmcnt(3)
    v_mfma_f32_16x16x32_bf16 v[200:203], a[80:83], a[32:35], 0
    s_waitcnt lgkmcnt(2)
    s_add_u32 s41, s41, 8192
    v_exp_f32 v204, v204
    s_add_u32 m0, s42, 4096
    v_exp_f32 v205, v205
    buffer_load_dwordx4 v234, s[16:19], s41 offen offset:0 nt lds
    s_add_u32 m0, s42, 36736
    v_exp_f32 v206, v206
    buffer_load_dwordx4 v234, s[16:19], s41 offen offset:128 nt lds
    v_mfma_f32_16x16x32_bf16 v[200:203], a[212:215], a[36:39], v[200:203]
    s_waitcnt lgkmcnt(1)
    v_exp_f32 v207, v207
    v_mfma_f32_16x16x32_bf16 v[200:203], a[216:219], a[40:43], v[200:203]
    s_waitcnt lgkmcnt(0)
    v_cvt_pk_bf16_f32 v166, v204, v205
    v_cvt_pk_bf16_f32 v167, v206, v207
    v_mfma_f32_16x16x32_bf16 v[200:203], a[220:223], a[44:47], v[200:203]
    v_mfma_f32_16x16x32_bf16 v[204:207], a[84:87], a[32:35], 0
    v_mfma_f32_16x16x32_bf16 v[204:207], a[228:231], a[36:39], v[204:207]
    v_mfma_f32_16x16x32_bf16 v[204:207], a[232:235], a[40:43], v[204:207]
    v_mfma_f32_16x16x32_bf16 v[204:207], a[236:239], a[44:47], v[204:207]
    s_waitcnt vmcnt(10)
    ds_read_b128 a[48:51], v12 offset:12288
    ds_read_b128 a[52:55], v13 offset:12288
    ds_read_b128 a[56:59], v14 offset:12288
    ds_read_b128 a[60:63], v15 offset:12288
    v_exp_f32 v200, v200
    v_exp_f32 v201, v201
    v_exp_f32 v202, v202
    v_exp_f32 v203, v203
    v_cvt_pk_bf16_f32 v168, v200, v201
    v_cvt_pk_bf16_f32 v169, v202, v203
    s_waitcnt lgkmcnt(3)
    v_mfma_f32_16x16x32_bf16 v[200:203], a[80:83], a[48:51], 0
    s_waitcnt lgkmcnt(2)
    s_add_u32 s41, s41, 8192
    v_exp_f32 v204, v204
    s_add_u32 m0, s42, 8192
    v_exp_f32 v205, v205
    buffer_load_dwordx4 v234, s[16:19], s41 offen offset:0 nt lds
    s_add_u32 m0, s42, 40832
    v_exp_f32 v206, v206
    buffer_load_dwordx4 v234, s[16:19], s41 offen offset:128 nt lds
    v_mfma_f32_16x16x32_bf16 v[200:203], a[212:215], a[52:55], v[200:203]
    s_waitcnt lgkmcnt(1)
    s_add_u32 s40, s40, 8192
    v_exp_f32 v207, v207
    v_mfma_f32_16x16x32_bf16 v[200:203], a[216:219], a[56:59], v[200:203]
    s_waitcnt lgkmcnt(0)
    v_cvt_pk_bf16_f32 v170, v204, v205
    v_cvt_pk_bf16_f32 v171, v206, v207
    v_mfma_f32_16x16x32_bf16 v[200:203], a[220:223], a[60:63], v[200:203]
    s_waitcnt vmcnt(8)
    ds_read_b128 a[64:67], v12 offset:16384
    ds_read_b128 a[68:71], v13 offset:16384
    ds_read_b128 a[72:75], v14 offset:16384
    ds_read_b128 a[76:79], v15 offset:16384
    s_waitcnt lgkmcnt(3)
    v_mfma_f32_16x16x32_bf16 v[204:207], a[80:83], a[64:67], 0
    s_waitcnt lgkmcnt(2)
    v_mfma_f32_16x16x32_bf16 v[204:207], a[212:215], a[68:71], v[204:207]
    s_waitcnt lgkmcnt(1)
    buffer_load_dwordx4 v[244:247], v234, s[12:15], s40 offen offset:0 nt
    v_mfma_f32_16x16x32_bf16 v[204:207], a[216:219], a[72:75], v[204:207]
    s_waitcnt lgkmcnt(0)
    v_exp_f32 v200, v200
    v_mfma_f32_16x16x32_bf16 v[204:207], a[220:223], a[76:79], v[204:207]
    s_barrier
    v_exp_f32 v201, v201
    v_exp_f32 v202, v202
    v_exp_f32 v203, v203
    v_cvt_pk_bf16_f32 v172, v200, v201
    v_cvt_pk_bf16_f32 v173, v202, v203
    v_mfma_f32_16x16x32_bf16 v[200:203], a[84:87], a[48:51], 0
    ds_read_b128 a[88:91], v228 offset:8192
    v_exp_f32 v204, v204
    v_mfma_f32_16x16x32_bf16 v[200:203], a[228:231], a[52:55], v[200:203]
    ds_read_b128 a[212:215], v229 offset:8192
    v_exp_f32 v205, v205
    v_mfma_f32_16x16x32_bf16 v[200:203], a[232:235], a[56:59], v[200:203]
    ds_read_b128 a[216:219], v235 offset:8192
    v_exp_f32 v206, v206
    v_mfma_f32_16x16x32_bf16 v[200:203], a[236:239], a[60:63], v[200:203]
    ds_read_b128 a[220:223], v231 offset:8192
    v_exp_f32 v207, v207
    buffer_load_dwordx4 v[248:251], v234, s[12:15], s40 offen offset:2048 nt
    v_cvt_pk_bf16_f32 v176, v204, v205
    v_cvt_pk_bf16_f32 v177, v206, v207
    v_mfma_f32_16x16x32_bf16 v[204:207], a[84:87], a[64:67], 0
    ds_read_b128 a[92:95], v228 offset:12288
    v_mfma_f32_16x16x32_bf16 v[204:207], a[228:231], a[68:71], v[204:207]
    v_exp_f32 v200, v200
    v_mfma_f32_16x16x32_bf16 v[204:207], a[232:235], a[72:75], v[204:207]
    v_exp_f32 v201, v201
    v_mfma_f32_16x16x32_bf16 v[204:207], a[236:239], a[76:79], v[204:207]
    s_waitcnt lgkmcnt(4)
    v_exp_f32 v202, v202
    v_exp_f32 v203, v203
    v_cvt_pk_bf16_f32 v174, v200, v201
    v_cvt_pk_bf16_f32 v175, v202, v203
    v_mfma_f32_16x16x32_bf16 v[200:203], a[88:91], a[0:3], 0
    s_waitcnt vmcnt(8) lgkmcnt(3)
    s_barrier
    ds_read_b64_tr_b16 v[208:209], v224 offset:0
    v_mfma_f32_16x16x32_bf16 v[200:203], a[212:215], a[4:7], v[200:203]
    s_waitcnt lgkmcnt(3)
    s_add_u32 s40, s40, 8192
    ds_read_b64_tr_b16 v[210:211], v224 offset:2048
    v_exp_f32 v204, v204
    v_mfma_f32_16x16x32_bf16 v[200:203], a[216:219], a[8:11], v[200:203]
    s_waitcnt lgkmcnt(3)
    v_exp_f32 v205, v205
    v_mfma_f32_16x16x32_bf16 v[200:203], a[220:223], a[12:15], v[200:203]
    v_exp_f32 v206, v206
    v_exp_f32 v207, v207
    v_cvt_pk_bf16_f32 v178, v204, v205
    v_cvt_pk_bf16_f32 v179, v206, v207
    v_mfma_f32_16x16x32_bf16 v[204:207], a[88:91], a[16:19], 0
    s_waitcnt vmcnt(7)
    ds_read_b64_tr_b16 v[212:213], v224 offset:8
    v_lshlrev_b32 v252, 16, v236
    v_mfma_f32_16x16x32_bf16 v[204:207], a[212:215], a[20:23], v[204:207]
    s_waitcnt vmcnt(6)
    ds_read_b64_tr_b16 v[214:215], v224 offset:2056
    v_lshlrev_b32 v253, 16, v237
    v_and_b32 v236, s26, v236
    v_and_b32 v237, s26, v237
    v_mul_f32 v252, s25, v252
    v_mul_f32 v253, s25, v253
    v_mul_f32 v236, s25, v236
    v_mul_f32 v237, s25, v237
    v_cvt_pk_bf16_f32 v236, v252, v236
    v_lshlrev_b32 v252, 16, v238
    v_and_b32 v238, s26, v238
    v_mul_f32 v252, s25, v252
    v_mul_f32 v238, s25, v238
    v_cvt_pk_bf16_f32 v237, v253, v237
    v_lshlrev_b32 v253, 16, v239
    v_and_b32 v239, s26, v239
    v_mul_f32 v253, s25, v253
    v_mul_f32 v239, s25, v239
    ds_write_b64 v254, v[236:237] offset:16384
    v_cvt_pk_bf16_f32 v238, v252, v238
    v_lshlrev_b32 v252, 16, v240
    v_and_b32 v240, s26, v240
    v_mul_f32 v252, s25, v252
    v_mul_f32 v240, s25, v240
    v_cvt_pk_bf16_f32 v239, v253, v239
    v_lshlrev_b32 v253, 16, v241
    v_and_b32 v241, s26, v241
    v_mul_f32 v253, s25, v253
    v_mul_f32 v241, s25, v241
    ds_write_b64 v254, v[238:239] offset:16392
    v_cvt_pk_bf16_f32 v240, v252, v240
    v_cvt_pk_bf16_f32 v241, v253, v241
    v_mfma_f32_16x16x32_bf16 v[204:207], a[216:219], a[24:27], v[204:207]
    ds_write_b64 v254, v[240:241] offset:16512
    v_mfma_f32_16x16x32_bf16 v[204:207], a[220:223], a[28:31], v[204:207]
    s_waitcnt lgkmcnt(5)
    buffer_load_dwordx4 v[236:239], v234, s[12:15], s40 offen offset:0 nt
    v_lshlrev_b32 v252, 16, v242
    v_and_b32 v242, s26, v242
    v_mul_f32 v252, s25, v252
    v_mul_f32 v242, s25, v242
    v_cvt_pk_bf16_f32 v242, v252, v242
    v_mfma_f32_16x16x32_bf16 v[0:3], v[208:211], v[160:163], 0
    v_exp_f32 v200, v200
    v_mfma_f32_16x16x32_bf16 v[32:35], v[208:211], v[164:167], 0
    ds_read_b64_tr_b16 v[216:217], v225 offset:0
    v_lshlrev_b32 v253, 16, v243
    v_mfma_f32_16x16x32_bf16 v[64:67], v[208:211], v[168:171], 0
    v_exp_f32 v201, v201
    v_mfma_f32_16x16x32_bf16 v[96:99], v[208:211], v[172:175], 0
    ds_read_b64_tr_b16 v[218:219], v225 offset:2048
    v_cvt_pk_bf16_f32 v180, v200, v201
    v_smfmac_f32_16x16x64_bf16 a[240:243], a[252:255], v[160:167], v233
    ds_read_b128 a[228:231], v229 offset:12288
    v_and_b32 v243, s26, v243
    v_exp_f32 v202, v202
    v_exp_f32 v203, v203
    v_mul_f32 v253, s25, v253
    v_cvt_pk_bf16_f32 v181, v202, v203
    v_mfma_f32_16x16x32_bf16 v[200:203], a[88:91], a[32:35], 0
    v_exp_f32 v204, v204
    v_mfma_f32_16x16x32_bf16 v[200:203], a[212:215], a[36:39], v[200:203]
    ds_read_b128 a[232:235], v235 offset:12288
    v_mul_f32 v243, s25, v243
    v_mfma_f32_16x16x32_bf16 v[200:203], a[216:219], a[40:43], v[200:203]
    v_exp_f32 v205, v205
    v_cvt_pk_bf16_f32 v243, v253, v243
    v_mfma_f32_16x16x32_bf16 v[200:203], a[220:223], a[44:47], v[200:203]
    ds_read_b128 a[236:239], v231 offset:12288
    v_cvt_pk_bf16_f32 v184, v204, v205
    v_mfma_f32_16x16x32_bf16 v[128:131], v[208:211], v[176:179], 0
    s_waitcnt lgkmcnt(8)
    v_exp_f32 v206, v206
    v_mfma_f32_16x16x32_bf16 v[4:7], v[212:215], v[160:163], 0
    ds_write_b64 v254, v[242:243] offset:16520
    v_mfma_f32_16x16x32_bf16 v[36:39], v[212:215], v[164:167], 0
    v_exp_f32 v207, v207
    v_mfma_f32_16x16x32_bf16 v[68:71], v[212:215], v[168:171], 0
    buffer_load_dwordx4 v[240:243], v234, s[12:15], s40 offen offset:2048 nt
    v_cvt_pk_bf16_f32 v185, v206, v207
    v_mfma_f32_16x16x32_bf16 v[204:207], a[88:91], a[48:51], 0
    v_exp_f32 v200, v200
    v_mfma_f32_16x16x32_bf16 v[204:207], a[212:215], a[52:55], v[204:207]
    ds_read_b64_tr_b16 v[220:221], v225 offset:8
    v_mfma_f32_16x16x32_bf16 v[204:207], a[216:219], a[56:59], v[204:207]
    v_exp_f32 v201, v201
    v_mfma_f32_16x16x32_bf16 v[204:207], a[220:223], a[60:63], v[204:207]
    ds_read_b64_tr_b16 v[222:223], v225 offset:2056
    v_cvt_pk_bf16_f32 v188, v200, v201
    v_mfma_f32_16x16x32_bf16 v[100:103], v[212:215], v[172:175], 0
    v_exp_f32 v202, v202
    v_mfma_f32_16x16x32_bf16 v[132:135], v[212:215], v[176:179], 0
    s_waitcnt lgkmcnt(6)
    ds_read_b64_tr_b16 v[208:209], v224 offset:32768
    v_mfma_f32_16x16x32_bf16 v[8:11], v[216:219], v[160:163], 0
    v_exp_f32 v203, v203
    v_mfma_f32_16x16x32_bf16 v[40:43], v[216:219], v[164:167], 0
    ds_read_b64_tr_b16 v[210:211], v224 offset:34816
    v_cvt_pk_bf16_f32 v189, v202, v203
    v_mfma_f32_16x16x32_bf16 v[200:203], a[88:91], a[64:67], 0
    v_exp_f32 v204, v204
    v_mfma_f32_16x16x32_bf16 v[200:203], a[212:215], a[68:71], v[200:203]
    v_exp_f32 v205, v205
    v_mfma_f32_16x16x32_bf16 v[200:203], a[216:219], a[72:75], v[200:203]
    v_exp_f32 v206, v206
    v_mfma_f32_16x16x32_bf16 v[200:203], a[220:223], a[76:79], v[200:203]
    s_waitcnt vmcnt(6) lgkmcnt(4)
    s_barrier
    ds_read_b128 a[96:99], v228 offset:16384
    v_cvt_pk_bf16_f32 v192, v204, v205
    v_mfma_f32_16x16x32_bf16 v[72:75], v[216:219], v[168:171], 0
    v_exp_f32 v207, v207
    v_mfma_f32_16x16x32_bf16 v[104:107], v[216:219], v[172:175], 0
    ds_read_b128 a[212:215], v229 offset:16384
    v_cvt_pk_bf16_f32 v193, v206, v207
    v_mfma_f32_16x16x32_bf16 v[136:139], v[216:219], v[176:179], 0
    s_waitcnt lgkmcnt(4)
    ds_read_b64_tr_b16 v[212:213], v224 offset:32776
    v_mfma_f32_16x16x32_bf16 v[12:15], v[220:223], v[160:163], 0
    ds_read_b64_tr_b16 v[214:215], v224 offset:34824
    v_mfma_f32_16x16x32_bf16 v[204:207], a[92:95], a[0:3], 0
    s_add_u32 s41, s41, 8192
    v_exp_f32 v200, v200
    v_mfma_f32_16x16x32_bf16 v[204:207], a[228:231], a[4:7], v[204:207]
    s_waitcnt vmcnt(3)
    s_add_u32 m0, s42, 12288
    ds_read_b128 a[216:219], v235 offset:16384
    v_lshlrev_b32 v252, 16, v244
    v_mfma_f32_16x16x32_bf16 v[204:207], a[232:235], a[8:11], v[204:207]
    v_exp_f32 v201, v201
    v_mfma_f32_16x16x32_bf16 v[204:207], a[236:239], a[12:15], v[204:207]
    buffer_load_dwordx4 v234, s[16:19], s41 offen offset:0 nt lds
    v_mfma_f32_16x16x32_bf16 v[44:47], v[220:223], v[164:167], 0
    s_add_u32 m0, s42, 44928
    v_exp_f32 v202, v202
    v_mfma_f32_16x16x32_bf16 v[76:79], v[220:223], v[168:171], 0
    ds_read_b128 a[220:223], v231 offset:16384
    v_and_b32 v244, s26, v244
    v_mul_f32 v252, s25, v252
    v_mul_f32 v244, s25, v244
    v_cvt_pk_bf16_f32 v244, v252, v244
    v_mfma_f32_16x16x32_bf16 v[108:111], v[220:223], v[172:175], 0
    v_exp_f32 v203, v203
    v_mfma_f32_16x16x32_bf16 v[140:143], v[220:223], v[176:179], 0
    ds_read_b64_tr_b16 v[216:217], v225 offset:32768
    v_cvt_pk_bf16_f32 v196, v200, v201
    v_cvt_pk_bf16_f32 v197, v202, v203
    v_mfma_f32_16x16x32_bf16 v[200:203], a[92:95], a[16:19], 0
    v_exp_f32 v204, v204
    v_mfma_f32_16x16x32_bf16 v[200:203], a[228:231], a[20:23], v[200:203]
    buffer_load_dwordx4 v234, s[16:19], s41 offen offset:128 nt lds
    v_mfma_f32_16x16x32_bf16 v[200:203], a[232:235], a[24:27], v[200:203]
    v_exp_f32 v205, v205
    v_mfma_f32_16x16x32_bf16 v[200:203], a[236:239], a[28:31], v[200:203]
    s_waitcnt lgkmcnt(7)
    ds_read_b64_tr_b16 v[218:219], v225 offset:34816
    v_lshlrev_b32 v253, 16, v245
    v_mfma_f32_16x16x32_bf16 v[16:19], v[208:211], v[160:163], 0
    v_exp_f32 v206, v206
    v_mfma_f32_16x16x32_bf16 v[48:51], v[208:211], v[164:167], 0
    ds_read_b128 a[100:103], v228 offset:20480
    v_and_b32 v245, s26, v245
    v_mul_f32 v253, s25, v253
    v_mul_f32 v245, s25, v245
    v_cvt_pk_bf16_f32 v245, v253, v245
    v_mfma_f32_16x16x32_bf16 v[80:83], v[208:211], v[168:171], 0
    v_exp_f32 v207, v207
    v_mfma_f32_16x16x32_bf16 v[112:115], v[208:211], v[172:175], 0
    v_cvt_pk_bf16_f32 v182, v204, v205
    v_cvt_pk_bf16_f32 v183, v206, v207
    v_smfmac_f32_16x16x64_bf16 a[244:247], a[252:255], v[168:175], v233
    ds_write_b64 v254, v[244:245] offset:24576
    v_mfma_f32_16x16x32_bf16 v[204:207], a[92:95], a[32:35], 0
    v_exp_f32 v200, v200
    v_mfma_f32_16x16x32_bf16 v[204:207], a[228:231], a[36:39], v[204:207]
    v_lshlrev_b32 v252, 16, v246
    v_and_b32 v246, s26, v246
    v_mfma_f32_16x16x32_bf16 v[204:207], a[232:235], a[40:43], v[204:207]
    v_exp_f32 v201, v201
    v_mfma_f32_16x16x32_bf16 v[204:207], a[236:239], a[44:47], v[204:207]
    v_mul_f32 v252, s25, v252
    v_mul_f32 v246, s25, v246
    v_mfma_f32_16x16x32_bf16 v[144:147], v[208:211], v[176:179], 0
    s_waitcnt lgkmcnt(6)
    v_exp_f32 v202, v202
    v_cvt_pk_bf16_f32 v246, v252, v246
    v_mfma_f32_16x16x32_bf16 v[20:23], v[212:215], v[160:163], 0
    ds_read_b64_tr_b16 v[220:221], v225 offset:32776
    v_cvt_pk_bf16_f32 v186, v200, v201
    v_mfma_f32_16x16x32_bf16 v[52:55], v[212:215], v[164:167], 0
    v_exp_f32 v203, v203
    v_mfma_f32_16x16x32_bf16 v[84:87], v[212:215], v[168:171], 0
    ds_read_b64_tr_b16 v[222:223], v225 offset:34824
    v_cvt_pk_bf16_f32 v187, v202, v203
    v_mfma_f32_16x16x32_bf16 v[200:203], a[92:95], a[48:51], 0
    v_exp_f32 v204, v204
    v_mfma_f32_16x16x32_bf16 v[200:203], a[228:231], a[52:55], v[200:203]
    v_lshlrev_b32 v253, 16, v247
    v_and_b32 v247, s26, v247
    v_mfma_f32_16x16x32_bf16 v[200:203], a[232:235], a[56:59], v[200:203]
    v_exp_f32 v205, v205
    v_mfma_f32_16x16x32_bf16 v[200:203], a[236:239], a[60:63], v[200:203]
    v_mul_f32 v253, s25, v253
    v_mul_f32 v247, s25, v247
    v_mfma_f32_16x16x32_bf16 v[116:119], v[212:215], v[172:175], 0
    v_exp_f32 v206, v206
    v_cvt_pk_bf16_f32 v247, v253, v247
    v_mfma_f32_16x16x32_bf16 v[148:151], v[212:215], v[176:179], 0
    s_waitcnt lgkmcnt(4)
    ds_read_b64_tr_b16 v[208:209], v224 offset:4096
    v_cvt_pk_bf16_f32 v190, v204, v205
    v_mfma_f32_16x16x32_bf16 v[24:27], v[216:219], v[160:163], 0
    v_exp_f32 v207, v207
    v_mfma_f32_16x16x32_bf16 v[56:59], v[216:219], v[164:167], 0
    ds_write_b64 v254, v[246:247] offset:24584
    v_smfmac_f32_16x16x64_bf16 a[248:251], a[252:255], v[172:179], v233
    ds_read_b64_tr_b16 v[210:211], v224 offset:6144
    v_cvt_pk_bf16_f32 v191, v206, v207
    v_mfma_f32_16x16x32_bf16 v[204:207], a[92:95], a[64:67], 0
    v_exp_f32 v200, v200
    v_mfma_f32_16x16x32_bf16 v[204:207], a[228:231], a[68:71], v[204:207]
    s_waitcnt vmcnt(4)
    ds_read_b128 a[228:231], v229 offset:20480
    v_lshlrev_b32 v252, 16, v248
    v_mfma_f32_16x16x32_bf16 v[204:207], a[232:235], a[72:75], v[204:207]
    v_exp_f32 v201, v201
    v_mfma_f32_16x16x32_bf16 v[204:207], a[236:239], a[76:79], v[204:207]
    ds_read_b128 a[232:235], v235 offset:20480
    v_and_b32 v248, s26, v248
    v_mul_f32 v252, s25, v252
    v_mul_f32 v248, s25, v248
    v_cvt_pk_bf16_f32 v248, v252, v248
    v_mfma_f32_16x16x32_bf16 v[88:91], v[216:219], v[168:171], 0
    v_exp_f32 v202, v202
    v_mfma_f32_16x16x32_bf16 v[120:123], v[216:219], v[172:175], 0
    ds_read_b128 a[236:239], v231 offset:20480
    v_cvt_pk_bf16_f32 v194, v200, v201
    v_mfma_f32_16x16x32_bf16 v[152:155], v[216:219], v[176:179], 0
    s_waitcnt lgkmcnt(6)
    v_exp_f32 v203, v203
    v_mfma_f32_16x16x32_bf16 v[28:31], v[220:223], v[160:163], 0
    ds_read_b64_tr_b16 v[212:213], v224 offset:4104
    v_cvt_pk_bf16_f32 v195, v202, v203
    v_mfma_f32_16x16x32_bf16 v[200:203], a[96:99], a[0:3], 0
    s_add_u32 s40, s40, 8192
    v_exp_f32 v204, v204
    v_mfma_f32_16x16x32_bf16 v[200:203], a[212:215], a[4:7], v[200:203]
    buffer_load_dwordx4 v[244:247], v234, s[12:15], s40 offen offset:0 nt
    v_mfma_f32_16x16x32_bf16 v[200:203], a[216:219], a[8:11], v[200:203]
    v_exp_f32 v205, v205
    v_mfma_f32_16x16x32_bf16 v[200:203], a[220:223], a[12:15], v[200:203]
    ds_read_b64_tr_b16 v[214:215], v224 offset:6152
    v_lshlrev_b32 v253, 16, v249
    v_and_b32 v249, s26, v249
    v_mul_f32 v253, s25, v253
    v_mul_f32 v249, s25, v249
    v_cvt_pk_bf16_f32 v249, v253, v249
    v_mfma_f32_16x16x32_bf16 v[60:63], v[220:223], v[164:167], 0
    v_exp_f32 v206, v206
    v_mfma_f32_16x16x32_bf16 v[92:95], v[220:223], v[168:171], 0
    v_exp_f32 v207, v207
    v_mfma_f32_16x16x32_bf16 v[124:127], v[220:223], v[172:175], 0
    ds_write_b64 v254, v[248:249] offset:24704
    v_mfma_f32_16x16x32_bf16 v[156:159], v[220:223], v[176:179], 0
    ds_read_b64_tr_b16 v[216:217], v225 offset:4096
    v_cvt_pk_bf16_f32 v198, v204, v205
    v_cvt_pk_bf16_f32 v199, v206, v207
    v_mfma_f32_16x16x32_bf16 v[204:207], a[96:99], a[16:19], 0
    v_exp_f32 v200, v200
    v_mfma_f32_16x16x32_bf16 v[204:207], a[212:215], a[20:23], v[204:207]
    ds_read_b64_tr_b16 v[218:219], v225 offset:6144
    v_lshlrev_b32 v252, 16, v250
    v_mfma_f32_16x16x32_bf16 v[204:207], a[216:219], a[24:27], v[204:207]
    v_exp_f32 v201, v201
    v_mfma_f32_16x16x32_bf16 v[204:207], a[220:223], a[28:31], v[204:207]
    s_waitcnt lgkmcnt(8)
    v_and_b32 v250, s26, v250
    v_mul_f32 v252, s25, v252
    v_mul_f32 v250, s25, v250
    v_cvt_pk_bf16_f32 v250, v252, v250
    v_mfma_f32_16x16x32_bf16 v[0:3], v[208:211], v[180:183], v[0:3]
    v_exp_f32 v202, v202
    v_mfma_f32_16x16x32_bf16 v[32:35], v[208:211], v[184:187], v[32:35]
    v_lshlrev_b32 v253, 16, v251
    v_cvt_pk_bf16_f32 v160, v200, v201
    v_mfma_f32_16x16x32_bf16 v[64:67], v[208:211], v[188:191], v[64:67]
    v_exp_f32 v203, v203
    v_mfma_f32_16x16x32_bf16 v[96:99], v[208:211], v[192:195], v[96:99]
    v_cvt_pk_bf16_f32 v161, v202, v203
    v_and_b32 v251, s26, v251
    v_smfmac_f32_16x16x64_bf16 a[240:243], a[252:255], v[180:187], v233
    v_mul_f32 v253, s25, v253
    v_mul_f32 v251, s25, v251
    v_mfma_f32_16x16x32_bf16 v[200:203], a[96:99], a[32:35], 0
    v_exp_f32 v204, v204
    v_mfma_f32_16x16x32_bf16 v[200:203], a[212:215], a[36:39], v[200:203]
    v_cvt_pk_bf16_f32 v251, v253, v251
    v_mfma_f32_16x16x32_bf16 v[200:203], a[216:219], a[40:43], v[200:203]
    v_exp_f32 v205, v205
    v_mfma_f32_16x16x32_bf16 v[200:203], a[220:223], a[44:47], v[200:203]
    v_exp_f32 v206, v206
    v_mfma_f32_16x16x32_bf16 v[128:131], v[208:211], v[196:199], v[128:131]
    s_waitcnt lgkmcnt(3)
    v_exp_f32 v207, v207
    v_mfma_f32_16x16x32_bf16 v[4:7], v[212:215], v[180:183], v[4:7]
    ds_write_b64 v254, v[250:251] offset:24712
    v_mfma_f32_16x16x32_bf16 v[36:39], v[212:215], v[184:187], v[36:39]
    buffer_load_dwordx4 v[248:251], v234, s[12:15], s40 offen offset:2048 nt
    v_mfma_f32_16x16x32_bf16 v[68:71], v[212:215], v[188:191], v[68:71]
    ds_read_b64_tr_b16 v[220:221], v225 offset:4104
    v_cvt_pk_bf16_f32 v164, v204, v205
    v_cvt_pk_bf16_f32 v165, v206, v207
    v_mfma_f32_16x16x32_bf16 v[204:207], a[96:99], a[48:51], 0
    v_exp_f32 v200, v200
    v_mfma_f32_16x16x32_bf16 v[204:207], a[212:215], a[52:55], v[204:207]
    ds_read_b64_tr_b16 v[222:223], v225 offset:6152
    v_mfma_f32_16x16x32_bf16 v[204:207], a[216:219], a[56:59], v[204:207]
    v_exp_f32 v201, v201
    v_mfma_f32_16x16x32_bf16 v[204:207], a[220:223], a[60:63], v[204:207]
    v_exp_f32 v202, v202
    v_mfma_f32_16x16x32_bf16 v[100:103], v[212:215], v[192:195], v[100:103]
    v_exp_f32 v203, v203
    v_mfma_f32_16x16x32_bf16 v[132:135], v[212:215], v[196:199], v[132:135]
    s_waitcnt lgkmcnt(3)
    ds_read_b64_tr_b16 v[208:209], v224 offset:36864
    v_cvt_pk_bf16_f32 v168, v200, v201
    v_mfma_f32_16x16x32_bf16 v[8:11], v[216:219], v[180:183], v[8:11]
    ds_read_b64_tr_b16 v[210:211], v224 offset:38912
    v_cvt_pk_bf16_f32 v169, v202, v203
    v_mfma_f32_16x16x32_bf16 v[40:43], v[216:219], v[184:187], v[40:43]
    v_mfma_f32_16x16x32_bf16 v[200:203], a[96:99], a[64:67], 0
    v_exp_f32 v204, v204
    v_mfma_f32_16x16x32_bf16 v[200:203], a[212:215], a[68:71], v[200:203]
    v_exp_f32 v205, v205
    v_mfma_f32_16x16x32_bf16 v[200:203], a[216:219], a[72:75], v[200:203]
    v_exp_f32 v206, v206
    v_mfma_f32_16x16x32_bf16 v[200:203], a[220:223], a[76:79], v[200:203]
    s_waitcnt lgkmcnt(4)
    s_barrier
    ds_read_b128 a[104:107], v228 offset:24576
    v_cvt_pk_bf16_f32 v172, v204, v205
    v_mfma_f32_16x16x32_bf16 v[72:75], v[216:219], v[188:191], v[72:75]
L_pad0:
    s_cbranch_vccnz L_pad4
    v_exp_f32 v207, v207
    v_mfma_f32_16x16x32_bf16 v[104:107], v[216:219], v[192:195], v[104:107]
    ds_read_b128 a[212:215], v229 offset:24576
    v_cvt_pk_bf16_f32 v173, v206, v207
    v_mfma_f32_16x16x32_bf16 v[136:139], v[216:219], v[196:199], v[136:139]
    s_waitcnt lgkmcnt(4)
    ds_read_b64_tr_b16 v[212:213], v224 offset:36872
    v_mfma_f32_16x16x32_bf16 v[12:15], v[220:223], v[180:183], v[12:15]
    ds_read_b64_tr_b16 v[214:215], v224 offset:38920
    v_mfma_f32_16x16x32_bf16 v[204:207], a[100:103], a[0:3], 0
    s_add_u32 s41, s41, 8192
    v_exp_f32 v200, v200
    v_mfma_f32_16x16x32_bf16 v[204:207], a[228:231], a[4:7], v[204:207]
    s_waitcnt vmcnt(5)
    s_add_u32 m0, s42, 16384
    ds_read_b128 a[216:219], v235 offset:24576
    v_lshlrev_b32 v252, 16, v236
    v_mfma_f32_16x16x32_bf16 v[204:207], a[232:235], a[8:11], v[204:207]
    v_exp_f32 v201, v201
    v_mfma_f32_16x16x32_bf16 v[204:207], a[236:239], a[12:15], v[204:207]
    buffer_load_dwordx4 v234, s[16:19], s41 offen offset:0 nt lds
    v_mfma_f32_16x16x32_bf16 v[44:47], v[220:223], v[184:187], v[44:47]
    s_add_u32 m0, s42, 49024
    v_exp_f32 v202, v202
    v_mfma_f32_16x16x32_bf16 v[76:79], v[220:223], v[188:191], v[76:79]
    ds_read_b128 a[220:223], v231 offset:24576
    v_and_b32 v236, s26, v236
    v_mul_f32 v252, s25, v252
    v_mul_f32 v236, s25, v236
    v_cvt_pk_bf16_f32 v236, v252, v236
    v_mfma_f32_16x16x32_bf16 v[108:111], v[220:223], v[192:195], v[108:111]
    v_exp_f32 v203, v203
    v_mfma_f32_16x16x32_bf16 v[140:143], v[220:223], v[196:199], v[140:143]
    ds_read_b64_tr_b16 v[216:217], v225 offset:36864
    v_cvt_pk_bf16_f32 v176, v200, v201
    v_cvt_pk_bf16_f32 v177, v202, v203
    v_mfma_f32_16x16x32_bf16 v[200:203], a[100:103], a[16:19], 0
    v_exp_f32 v204, v204
    v_mfma_f32_16x16x32_bf16 v[200:203], a[228:231], a[20:23], v[200:203]
    buffer_load_dwordx4 v234, s[16:19], s41 offen offset:128 nt lds
    v_mfma_f32_16x16x32_bf16 v[200:203], a[232:235], a[24:27], v[200:203]
    v_exp_f32 v205, v205
    v_mfma_f32_16x16x32_bf16 v[200:203], a[236:239], a[28:31], v[200:203]
    s_waitcnt lgkmcnt(7)
    ds_read_b64_tr_b16 v[218:219], v225 offset:38912
    v_lshlrev_b32 v253, 16, v237
    v_mfma_f32_16x16x32_bf16 v[16:19], v[208:211], v[180:183], v[16:19]
    v_exp_f32 v206, v206
    v_mfma_f32_16x16x32_bf16 v[48:51], v[208:211], v[184:187], v[48:51]
    ds_read_b128 a[108:111], v228 offset:28672
    v_and_b32 v237, s26, v237
    v_mul_f32 v253, s25, v253
    v_mul_f32 v237, s25, v237
    v_cvt_pk_bf16_f32 v237, v253, v237
    v_mfma_f32_16x16x32_bf16 v[80:83], v[208:211], v[188:191], v[80:83]
    v_exp_f32 v207, v207
    v_mfma_f32_16x16x32_bf16 v[112:115], v[208:211], v[192:195], v[112:115]
    v_cvt_pk_bf16_f32 v162, v204, v205
    v_cvt_pk_bf16_f32 v163, v206, v207
    v_smfmac_f32_16x16x64_bf16 a[244:247], a[252:255], v[188:195], v233
    ds_write_b64 v254, v[236:237] offset:0
    v_mfma_f32_16x16x32_bf16 v[204:207], a[100:103], a[32:35], 0
    v_exp_f32 v200, v200
    v_mfma_f32_16x16x32_bf16 v[204:207], a[228:231], a[36:39], v[204:207]
    v_lshlrev_b32 v252, 16, v238
    v_and_b32 v238, s26, v238
    v_mfma_f32_16x16x32_bf16 v[204:207], a[232:235], a[40:43], v[204:207]
    v_exp_f32 v201, v201
    v_mfma_f32_16x16x32_bf16 v[204:207], a[236:239], a[44:47], v[204:207]
    v_mul_f32 v252, s25, v252
    v_mul_f32 v238, s25, v238
    v_mfma_f32_16x16x32_bf16 v[144:147], v[208:211], v[196:199], v[144:147]
    s_waitcnt lgkmcnt(6)
    v_exp_f32 v202, v202
    v_cvt_pk_bf16_f32 v238, v252, v238
    v_mfma_f32_16x16x32_bf16 v[20:23], v[212:215], v[180:183], v[20:23]
    ds_read_b64_tr_b16 v[220:221], v225 offset:36872
    v_cvt_pk_bf16_f32 v166, v200, v201
    v_mfma_f32_16x16x32_bf16 v[52:55], v[212:215], v[184:187], v[52:55]
    v_exp_f32 v203, v203
    v_mfma_f32_16x16x32_bf16 v[84:87], v[212:215], v[188:191], v[84:87]
    ds_read_b64_tr_b16 v[222:223], v225 offset:38920
    v_cvt_pk_bf16_f32 v167, v202, v203
    v_mfma_f32_16x16x32_bf16 v[200:203], a[100:103], a[48:51], 0
    v_exp_f32 v204, v204
    v_mfma_f32_16x16x32_bf16 v[200:203], a[228:231], a[52:55], v[200:203]
    v_lshlrev_b32 v253, 16, v239
    v_and_b32 v239, s26, v239
    v_mfma_f32_16x16x32_bf16 v[200:203], a[232:235], a[56:59], v[200:203]
    v_exp_f32 v205, v205
    v_mfma_f32_16x16x32_bf16 v[200:203], a[236:239], a[60:63], v[200:203]
    v_mul_f32 v253, s25, v253
    v_mul_f32 v239, s25, v239
    v_mfma_f32_16x16x32_bf16 v[116:119], v[212:215], v[192:195], v[116:119]
    v_exp_f32 v206, v206
    v_cvt_pk_bf16_f32 v239, v253, v239
    v_mfma_f32_16x16x32_bf16 v[148:151], v[212:215], v[196:199], v[148:151]
    s_waitcnt lgkmcnt(4)
    ds_read_b64_tr_b16 v[208:209], v224 offset:8192
    v_cvt_pk_bf16_f32 v170, v204, v205
    v_mfma_f32_16x16x32_bf16 v[24:27], v[216:219], v[180:183], v[24:27]
    v_exp_f32 v207, v207
    v_mfma_f32_16x16x32_bf16 v[56:59], v[216:219], v[184:187], v[56:59]
    ds_write_b64 v254, v[238:239] offset:8
    v_smfmac_f32_16x16x64_bf16 a[248:251], a[252:255], v[192:199], v233
    ds_read_b64_tr_b16 v[210:211], v224 offset:10240
    v_cvt_pk_bf16_f32 v171, v206, v207
    v_mfma_f32_16x16x32_bf16 v[204:207], a[100:103], a[64:67], 0
    v_exp_f32 v200, v200
    v_mfma_f32_16x16x32_bf16 v[204:207], a[228:231], a[68:71], v[204:207]
    s_waitcnt vmcnt(6)
    ds_read_b128 a[228:231], v229 offset:28672
    v_lshlrev_b32 v252, 16, v240
    v_mfma_f32_16x16x32_bf16 v[204:207], a[232:235], a[72:75], v[204:207]
    v_exp_f32 v201, v201
    v_mfma_f32_16x16x32_bf16 v[204:207], a[236:239], a[76:79], v[204:207]
    ds_read_b128 a[232:235], v235 offset:28672
    v_and_b32 v240, s26, v240
    v_mul_f32 v252, s25, v252
    v_mul_f32 v240, s25, v240
    v_cvt_pk_bf16_f32 v240, v252, v240
    v_mfma_f32_16x16x32_bf16 v[88:91], v[216:219], v[188:191], v[88:91]
    v_exp_f32 v202, v202
    v_mfma_f32_16x16x32_bf16 v[120:123], v[216:219], v[192:195], v[120:123]
    ds_read_b128 a[236:239], v231 offset:28672
    v_cvt_pk_bf16_f32 v174, v200, v201
    v_mfma_f32_16x16x32_bf16 v[152:155], v[216:219], v[196:199], v[152:155]
    s_waitcnt lgkmcnt(6)
    v_exp_f32 v203, v203
    v_mfma_f32_16x16x32_bf16 v[28:31], v[220:223], v[180:183], v[28:31]
    ds_read_b64_tr_b16 v[212:213], v224 offset:8200
    v_cvt_pk_bf16_f32 v175, v202, v203
    v_mfma_f32_16x16x32_bf16 v[200:203], a[104:107], a[0:3], 0
    s_add_u32 s40, s40, 8192
    v_exp_f32 v204, v204
    v_mfma_f32_16x16x32_bf16 v[200:203], a[212:215], a[4:7], v[200:203]
    buffer_load_dwordx4 v[236:239], v234, s[12:15], s40 offen offset:0 nt
    v_mfma_f32_16x16x32_bf16 v[200:203], a[216:219], a[8:11], v[200:203]
    v_exp_f32 v205, v205
    v_mfma_f32_16x16x32_bf16 v[200:203], a[220:223], a[12:15], v[200:203]
    ds_read_b64_tr_b16 v[214:215], v224 offset:10248
    v_lshlrev_b32 v253, 16, v241
    v_and_b32 v241, s26, v241
    v_mul_f32 v253, s25, v253
    v_mul_f32 v241, s25, v241
    v_cvt_pk_bf16_f32 v241, v253, v241
    v_mfma_f32_16x16x32_bf16 v[60:63], v[220:223], v[184:187], v[60:63]
    v_exp_f32 v206, v206
    v_mfma_f32_16x16x32_bf16 v[92:95], v[220:223], v[188:191], v[92:95]
    v_exp_f32 v207, v207
    v_mfma_f32_16x16x32_bf16 v[124:127], v[220:223], v[192:195], v[124:127]
    ds_write_b64 v254, v[240:241] offset:128
    v_mfma_f32_16x16x32_bf16 v[156:159], v[220:223], v[196:199], v[156:159]
    ds_read_b64_tr_b16 v[216:217], v225 offset:8192
    v_cvt_pk_bf16_f32 v178, v204, v205
    v_cvt_pk_bf16_f32 v179, v206, v207
    v_mfma_f32_16x16x32_bf16 v[204:207], a[104:107], a[16:19], 0
    v_exp_f32 v200, v200
    v_mfma_f32_16x16x32_bf16 v[204:207], a[212:215], a[20:23], v[204:207]
    ds_read_b64_tr_b16 v[218:219], v225 offset:10240
    v_lshlrev_b32 v252, 16, v242
    v_mfma_f32_16x16x32_bf16 v[204:207], a[216:219], a[24:27], v[204:207]
    v_exp_f32 v201, v201
    v_mfma_f32_16x16x32_bf16 v[204:207], a[220:223], a[28:31], v[204:207]
    s_waitcnt lgkmcnt(8)
    v_and_b32 v242, s26, v242
    v_mul_f32 v252, s25, v252
    v_mul_f32 v242, s25, v242
    v_cvt_pk_bf16_f32 v242, v252, v242
    v_mfma_f32_16x16x32_bf16 v[0:3], v[208:211], v[160:163], v[0:3]
    v_exp_f32 v202, v202
    v_mfma_f32_16x16x32_bf16 v[32:35], v[208:211], v[164:167], v[32:35]
    v_lshlrev_b32 v253, 16, v243
    v_cvt_pk_bf16_f32 v180, v200, v201
    v_mfma_f32_16x16x32_bf16 v[64:67], v[208:211], v[168:171], v[64:67]
    v_exp_f32 v203, v203
    v_mfma_f32_16x16x32_bf16 v[96:99], v[208:211], v[172:175], v[96:99]
    v_cvt_pk_bf16_f32 v181, v202, v203
    v_and_b32 v243, s26, v243
    v_smfmac_f32_16x16x64_bf16 a[240:243], a[252:255], v[160:167], v233
    v_mul_f32 v253, s25, v253
    v_mul_f32 v243, s25, v243
    v_mfma_f32_16x16x32_bf16 v[200:203], a[104:107], a[32:35], 0
    v_exp_f32 v204, v204
    v_mfma_f32_16x16x32_bf16 v[200:203], a[212:215], a[36:39], v[200:203]
    v_cvt_pk_bf16_f32 v243, v253, v243
    v_mfma_f32_16x16x32_bf16 v[200:203], a[216:219], a[40:43], v[200:203]
    v_exp_f32 v205, v205
    v_mfma_f32_16x16x32_bf16 v[200:203], a[220:223], a[44:47], v[200:203]
    v_exp_f32 v206, v206
    v_mfma_f32_16x16x32_bf16 v[128:131], v[208:211], v[176:179], v[128:131]
    s_waitcnt lgkmcnt(3)
    v_exp_f32 v207, v207
    v_mfma_f32_16x16x32_bf16 v[4:7], v[212:215], v[160:163], v[4:7]
    ds_write_b64 v254, v[242:243] offset:136
    v_mfma_f32_16x16x32_bf16 v[36:39], v[212:215], v[164:167], v[36:39]
    buffer_load_dwordx4 v[240:243], v234, s[12:15], s40 offen offset:2048 nt
    v_mfma_f32_16x16x32_bf16 v[68:71], v[212:215], v[168:171], v[68:71]
    ds_read_b64_tr_b16 v[220:221], v225 offset:8200
    v_cvt_pk_bf16_f32 v184, v204, v205
    v_cvt_pk_bf16_f32 v185, v206, v207
    v_mfma_f32_16x16x32_bf16 v[204:207], a[104:107], a[48:51], 0
    v_exp_f32 v200, v200
    v_mfma_f32_16x16x32_bf16 v[204:207], a[212:215], a[52:55], v[204:207]
    ds_read_b64_tr_b16 v[222:223], v225 offset:10248
    v_mfma_f32_16x16x32_bf16 v[204:207], a[216:219], a[56:59], v[204:207]
    v_exp_f32 v201, v201
    v_mfma_f32_16x16x32_bf16 v[204:207], a[220:223], a[60:63], v[204:207]
    v_exp_f32 v202, v202
    v_mfma_f32_16x16x32_bf16 v[100:103], v[212:215], v[172:175], v[100:103]
    v_exp_f32 v203, v203
    v_mfma_f32_16x16x32_bf16 v[132:135], v[212:215], v[176:179], v[132:135]
    s_waitcnt lgkmcnt(3)
    ds_read_b64_tr_b16 v[208:209], v224 offset:40960
    v_cvt_pk_bf16_f32 v188, v200, v201
    v_mfma_f32_16x16x32_bf16 v[8:11], v[216:219], v[160:163], v[8:11]
    ds_read_b64_tr_b16 v[210:211], v224 offset:43008
    v_cvt_pk_bf16_f32 v189, v202, v203
    v_mfma_f32_16x16x32_bf16 v[40:43], v[216:219], v[164:167], v[40:43]
    v_mfma_f32_16x16x32_bf16 v[200:203], a[104:107], a[64:67], 0
    v_exp_f32 v204, v204
    v_mfma_f32_16x16x32_bf16 v[200:203], a[212:215], a[68:71], v[200:203]
    v_exp_f32 v205, v205
    v_mfma_f32_16x16x32_bf16 v[200:203], a[216:219], a[72:75], v[200:203]
    v_exp_f32 v206, v206
    v_mfma_f32_16x16x32_bf16 v[200:203], a[220:223], a[76:79], v[200:203]
    s_waitcnt vmcnt(6) lgkmcnt(4)
    s_barrier
    ds_read_b128 a[112:115], v228 offset:0
    v_cvt_pk_bf16_f32 v192, v204, v205
    v_mfma_f32_16x16x32_bf16 v[72:75], v[216:219], v[168:171], v[72:75]
    v_exp_f32 v207, v207
    v_mfma_f32_16x16x32_bf16 v[104:107], v[216:219], v[172:175], v[104:107]
    ds_read_b128 a[212:215], v229 offset:0
    v_cvt_pk_bf16_f32 v193, v206, v207
    v_mfma_f32_16x16x32_bf16 v[136:139], v[216:219], v[176:179], v[136:139]
    s_waitcnt lgkmcnt(4)
    ds_read_b64_tr_b16 v[212:213], v224 offset:40968
    v_mfma_f32_16x16x32_bf16 v[12:15], v[220:223], v[160:163], v[12:15]
    ds_read_b64_tr_b16 v[214:215], v224 offset:43016
    v_mfma_f32_16x16x32_bf16 v[204:207], a[108:111], a[0:3], 0
    s_add_u32 s41, s41, 8192
    v_exp_f32 v200, v200
    v_mfma_f32_16x16x32_bf16 v[204:207], a[228:231], a[4:7], v[204:207]
    s_waitcnt vmcnt(5)
    s_add_u32 m0, s42, 20480
    ds_read_b128 a[216:219], v235 offset:0
    v_lshlrev_b32 v252, 16, v244
    v_mfma_f32_16x16x32_bf16 v[204:207], a[232:235], a[8:11], v[204:207]
    v_exp_f32 v201, v201
    v_mfma_f32_16x16x32_bf16 v[204:207], a[236:239], a[12:15], v[204:207]
    buffer_load_dwordx4 v234, s[16:19], s41 offen offset:0 nt lds
    v_mfma_f32_16x16x32_bf16 v[44:47], v[220:223], v[164:167], v[44:47]
    s_add_u32 m0, s42, 53120
    v_exp_f32 v202, v202
    v_mfma_f32_16x16x32_bf16 v[76:79], v[220:223], v[168:171], v[76:79]
    ds_read_b128 a[220:223], v231 offset:0
    v_and_b32 v244, s26, v244
    v_mul_f32 v252, s25, v252
    v_mul_f32 v244, s25, v244
    v_cvt_pk_bf16_f32 v244, v252, v244
    v_mfma_f32_16x16x32_bf16 v[108:111], v[220:223], v[172:175], v[108:111]
    v_exp_f32 v203, v203
    v_mfma_f32_16x16x32_bf16 v[140:143], v[220:223], v[176:179], v[140:143]
    ds_read_b64_tr_b16 v[216:217], v225 offset:40960
    v_cvt_pk_bf16_f32 v196, v200, v201
    v_cvt_pk_bf16_f32 v197, v202, v203
    v_mfma_f32_16x16x32_bf16 v[200:203], a[108:111], a[16:19], 0
    v_exp_f32 v204, v204
    v_mfma_f32_16x16x32_bf16 v[200:203], a[228:231], a[20:23], v[200:203]
    buffer_load_dwordx4 v234, s[16:19], s41 offen offset:128 nt lds
    v_mfma_f32_16x16x32_bf16 v[200:203], a[232:235], a[24:27], v[200:203]
    v_exp_f32 v205, v205
    v_mfma_f32_16x16x32_bf16 v[200:203], a[236:239], a[28:31], v[200:203]
    s_waitcnt lgkmcnt(7)
    ds_read_b64_tr_b16 v[218:219], v225 offset:43008
    v_lshlrev_b32 v253, 16, v245
    v_mfma_f32_16x16x32_bf16 v[16:19], v[208:211], v[160:163], v[16:19]
    v_exp_f32 v206, v206
    v_mfma_f32_16x16x32_bf16 v[48:51], v[208:211], v[164:167], v[48:51]
    ds_read_b128 a[116:119], v228 offset:4096
    v_and_b32 v245, s26, v245
    v_mul_f32 v253, s25, v253
    v_mul_f32 v245, s25, v245
    v_cvt_pk_bf16_f32 v245, v253, v245
    v_mfma_f32_16x16x32_bf16 v[80:83], v[208:211], v[168:171], v[80:83]
    v_exp_f32 v207, v207
    v_mfma_f32_16x16x32_bf16 v[112:115], v[208:211], v[172:175], v[112:115]
    v_cvt_pk_bf16_f32 v182, v204, v205
    v_cvt_pk_bf16_f32 v183, v206, v207
    v_smfmac_f32_16x16x64_bf16 a[244:247], a[252:255], v[168:175], v233
    ds_write_b64 v254, v[244:245] offset:8192
    v_mfma_f32_16x16x32_bf16 v[204:207], a[108:111], a[32:35], 0
    v_exp_f32 v200, v200
    v_mfma_f32_16x16x32_bf16 v[204:207], a[228:231], a[36:39], v[204:207]
    v_lshlrev_b32 v252, 16, v246
    v_and_b32 v246, s26, v246
    v_mfma_f32_16x16x32_bf16 v[204:207], a[232:235], a[40:43], v[204:207]
    v_exp_f32 v201, v201
    v_mfma_f32_16x16x32_bf16 v[204:207], a[236:239], a[44:47], v[204:207]
    v_mul_f32 v252, s25, v252
    v_mul_f32 v246, s25, v246
    v_mfma_f32_16x16x32_bf16 v[144:147], v[208:211], v[176:179], v[144:147]
    s_waitcnt lgkmcnt(6)
    v_exp_f32 v202, v202
    v_cvt_pk_bf16_f32 v246, v252, v246
    v_mfma_f32_16x16x32_bf16 v[20:23], v[212:215], v[160:163], v[20:23]
    ds_read_b64_tr_b16 v[220:221], v225 offset:40968
    v_cvt_pk_bf16_f32 v186, v200, v201
    v_mfma_f32_16x16x32_bf16 v[52:55], v[212:215], v[164:167], v[52:55]
    v_exp_f32 v203, v203
    v_mfma_f32_16x16x32_bf16 v[84:87], v[212:215], v[168:171], v[84:87]
    ds_read_b64_tr_b16 v[222:223], v225 offset:43016
    v_cvt_pk_bf16_f32 v187, v202, v203
    v_mfma_f32_16x16x32_bf16 v[200:203], a[108:111], a[48:51], 0
    v_exp_f32 v204, v204
    v_mfma_f32_16x16x32_bf16 v[200:203], a[228:231], a[52:55], v[200:203]
    v_lshlrev_b32 v253, 16, v247
    v_and_b32 v247, s26, v247
    v_mfma_f32_16x16x32_bf16 v[200:203], a[232:235], a[56:59], v[200:203]
    v_exp_f32 v205, v205
    v_mfma_f32_16x16x32_bf16 v[200:203], a[236:239], a[60:63], v[200:203]
    v_mul_f32 v253, s25, v253
    v_mul_f32 v247, s25, v247
    v_mfma_f32_16x16x32_bf16 v[116:119], v[212:215], v[172:175], v[116:119]
    v_exp_f32 v206, v206
    v_cvt_pk_bf16_f32 v247, v253, v247
    v_mfma_f32_16x16x32_bf16 v[148:151], v[212:215], v[176:179], v[148:151]
    s_waitcnt lgkmcnt(4)
    ds_read_b64_tr_b16 v[208:209], v224 offset:12288
    v_cvt_pk_bf16_f32 v190, v204, v205
    v_mfma_f32_16x16x32_bf16 v[24:27], v[216:219], v[160:163], v[24:27]
    v_exp_f32 v207, v207
    v_mfma_f32_16x16x32_bf16 v[56:59], v[216:219], v[164:167], v[56:59]
    ds_write_b64 v254, v[246:247] offset:8200
    v_smfmac_f32_16x16x64_bf16 a[248:251], a[252:255], v[172:179], v233
    ds_read_b64_tr_b16 v[210:211], v224 offset:14336
    v_cvt_pk_bf16_f32 v191, v206, v207
    v_mfma_f32_16x16x32_bf16 v[204:207], a[108:111], a[64:67], 0
    v_exp_f32 v200, v200
    v_mfma_f32_16x16x32_bf16 v[204:207], a[228:231], a[68:71], v[204:207]
    s_waitcnt vmcnt(6)
    ds_read_b128 a[228:231], v229 offset:4096
    v_lshlrev_b32 v252, 16, v248
    v_mfma_f32_16x16x32_bf16 v[204:207], a[232:235], a[72:75], v[204:207]
    v_exp_f32 v201, v201
    v_mfma_f32_16x16x32_bf16 v[204:207], a[236:239], a[76:79], v[204:207]
    ds_read_b128 a[232:235], v235 offset:4096
    v_and_b32 v248, s26, v248
    v_mul_f32 v252, s25, v252
    v_mul_f32 v248, s25, v248
    v_cvt_pk_bf16_f32 v248, v252, v248
    v_mfma_f32_16x16x32_bf16 v[88:91], v[216:219], v[168:171], v[88:91]
    v_exp_f32 v202, v202
    v_mfma_f32_16x16x32_bf16 v[120:123], v[216:219], v[172:175], v[120:123]
    ds_read_b128 a[236:239], v231 offset:4096
    v_cvt_pk_bf16_f32 v194, v200, v201
    v_mfma_f32_16x16x32_bf16 v[152:155], v[216:219], v[176:179], v[152:155]
    s_waitcnt lgkmcnt(6)
    v_exp_f32 v203, v203
    v_mfma_f32_16x16x32_bf16 v[28:31], v[220:223], v[160:163], v[28:31]
    ds_read_b64_tr_b16 v[212:213], v224 offset:12296
    v_cvt_pk_bf16_f32 v195, v202, v203
    v_mfma_f32_16x16x32_bf16 v[200:203], a[112:115], a[0:3], 0
    s_add_u32 s40, s40, 8192
    v_exp_f32 v204, v204
    v_mfma_f32_16x16x32_bf16 v[200:203], a[212:215], a[4:7], v[200:203]
    buffer_load_dwordx4 v[244:247], v234, s[12:15], s40 offen offset:0 nt
    v_mfma_f32_16x16x32_bf16 v[200:203], a[216:219], a[8:11], v[200:203]
    v_exp_f32 v205, v205
    v_mfma_f32_16x16x32_bf16 v[200:203], a[220:223], a[12:15], v[200:203]
    ds_read_b64_tr_b16 v[214:215], v224 offset:14344
    v_lshlrev_b32 v253, 16, v249
    v_and_b32 v249, s26, v249
    v_mul_f32 v253, s25, v253
    v_mul_f32 v249, s25, v249
    v_cvt_pk_bf16_f32 v249, v253, v249
    v_mfma_f32_16x16x32_bf16 v[60:63], v[220:223], v[164:167], v[60:63]
    v_exp_f32 v206, v206
    v_mfma_f32_16x16x32_bf16 v[92:95], v[220:223], v[168:171], v[92:95]
    v_exp_f32 v207, v207
    v_mfma_f32_16x16x32_bf16 v[124:127], v[220:223], v[172:175], v[124:127]
    ds_write_b64 v254, v[248:249] offset:8320
    v_mfma_f32_16x16x32_bf16 v[156:159], v[220:223], v[176:179], v[156:159]
    ds_read_b64_tr_b16 v[216:217], v225 offset:12288
    v_cvt_pk_bf16_f32 v198, v204, v205
    v_cvt_pk_bf16_f32 v199, v206, v207
    v_mfma_f32_16x16x32_bf16 v[204:207], a[112:115], a[16:19], 0
    v_exp_f32 v200, v200
    v_mfma_f32_16x16x32_bf16 v[204:207], a[212:215], a[20:23], v[204:207]
    ds_read_b64_tr_b16 v[218:219], v225 offset:14336
    v_lshlrev_b32 v252, 16, v250
    v_mfma_f32_16x16x32_bf16 v[204:207], a[216:219], a[24:27], v[204:207]
    v_exp_f32 v201, v201
    v_mfma_f32_16x16x32_bf16 v[204:207], a[220:223], a[28:31], v[204:207]
    s_waitcnt lgkmcnt(8)
    v_and_b32 v250, s26, v250
    v_mul_f32 v252, s25, v252
    v_mul_f32 v250, s25, v250
    v_cvt_pk_bf16_f32 v250, v252, v250
    v_mfma_f32_16x16x32_bf16 v[0:3], v[208:211], v[180:183], v[0:3]
    v_exp_f32 v202, v202
    v_mfma_f32_16x16x32_bf16 v[32:35], v[208:211], v[184:187], v[32:35]
    v_lshlrev_b32 v253, 16, v251
    v_cvt_pk_bf16_f32 v160, v200, v201
    v_mfma_f32_16x16x32_bf16 v[64:67], v[208:211], v[188:191], v[64:67]
    v_exp_f32 v203, v203
    v_mfma_f32_16x16x32_bf16 v[96:99], v[208:211], v[192:195], v[96:99]
    v_cvt_pk_bf16_f32 v161, v202, v203
    v_and_b32 v251, s26, v251
    v_smfmac_f32_16x16x64_bf16 a[240:243], a[252:255], v[180:187], v233
    v_mul_f32 v253, s25, v253
    v_mul_f32 v251, s25, v251
    v_mfma_f32_16x16x32_bf16 v[200:203], a[112:115], a[32:35], 0
    v_exp_f32 v204, v204
    v_mfma_f32_16x16x32_bf16 v[200:203], a[212:215], a[36:39], v[200:203]
    v_cvt_pk_bf16_f32 v251, v253, v251
    v_mfma_f32_16x16x32_bf16 v[200:203], a[216:219], a[40:43], v[200:203]
    v_exp_f32 v205, v205
    v_mfma_f32_16x16x32_bf16 v[200:203], a[220:223], a[44:47], v[200:203]
    v_exp_f32 v206, v206
    v_mfma_f32_16x16x32_bf16 v[128:131], v[208:211], v[196:199], v[128:131]
    s_waitcnt lgkmcnt(3)
    v_exp_f32 v207, v207
    v_mfma_f32_16x16x32_bf16 v[4:7], v[212:215], v[180:183], v[4:7]
    ds_write_b64 v254, v[250:251] offset:8328
    v_mfma_f32_16x16x32_bf16 v[36:39], v[212:215], v[184:187], v[36:39]
    buffer_load_dwordx4 v[248:251], v234, s[12:15], s40 offen offset:2048 nt
    v_mfma_f32_16x16x32_bf16 v[68:71], v[212:215], v[188:191], v[68:71]
    ds_read_b64_tr_b16 v[220:221], v225 offset:12296
    v_cvt_pk_bf16_f32 v164, v204, v205
    v_cvt_pk_bf16_f32 v165, v206, v207
    v_mfma_f32_16x16x32_bf16 v[204:207], a[112:115], a[48:51], 0
    v_exp_f32 v200, v200
    v_mfma_f32_16x16x32_bf16 v[204:207], a[212:215], a[52:55], v[204:207]
    ds_read_b64_tr_b16 v[222:223], v225 offset:14344
    v_mfma_f32_16x16x32_bf16 v[204:207], a[216:219], a[56:59], v[204:207]
    v_exp_f32 v201, v201
    v_mfma_f32_16x16x32_bf16 v[204:207], a[220:223], a[60:63], v[204:207]
    v_exp_f32 v202, v202
    v_mfma_f32_16x16x32_bf16 v[100:103], v[212:215], v[192:195], v[100:103]
    v_exp_f32 v203, v203
    v_mfma_f32_16x16x32_bf16 v[132:135], v[212:215], v[196:199], v[132:135]
    s_waitcnt lgkmcnt(3)
    ds_read_b64_tr_b16 v[208:209], v224 offset:45056
    v_cvt_pk_bf16_f32 v168, v200, v201
    v_mfma_f32_16x16x32_bf16 v[8:11], v[216:219], v[180:183], v[8:11]
    ds_read_b64_tr_b16 v[210:211], v224 offset:47104
    v_cvt_pk_bf16_f32 v169, v202, v203
    v_mfma_f32_16x16x32_bf16 v[40:43], v[216:219], v[184:187], v[40:43]
    v_mfma_f32_16x16x32_bf16 v[200:203], a[112:115], a[64:67], 0
    v_exp_f32 v204, v204
    v_mfma_f32_16x16x32_bf16 v[200:203], a[212:215], a[68:71], v[200:203]
    v_exp_f32 v205, v205
    v_mfma_f32_16x16x32_bf16 v[200:203], a[216:219], a[72:75], v[200:203]
    v_exp_f32 v206, v206
    v_mfma_f32_16x16x32_bf16 v[200:203], a[220:223], a[76:79], v[200:203]
    s_waitcnt vmcnt(6) lgkmcnt(4)
    s_barrier
    ds_read_b128 a[120:123], v228 offset:8192
    v_cvt_pk_bf16_f32 v172, v204, v205
    v_mfma_f32_16x16x32_bf16 v[72:75], v[216:219], v[188:191], v[72:75]
    v_exp_f32 v207, v207
    v_mfma_f32_16x16x32_bf16 v[104:107], v[216:219], v[192:195], v[104:107]
    ds_read_b128 a[212:215], v229 offset:8192
    v_cvt_pk_bf16_f32 v173, v206, v207
    v_mfma_f32_16x16x32_bf16 v[136:139], v[216:219], v[196:199], v[136:139]
    s_waitcnt lgkmcnt(4)
    ds_read_b64_tr_b16 v[212:213], v224 offset:45064
    v_mfma_f32_16x16x32_bf16 v[12:15], v[220:223], v[180:183], v[12:15]
    ds_read_b64_tr_b16 v[214:215], v224 offset:47112
    v_mfma_f32_16x16x32_bf16 v[204:207], a[116:119], a[0:3], 0
    s_add_u32 s41, s41, 8192
    v_exp_f32 v200, v200
    v_mfma_f32_16x16x32_bf16 v[204:207], a[228:231], a[4:7], v[204:207]
    s_waitcnt vmcnt(5)
    s_add_u32 m0, s42, 24576
    ds_read_b128 a[216:219], v235 offset:8192
    v_lshlrev_b32 v252, 16, v236
    v_mfma_f32_16x16x32_bf16 v[204:207], a[232:235], a[8:11], v[204:207]
    v_exp_f32 v201, v201
    v_mfma_f32_16x16x32_bf16 v[204:207], a[236:239], a[12:15], v[204:207]
    buffer_load_dwordx4 v234, s[16:19], s41 offen offset:0 nt lds
    v_mfma_f32_16x16x32_bf16 v[44:47], v[220:223], v[184:187], v[44:47]
    s_add_u32 m0, s42, 57216
    v_exp_f32 v202, v202
    v_mfma_f32_16x16x32_bf16 v[76:79], v[220:223], v[188:191], v[76:79]
    ds_read_b128 a[220:223], v231 offset:8192
    v_and_b32 v236, s26, v236
    v_mul_f32 v252, s25, v252
    v_mul_f32 v236, s25, v236
    v_cvt_pk_bf16_f32 v236, v252, v236
    v_mfma_f32_16x16x32_bf16 v[108:111], v[220:223], v[192:195], v[108:111]
    v_exp_f32 v203, v203
    v_mfma_f32_16x16x32_bf16 v[140:143], v[220:223], v[196:199], v[140:143]
    ds_read_b64_tr_b16 v[216:217], v225 offset:45056
    v_cvt_pk_bf16_f32 v176, v200, v201
    v_cvt_pk_bf16_f32 v177, v202, v203
    v_mfma_f32_16x16x32_bf16 v[200:203], a[116:119], a[16:19], 0
    v_exp_f32 v204, v204
    v_mfma_f32_16x16x32_bf16 v[200:203], a[228:231], a[20:23], v[200:203]
    buffer_load_dwordx4 v234, s[16:19], s41 offen offset:128 nt lds
    v_mfma_f32_16x16x32_bf16 v[200:203], a[232:235], a[24:27], v[200:203]
    v_exp_f32 v205, v205
    v_mfma_f32_16x16x32_bf16 v[200:203], a[236:239], a[28:31], v[200:203]
    s_waitcnt lgkmcnt(7)
    ds_read_b64_tr_b16 v[218:219], v225 offset:47104
    v_lshlrev_b32 v253, 16, v237
    v_mfma_f32_16x16x32_bf16 v[16:19], v[208:211], v[180:183], v[16:19]
    v_exp_f32 v206, v206
    v_mfma_f32_16x16x32_bf16 v[48:51], v[208:211], v[184:187], v[48:51]
    ds_read_b128 a[124:127], v228 offset:12288
    v_and_b32 v237, s26, v237
    v_mul_f32 v253, s25, v253
    v_mul_f32 v237, s25, v237
    v_cvt_pk_bf16_f32 v237, v253, v237
    v_mfma_f32_16x16x32_bf16 v[80:83], v[208:211], v[188:191], v[80:83]
    v_exp_f32 v207, v207
    v_mfma_f32_16x16x32_bf16 v[112:115], v[208:211], v[192:195], v[112:115]
    v_cvt_pk_bf16_f32 v162, v204, v205
    v_cvt_pk_bf16_f32 v163, v206, v207
    v_smfmac_f32_16x16x64_bf16 a[244:247], a[252:255], v[188:195], v233
    ds_write_b64 v254, v[236:237] offset:16384
    v_mfma_f32_16x16x32_bf16 v[204:207], a[116:119], a[32:35], 0
    v_exp_f32 v200, v200
    v_mfma_f32_16x16x32_bf16 v[204:207], a[228:231], a[36:39], v[204:207]
    v_lshlrev_b32 v252, 16, v238
    v_and_b32 v238, s26, v238
    v_mfma_f32_16x16x32_bf16 v[204:207], a[232:235], a[40:43], v[204:207]
    v_exp_f32 v201, v201
    v_mfma_f32_16x16x32_bf16 v[204:207], a[236:239], a[44:47], v[204:207]
    v_mul_f32 v252, s25, v252
    v_mul_f32 v238, s25, v238
    v_mfma_f32_16x16x32_bf16 v[144:147], v[208:211], v[196:199], v[144:147]
    s_waitcnt lgkmcnt(6)
    v_exp_f32 v202, v202
    v_cvt_pk_bf16_f32 v238, v252, v238
    v_mfma_f32_16x16x32_bf16 v[20:23], v[212:215], v[180:183], v[20:23]
    ds_read_b64_tr_b16 v[220:221], v225 offset:45064
    v_cvt_pk_bf16_f32 v166, v200, v201
    v_mfma_f32_16x16x32_bf16 v[52:55], v[212:215], v[184:187], v[52:55]
    v_exp_f32 v203, v203
    v_mfma_f32_16x16x32_bf16 v[84:87], v[212:215], v[188:191], v[84:87]
    ds_read_b64_tr_b16 v[222:223], v225 offset:47112
    v_cvt_pk_bf16_f32 v167, v202, v203
    v_mfma_f32_16x16x32_bf16 v[200:203], a[116:119], a[48:51], 0
    v_exp_f32 v204, v204
    v_mfma_f32_16x16x32_bf16 v[200:203], a[228:231], a[52:55], v[200:203]
    v_lshlrev_b32 v253, 16, v239
    v_and_b32 v239, s26, v239
    v_mfma_f32_16x16x32_bf16 v[200:203], a[232:235], a[56:59], v[200:203]
    v_exp_f32 v205, v205
    v_mfma_f32_16x16x32_bf16 v[200:203], a[236:239], a[60:63], v[200:203]
    v_mul_f32 v253, s25, v253
    v_mul_f32 v239, s25, v239
    v_mfma_f32_16x16x32_bf16 v[116:119], v[212:215], v[192:195], v[116:119]
    v_exp_f32 v206, v206
    v_cvt_pk_bf16_f32 v239, v253, v239
    v_mfma_f32_16x16x32_bf16 v[148:151], v[212:215], v[196:199], v[148:151]
    s_waitcnt lgkmcnt(4)
    ds_read_b64_tr_b16 v[208:209], v224 offset:16384
    v_cvt_pk_bf16_f32 v170, v204, v205
    v_mfma_f32_16x16x32_bf16 v[24:27], v[216:219], v[180:183], v[24:27]
    v_exp_f32 v207, v207
    v_mfma_f32_16x16x32_bf16 v[56:59], v[216:219], v[184:187], v[56:59]
    ds_write_b64 v254, v[238:239] offset:16392
    v_smfmac_f32_16x16x64_bf16 a[248:251], a[252:255], v[192:199], v233
    ds_read_b64_tr_b16 v[210:211], v224 offset:18432
    v_cvt_pk_bf16_f32 v171, v206, v207
    v_mfma_f32_16x16x32_bf16 v[204:207], a[116:119], a[64:67], 0
    v_exp_f32 v200, v200
    v_mfma_f32_16x16x32_bf16 v[204:207], a[228:231], a[68:71], v[204:207]
    s_waitcnt vmcnt(6)
    ds_read_b128 a[228:231], v229 offset:12288
    v_lshlrev_b32 v252, 16, v240
    v_mfma_f32_16x16x32_bf16 v[204:207], a[232:235], a[72:75], v[204:207]
    v_exp_f32 v201, v201
    v_mfma_f32_16x16x32_bf16 v[204:207], a[236:239], a[76:79], v[204:207]
    ds_read_b128 a[232:235], v235 offset:12288
    v_and_b32 v240, s26, v240
    v_mul_f32 v252, s25, v252
    v_mul_f32 v240, s25, v240
    v_cvt_pk_bf16_f32 v240, v252, v240
    v_mfma_f32_16x16x32_bf16 v[88:91], v[216:219], v[188:191], v[88:91]
    v_exp_f32 v202, v202
    v_mfma_f32_16x16x32_bf16 v[120:123], v[216:219], v[192:195], v[120:123]
    ds_read_b128 a[236:239], v231 offset:12288
    v_cvt_pk_bf16_f32 v174, v200, v201
    v_mfma_f32_16x16x32_bf16 v[152:155], v[216:219], v[196:199], v[152:155]
    s_waitcnt lgkmcnt(6)
    v_exp_f32 v203, v203
    v_mfma_f32_16x16x32_bf16 v[28:31], v[220:223], v[180:183], v[28:31]
    ds_read_b64_tr_b16 v[212:213], v224 offset:16392
    v_cvt_pk_bf16_f32 v175, v202, v203
    v_mfma_f32_16x16x32_bf16 v[200:203], a[120:123], a[0:3], 0
    s_add_u32 s40, s40, 8192
    v_exp_f32 v204, v204
    v_mfma_f32_16x16x32_bf16 v[200:203], a[212:215], a[4:7], v[200:203]
    buffer_load_dwordx4 v[236:239], v234, s[12:15], s40 offen offset:0 nt
    v_mfma_f32_16x16x32_bf16 v[200:203], a[216:219], a[8:11], v[200:203]
    v_exp_f32 v205, v205
    v_mfma_f32_16x16x32_bf16 v[200:203], a[220:223], a[12:15], v[200:203]
    ds_read_b64_tr_b16 v[214:215], v224 offset:18440
    v_lshlrev_b32 v253, 16, v241
    v_and_b32 v241, s26, v241
    v_mul_f32 v253, s25, v253
    v_mul_f32 v241, s25, v241
    v_cvt_pk_bf16_f32 v241, v253, v241
    v_mfma_f32_16x16x32_bf16 v[60:63], v[220:223], v[184:187], v[60:63]
    v_exp_f32 v206, v206
    v_mfma_f32_16x16x32_bf16 v[92:95], v[220:223], v[188:191], v[92:95]
    v_exp_f32 v207, v207
    v_mfma_f32_16x16x32_bf16 v[124:127], v[220:223], v[192:195], v[124:127]
    ds_write_b64 v254, v[240:241] offset:16512
    v_mfma_f32_16x16x32_bf16 v[156:159], v[220:223], v[196:199], v[156:159]
    ds_read_b64_tr_b16 v[216:217], v225 offset:16384
    v_cvt_pk_bf16_f32 v178, v204, v205
    v_cvt_pk_bf16_f32 v179, v206, v207
    v_mfma_f32_16x16x32_bf16 v[204:207], a[120:123], a[16:19], 0
    v_exp_f32 v200, v200
    v_mfma_f32_16x16x32_bf16 v[204:207], a[212:215], a[20:23], v[204:207]
L_pad1:
    s_cbranch_vccnz L_pad5
    ds_read_b64_tr_b16 v[218:219], v225 offset:18432
    v_lshlrev_b32 v252, 16, v242
    v_mfma_f32_16x16x32_bf16 v[204:207], a[216:219], a[24:27], v[204:207]
    v_exp_f32 v201, v201
    v_mfma_f32_16x16x32_bf16 v[204:207], a[220:223], a[28:31], v[204:207]
    s_waitcnt lgkmcnt(8)
    v_and_b32 v242, s26, v242
    v_mul_f32 v252, s25, v252
    v_mul_f32 v242, s25, v242
    v_cvt_pk_bf16_f32 v242, v252, v242
    v_mfma_f32_16x16x32_bf16 v[0:3], v[208:211], v[160:163], v[0:3]
    v_exp_f32 v202, v202
    v_mfma_f32_16x16x32_bf16 v[32:35], v[208:211], v[164:167], v[32:35]
    v_lshlrev_b32 v253, 16, v243
    v_cvt_pk_bf16_f32 v180, v200, v201
    v_mfma_f32_16x16x32_bf16 v[64:67], v[208:211], v[168:171], v[64:67]
    v_exp_f32 v203, v203
    v_mfma_f32_16x16x32_bf16 v[96:99], v[208:211], v[172:175], v[96:99]
    v_cvt_pk_bf16_f32 v181, v202, v203
    v_and_b32 v243, s26, v243
    v_smfmac_f32_16x16x64_bf16 a[240:243], a[252:255], v[160:167], v233
    v_mul_f32 v253, s25, v253
    v_mul_f32 v243, s25, v243
    v_mfma_f32_16x16x32_bf16 v[200:203], a[120:123], a[32:35], 0
    v_exp_f32 v204, v204
    v_mfma_f32_16x16x32_bf16 v[200:203], a[212:215], a[36:39], v[200:203]
    v_cvt_pk_bf16_f32 v243, v253, v243
    v_mfma_f32_16x16x32_bf16 v[200:203], a[216:219], a[40:43], v[200:203]
    v_exp_f32 v205, v205
    v_mfma_f32_16x16x32_bf16 v[200:203], a[220:223], a[44:47], v[200:203]
    v_exp_f32 v206, v206
    v_mfma_f32_16x16x32_bf16 v[128:131], v[208:211], v[176:179], v[128:131]
    s_waitcnt lgkmcnt(3)
    v_exp_f32 v207, v207
    v_mfma_f32_16x16x32_bf16 v[4:7], v[212:215], v[160:163], v[4:7]
    ds_write_b64 v254, v[242:243] offset:16520
    v_mfma_f32_16x16x32_bf16 v[36:39], v[212:215], v[164:167], v[36:39]
    buffer_load_dwordx4 v[240:243], v234, s[12:15], s40 offen offset:2048 nt
    v_mfma_f32_16x16x32_bf16 v[68:71], v[212:215], v[168:171], v[68:71]
    ds_read_b64_tr_b16 v[220:221], v225 offset:16392
    v_cvt_pk_bf16_f32 v184, v204, v205
    v_cvt_pk_bf16_f32 v185, v206, v207
    v_mfma_f32_16x16x32_bf16 v[204:207], a[120:123], a[48:51], 0
    v_exp_f32 v200, v200
    v_mfma_f32_16x16x32_bf16 v[204:207], a[212:215], a[52:55], v[204:207]
    ds_read_b64_tr_b16 v[222:223], v225 offset:18440
    v_mfma_f32_16x16x32_bf16 v[204:207], a[216:219], a[56:59], v[204:207]
    v_exp_f32 v201, v201
    v_mfma_f32_16x16x32_bf16 v[204:207], a[220:223], a[60:63], v[204:207]
    v_exp_f32 v202, v202
    v_mfma_f32_16x16x32_bf16 v[100:103], v[212:215], v[172:175], v[100:103]
    v_exp_f32 v203, v203
    v_mfma_f32_16x16x32_bf16 v[132:135], v[212:215], v[176:179], v[132:135]
    s_waitcnt lgkmcnt(3)
    ds_read_b64_tr_b16 v[208:209], v224 offset:49152
    v_cvt_pk_bf16_f32 v188, v200, v201
    v_mfma_f32_16x16x32_bf16 v[8:11], v[216:219], v[160:163], v[8:11]
    ds_read_b64_tr_b16 v[210:211], v224 offset:51200
    v_cvt_pk_bf16_f32 v189, v202, v203
    v_mfma_f32_16x16x32_bf16 v[40:43], v[216:219], v[164:167], v[40:43]
    v_mfma_f32_16x16x32_bf16 v[200:203], a[120:123], a[64:67], 0
    v_exp_f32 v204, v204
    v_mfma_f32_16x16x32_bf16 v[200:203], a[212:215], a[68:71], v[200:203]
    v_exp_f32 v205, v205
    v_mfma_f32_16x16x32_bf16 v[200:203], a[216:219], a[72:75], v[200:203]
    v_exp_f32 v206, v206
    v_mfma_f32_16x16x32_bf16 v[200:203], a[220:223], a[76:79], v[200:203]
    s_waitcnt vmcnt(6) lgkmcnt(4)
    s_barrier
    ds_read_b128 a[128:131], v228 offset:16384
    v_cvt_pk_bf16_f32 v192, v204, v205
    v_mfma_f32_16x16x32_bf16 v[72:75], v[216:219], v[168:171], v[72:75]
    v_exp_f32 v207, v207
    v_mfma_f32_16x16x32_bf16 v[104:107], v[216:219], v[172:175], v[104:107]
    ds_read_b128 a[212:215], v229 offset:16384
    v_cvt_pk_bf16_f32 v193, v206, v207
    v_mfma_f32_16x16x32_bf16 v[136:139], v[216:219], v[176:179], v[136:139]
    s_waitcnt lgkmcnt(4)
    ds_read_b64_tr_b16 v[212:213], v224 offset:49160
    v_mfma_f32_16x16x32_bf16 v[12:15], v[220:223], v[160:163], v[12:15]
    ds_read_b64_tr_b16 v[214:215], v224 offset:51208
    v_mfma_f32_16x16x32_bf16 v[204:207], a[124:127], a[0:3], 0
    s_add_u32 s41, s41, 8192
    v_exp_f32 v200, v200
    v_mfma_f32_16x16x32_bf16 v[204:207], a[228:231], a[4:7], v[204:207]
    s_waitcnt vmcnt(5)
    s_add_u32 m0, s42, 28672
    ds_read_b128 a[216:219], v235 offset:16384
    v_lshlrev_b32 v252, 16, v244
    v_mfma_f32_16x16x32_bf16 v[204:207], a[232:235], a[8:11], v[204:207]
    v_exp_f32 v201, v201
    v_mfma_f32_16x16x32_bf16 v[204:207], a[236:239], a[12:15], v[204:207]
    buffer_load_dwordx4 v234, s[16:19], s41 offen offset:0 nt lds
    v_mfma_f32_16x16x32_bf16 v[44:47], v[220:223], v[164:167], v[44:47]
    s_add_u32 m0, s42, 61312
    v_exp_f32 v202, v202
    v_mfma_f32_16x16x32_bf16 v[76:79], v[220:223], v[168:171], v[76:79]
    ds_read_b128 a[220:223], v231 offset:16384
    v_and_b32 v244, s26, v244
    v_mul_f32 v252, s25, v252
    v_mul_f32 v244, s25, v244
    v_cvt_pk_bf16_f32 v244, v252, v244
    v_mfma_f32_16x16x32_bf16 v[108:111], v[220:223], v[172:175], v[108:111]
    v_exp_f32 v203, v203
    v_mfma_f32_16x16x32_bf16 v[140:143], v[220:223], v[176:179], v[140:143]
    ds_read_b64_tr_b16 v[216:217], v225 offset:49152
    v_cvt_pk_bf16_f32 v196, v200, v201
    v_cvt_pk_bf16_f32 v197, v202, v203
    v_mfma_f32_16x16x32_bf16 v[200:203], a[124:127], a[16:19], 0
    v_exp_f32 v204, v204
    v_mfma_f32_16x16x32_bf16 v[200:203], a[228:231], a[20:23], v[200:203]
    buffer_load_dwordx4 v234, s[16:19], s41 offen offset:128 nt lds
    v_mfma_f32_16x16x32_bf16 v[200:203], a[232:235], a[24:27], v[200:203]
    v_exp_f32 v205, v205
    v_mfma_f32_16x16x32_bf16 v[200:203], a[236:239], a[28:31], v[200:203]
    s_waitcnt lgkmcnt(7)
    ds_read_b64_tr_b16 v[218:219], v225 offset:51200
    v_lshlrev_b32 v253, 16, v245
    v_mfma_f32_16x16x32_bf16 v[16:19], v[208:211], v[160:163], v[16:19]
    v_exp_f32 v206, v206
    v_mfma_f32_16x16x32_bf16 v[48:51], v[208:211], v[164:167], v[48:51]
    ds_read_b128 a[132:135], v228 offset:20480
    v_and_b32 v245, s26, v245
    v_mul_f32 v253, s25, v253
    v_mul_f32 v245, s25, v245
    v_cvt_pk_bf16_f32 v245, v253, v245
    v_mfma_f32_16x16x32_bf16 v[80:83], v[208:211], v[168:171], v[80:83]
    v_exp_f32 v207, v207
    v_mfma_f32_16x16x32_bf16 v[112:115], v[208:211], v[172:175], v[112:115]
    v_cvt_pk_bf16_f32 v182, v204, v205
    v_cvt_pk_bf16_f32 v183, v206, v207
    v_smfmac_f32_16x16x64_bf16 a[244:247], a[252:255], v[168:175], v233
    ds_write_b64 v254, v[244:245] offset:24576
    v_mfma_f32_16x16x32_bf16 v[204:207], a[124:127], a[32:35], 0
    v_exp_f32 v200, v200
    v_mfma_f32_16x16x32_bf16 v[204:207], a[228:231], a[36:39], v[204:207]
    v_lshlrev_b32 v252, 16, v246
    v_and_b32 v246, s26, v246
    v_mfma_f32_16x16x32_bf16 v[204:207], a[232:235], a[40:43], v[204:207]
    v_exp_f32 v201, v201
    v_mfma_f32_16x16x32_bf16 v[204:207], a[236:239], a[44:47], v[204:207]
    v_mul_f32 v252, s25, v252
    v_mul_f32 v246, s25, v246
    v_mfma_f32_16x16x32_bf16 v[144:147], v[208:211], v[176:179], v[144:147]
    s_waitcnt lgkmcnt(6)
    v_exp_f32 v202, v202
    v_cvt_pk_bf16_f32 v246, v252, v246
    v_mfma_f32_16x16x32_bf16 v[20:23], v[212:215], v[160:163], v[20:23]
    ds_read_b64_tr_b16 v[220:221], v225 offset:49160
    v_cvt_pk_bf16_f32 v186, v200, v201
    v_mfma_f32_16x16x32_bf16 v[52:55], v[212:215], v[164:167], v[52:55]
    v_exp_f32 v203, v203
    v_mfma_f32_16x16x32_bf16 v[84:87], v[212:215], v[168:171], v[84:87]
    ds_read_b64_tr_b16 v[222:223], v225 offset:51208
    v_cvt_pk_bf16_f32 v187, v202, v203
    v_mfma_f32_16x16x32_bf16 v[200:203], a[124:127], a[48:51], 0
    v_exp_f32 v204, v204
    v_mfma_f32_16x16x32_bf16 v[200:203], a[228:231], a[52:55], v[200:203]
    v_lshlrev_b32 v253, 16, v247
    v_and_b32 v247, s26, v247
    v_mfma_f32_16x16x32_bf16 v[200:203], a[232:235], a[56:59], v[200:203]
    v_exp_f32 v205, v205
    v_mfma_f32_16x16x32_bf16 v[200:203], a[236:239], a[60:63], v[200:203]
    v_mul_f32 v253, s25, v253
    v_mul_f32 v247, s25, v247
    v_mfma_f32_16x16x32_bf16 v[116:119], v[212:215], v[172:175], v[116:119]
    v_exp_f32 v206, v206
    v_cvt_pk_bf16_f32 v247, v253, v247
    v_mfma_f32_16x16x32_bf16 v[148:151], v[212:215], v[176:179], v[148:151]
    s_waitcnt lgkmcnt(4)
    ds_read_b64_tr_b16 v[208:209], v224 offset:20480
    v_cvt_pk_bf16_f32 v190, v204, v205
    v_mfma_f32_16x16x32_bf16 v[24:27], v[216:219], v[160:163], v[24:27]
    v_exp_f32 v207, v207
    v_mfma_f32_16x16x32_bf16 v[56:59], v[216:219], v[164:167], v[56:59]
    ds_write_b64 v254, v[246:247] offset:24584
    v_smfmac_f32_16x16x64_bf16 a[248:251], a[252:255], v[172:179], v233
    ds_read_b64_tr_b16 v[210:211], v224 offset:22528
    v_cvt_pk_bf16_f32 v191, v206, v207
    v_mfma_f32_16x16x32_bf16 v[204:207], a[124:127], a[64:67], 0
    v_exp_f32 v200, v200
    v_mfma_f32_16x16x32_bf16 v[204:207], a[228:231], a[68:71], v[204:207]
    s_waitcnt vmcnt(6)
    ds_read_b128 a[228:231], v229 offset:20480
    v_lshlrev_b32 v252, 16, v248
    v_mfma_f32_16x16x32_bf16 v[204:207], a[232:235], a[72:75], v[204:207]
    v_exp_f32 v201, v201
    v_mfma_f32_16x16x32_bf16 v[204:207], a[236:239], a[76:79], v[204:207]
    ds_read_b128 a[232:235], v235 offset:20480
    v_and_b32 v248, s26, v248
    v_mul_f32 v252, s25, v252
    v_mul_f32 v248, s25, v248
    v_cvt_pk_bf16_f32 v248, v252, v248
    v_mfma_f32_16x16x32_bf16 v[88:91], v[216:219], v[168:171], v[88:91]
    v_exp_f32 v202, v202
    v_mfma_f32_16x16x32_bf16 v[120:123], v[216:219], v[172:175], v[120:123]
    ds_read_b128 a[236:239], v231 offset:20480
    v_cvt_pk_bf16_f32 v194, v200, v201
    v_mfma_f32_16x16x32_bf16 v[152:155], v[216:219], v[176:179], v[152:155]
    s_waitcnt lgkmcnt(6)
    v_exp_f32 v203, v203
    v_mfma_f32_16x16x32_bf16 v[28:31], v[220:223], v[160:163], v[28:31]
    ds_read_b64_tr_b16 v[212:213], v224 offset:20488
    v_cvt_pk_bf16_f32 v195, v202, v203
    v_mfma_f32_16x16x32_bf16 v[200:203], a[128:131], a[0:3], 0
    s_add_u32 s40, s40, 8192
    v_exp_f32 v204, v204
    v_mfma_f32_16x16x32_bf16 v[200:203], a[212:215], a[4:7], v[200:203]
    buffer_load_dwordx4 v[244:247], v234, s[12:15], s40 offen offset:0 nt
    v_mfma_f32_16x16x32_bf16 v[200:203], a[216:219], a[8:11], v[200:203]
    v_exp_f32 v205, v205
    v_mfma_f32_16x16x32_bf16 v[200:203], a[220:223], a[12:15], v[200:203]
    ds_read_b64_tr_b16 v[214:215], v224 offset:22536
    v_lshlrev_b32 v253, 16, v249
    v_and_b32 v249, s26, v249
    v_mul_f32 v253, s25, v253
    v_mul_f32 v249, s25, v249
    v_cvt_pk_bf16_f32 v249, v253, v249
    v_mfma_f32_16x16x32_bf16 v[60:63], v[220:223], v[164:167], v[60:63]
    v_exp_f32 v206, v206
    v_mfma_f32_16x16x32_bf16 v[92:95], v[220:223], v[168:171], v[92:95]
    v_exp_f32 v207, v207
    v_mfma_f32_16x16x32_bf16 v[124:127], v[220:223], v[172:175], v[124:127]
    ds_write_b64 v254, v[248:249] offset:24704
    v_mfma_f32_16x16x32_bf16 v[156:159], v[220:223], v[176:179], v[156:159]
    ds_read_b64_tr_b16 v[216:217], v225 offset:20480
    v_cvt_pk_bf16_f32 v198, v204, v205
    v_cvt_pk_bf16_f32 v199, v206, v207
    v_mfma_f32_16x16x32_bf16 v[204:207], a[128:131], a[16:19], 0
    v_exp_f32 v200, v200
    v_mfma_f32_16x16x32_bf16 v[204:207], a[212:215], a[20:23], v[204:207]
    ds_read_b64_tr_b16 v[218:219], v225 offset:22528
    v_lshlrev_b32 v252, 16, v250
    v_mfma_f32_16x16x32_bf16 v[204:207], a[216:219], a[24:27], v[204:207]
    v_exp_f32 v201, v201
    v_mfma_f32_16x16x32_bf16 v[204:207], a[220:223], a[28:31], v[204:207]
    s_waitcnt lgkmcnt(8)
    v_and_b32 v250, s26, v250
    v_mul_f32 v252, s25, v252
    v_mul_f32 v250, s25, v250
    v_cvt_pk_bf16_f32 v250, v252, v250
    v_mfma_f32_16x16x32_bf16 v[0:3], v[208:211], v[180:183], v[0:3]
    v_exp_f32 v202, v202
    v_mfma_f32_16x16x32_bf16 v[32:35], v[208:211], v[184:187], v[32:35]
    v_lshlrev_b32 v253, 16, v251
    v_cvt_pk_bf16_f32 v160, v200, v201
    v_mfma_f32_16x16x32_bf16 v[64:67], v[208:211], v[188:191], v[64:67]
    v_exp_f32 v203, v203
    v_mfma_f32_16x16x32_bf16 v[96:99], v[208:211], v[192:195], v[96:99]
    v_cvt_pk_bf16_f32 v161, v202, v203
    v_and_b32 v251, s26, v251
    v_smfmac_f32_16x16x64_bf16 a[240:243], a[252:255], v[180:187], v233
    v_mul_f32 v253, s25, v253
    v_mul_f32 v251, s25, v251
    v_mfma_f32_16x16x32_bf16 v[200:203], a[128:131], a[32:35], 0
    v_exp_f32 v204, v204
    v_mfma_f32_16x16x32_bf16 v[200:203], a[212:215], a[36:39], v[200:203]
    v_cvt_pk_bf16_f32 v251, v253, v251
    v_mfma_f32_16x16x32_bf16 v[200:203], a[216:219], a[40:43], v[200:203]
    v_exp_f32 v205, v205
    v_mfma_f32_16x16x32_bf16 v[200:203], a[220:223], a[44:47], v[200:203]
    v_exp_f32 v206, v206
    v_mfma_f32_16x16x32_bf16 v[128:131], v[208:211], v[196:199], v[128:131]
    s_waitcnt lgkmcnt(3)
    v_exp_f32 v207, v207
    v_mfma_f32_16x16x32_bf16 v[4:7], v[212:215], v[180:183], v[4:7]
    ds_write_b64 v254, v[250:251] offset:24712
    v_mfma_f32_16x16x32_bf16 v[36:39], v[212:215], v[184:187], v[36:39]
    buffer_load_dwordx4 v[248:251], v234, s[12:15], s40 offen offset:2048 nt
    v_mfma_f32_16x16x32_bf16 v[68:71], v[212:215], v[188:191], v[68:71]
    ds_read_b64_tr_b16 v[220:221], v225 offset:20488
    v_cvt_pk_bf16_f32 v164, v204, v205
    v_cvt_pk_bf16_f32 v165, v206, v207
    v_mfma_f32_16x16x32_bf16 v[204:207], a[128:131], a[48:51], 0
    v_exp_f32 v200, v200
    v_mfma_f32_16x16x32_bf16 v[204:207], a[212:215], a[52:55], v[204:207]
    ds_read_b64_tr_b16 v[222:223], v225 offset:22536
    v_mfma_f32_16x16x32_bf16 v[204:207], a[216:219], a[56:59], v[204:207]
    v_exp_f32 v201, v201
    v_mfma_f32_16x16x32_bf16 v[204:207], a[220:223], a[60:63], v[204:207]
    v_exp_f32 v202, v202
    v_mfma_f32_16x16x32_bf16 v[100:103], v[212:215], v[192:195], v[100:103]
    v_exp_f32 v203, v203
    v_mfma_f32_16x16x32_bf16 v[132:135], v[212:215], v[196:199], v[132:135]
    s_waitcnt lgkmcnt(3)
    ds_read_b64_tr_b16 v[208:209], v224 offset:53248
    v_cvt_pk_bf16_f32 v168, v200, v201
    v_mfma_f32_16x16x32_bf16 v[8:11], v[216:219], v[180:183], v[8:11]
    ds_read_b64_tr_b16 v[210:211], v224 offset:55296
    v_cvt_pk_bf16_f32 v169, v202, v203
    v_mfma_f32_16x16x32_bf16 v[40:43], v[216:219], v[184:187], v[40:43]
    v_mfma_f32_16x16x32_bf16 v[200:203], a[128:131], a[64:67], 0
    v_exp_f32 v204, v204
    v_mfma_f32_16x16x32_bf16 v[200:203], a[212:215], a[68:71], v[200:203]
    v_exp_f32 v205, v205
    v_mfma_f32_16x16x32_bf16 v[200:203], a[216:219], a[72:75], v[200:203]
    v_exp_f32 v206, v206
    v_mfma_f32_16x16x32_bf16 v[200:203], a[220:223], a[76:79], v[200:203]
    s_waitcnt vmcnt(6) lgkmcnt(4)
    s_barrier
    ds_read_b128 a[136:139], v228 offset:24576
    v_cvt_pk_bf16_f32 v172, v204, v205
    v_mfma_f32_16x16x32_bf16 v[72:75], v[216:219], v[188:191], v[72:75]
    v_exp_f32 v207, v207
    v_mfma_f32_16x16x32_bf16 v[104:107], v[216:219], v[192:195], v[104:107]
    ds_read_b128 a[212:215], v229 offset:24576
    v_cvt_pk_bf16_f32 v173, v206, v207
    v_mfma_f32_16x16x32_bf16 v[136:139], v[216:219], v[196:199], v[136:139]
    s_waitcnt lgkmcnt(4)
    ds_read_b64_tr_b16 v[212:213], v224 offset:53256
    v_mfma_f32_16x16x32_bf16 v[12:15], v[220:223], v[180:183], v[12:15]
    ds_read_b64_tr_b16 v[214:215], v224 offset:55304
    v_mfma_f32_16x16x32_bf16 v[204:207], a[132:135], a[0:3], 0
    s_add_u32 s41, s41, 8192
    v_exp_f32 v200, v200
    v_mfma_f32_16x16x32_bf16 v[204:207], a[228:231], a[4:7], v[204:207]
    s_waitcnt vmcnt(5)
    s_add_u32 m0, s42, 65536
    ds_read_b128 a[216:219], v235 offset:24576
    v_lshlrev_b32 v252, 16, v236
    v_mfma_f32_16x16x32_bf16 v[204:207], a[232:235], a[8:11], v[204:207]
    v_exp_f32 v201, v201
    v_mfma_f32_16x16x32_bf16 v[204:207], a[236:239], a[12:15], v[204:207]
    buffer_load_dwordx4 v234, s[16:19], s41 offen offset:0 nt lds
    v_mfma_f32_16x16x32_bf16 v[44:47], v[220:223], v[184:187], v[44:47]
    s_add_u32 m0, s42, 98176
    v_exp_f32 v202, v202
    v_mfma_f32_16x16x32_bf16 v[76:79], v[220:223], v[188:191], v[76:79]
    ds_read_b128 a[220:223], v231 offset:24576
    v_and_b32 v236, s26, v236
    v_mul_f32 v252, s25, v252
    v_mul_f32 v236, s25, v236
    v_cvt_pk_bf16_f32 v236, v252, v236
    v_mfma_f32_16x16x32_bf16 v[108:111], v[220:223], v[192:195], v[108:111]
    v_exp_f32 v203, v203
    v_mfma_f32_16x16x32_bf16 v[140:143], v[220:223], v[196:199], v[140:143]
    ds_read_b64_tr_b16 v[216:217], v225 offset:53248
    v_cvt_pk_bf16_f32 v176, v200, v201
    v_cvt_pk_bf16_f32 v177, v202, v203
    v_mfma_f32_16x16x32_bf16 v[200:203], a[132:135], a[16:19], 0
    v_exp_f32 v204, v204
    v_mfma_f32_16x16x32_bf16 v[200:203], a[228:231], a[20:23], v[200:203]
    buffer_load_dwordx4 v234, s[16:19], s41 offen offset:128 nt lds
    v_mfma_f32_16x16x32_bf16 v[200:203], a[232:235], a[24:27], v[200:203]
    v_exp_f32 v205, v205
    v_mfma_f32_16x16x32_bf16 v[200:203], a[236:239], a[28:31], v[200:203]
    s_waitcnt lgkmcnt(7)
    ds_read_b64_tr_b16 v[218:219], v225 offset:55296
    v_lshlrev_b32 v253, 16, v237
    v_mfma_f32_16x16x32_bf16 v[16:19], v[208:211], v[180:183], v[16:19]
    v_exp_f32 v206, v206
    v_mfma_f32_16x16x32_bf16 v[48:51], v[208:211], v[184:187], v[48:51]
    ds_read_b128 a[140:143], v228 offset:28672
    v_and_b32 v237, s26, v237
    v_mul_f32 v253, s25, v253
    v_mul_f32 v237, s25, v237
    v_cvt_pk_bf16_f32 v237, v253, v237
    v_mfma_f32_16x16x32_bf16 v[80:83], v[208:211], v[188:191], v[80:83]
    v_exp_f32 v207, v207
    v_mfma_f32_16x16x32_bf16 v[112:115], v[208:211], v[192:195], v[112:115]
    v_cvt_pk_bf16_f32 v162, v204, v205
    v_cvt_pk_bf16_f32 v163, v206, v207
    v_smfmac_f32_16x16x64_bf16 a[244:247], a[252:255], v[188:195], v233
    ds_write_b64 v254, v[236:237] offset:0
    v_mfma_f32_16x16x32_bf16 v[204:207], a[132:135], a[32:35], 0
    v_exp_f32 v200, v200
    v_mfma_f32_16x16x32_bf16 v[204:207], a[228:231], a[36:39], v[204:207]
    v_lshlrev_b32 v252, 16, v238
    v_and_b32 v238, s26, v238
    v_mfma_f32_16x16x32_bf16 v[204:207], a[232:235], a[40:43], v[204:207]
    v_exp_f32 v201, v201
    v_mfma_f32_16x16x32_bf16 v[204:207], a[236:239], a[44:47], v[204:207]
    v_mul_f32 v252, s25, v252
    v_mul_f32 v238, s25, v238
    v_mfma_f32_16x16x32_bf16 v[144:147], v[208:211], v[196:199], v[144:147]
    s_waitcnt lgkmcnt(6)
    v_exp_f32 v202, v202
    v_cvt_pk_bf16_f32 v238, v252, v238
    v_mfma_f32_16x16x32_bf16 v[20:23], v[212:215], v[180:183], v[20:23]
    ds_read_b64_tr_b16 v[220:221], v225 offset:53256
    v_cvt_pk_bf16_f32 v166, v200, v201
    v_mfma_f32_16x16x32_bf16 v[52:55], v[212:215], v[184:187], v[52:55]
    v_exp_f32 v203, v203
    v_mfma_f32_16x16x32_bf16 v[84:87], v[212:215], v[188:191], v[84:87]
    ds_read_b64_tr_b16 v[222:223], v225 offset:55304
    v_cvt_pk_bf16_f32 v167, v202, v203
    v_mfma_f32_16x16x32_bf16 v[200:203], a[132:135], a[48:51], 0
    v_exp_f32 v204, v204
    v_mfma_f32_16x16x32_bf16 v[200:203], a[228:231], a[52:55], v[200:203]
    v_lshlrev_b32 v253, 16, v239
    v_and_b32 v239, s26, v239
    v_mfma_f32_16x16x32_bf16 v[200:203], a[232:235], a[56:59], v[200:203]
    v_exp_f32 v205, v205
    v_mfma_f32_16x16x32_bf16 v[200:203], a[236:239], a[60:63], v[200:203]
    v_mul_f32 v253, s25, v253
    v_mul_f32 v239, s25, v239
    v_mfma_f32_16x16x32_bf16 v[116:119], v[212:215], v[192:195], v[116:119]
    v_exp_f32 v206, v206
    v_cvt_pk_bf16_f32 v239, v253, v239
    v_mfma_f32_16x16x32_bf16 v[148:151], v[212:215], v[196:199], v[148:151]
    s_waitcnt lgkmcnt(4)
    ds_read_b64_tr_b16 v[208:209], v224 offset:24576
    v_cvt_pk_bf16_f32 v170, v204, v205
    v_mfma_f32_16x16x32_bf16 v[24:27], v[216:219], v[180:183], v[24:27]
    v_exp_f32 v207, v207
    v_mfma_f32_16x16x32_bf16 v[56:59], v[216:219], v[184:187], v[56:59]
    ds_write_b64 v254, v[238:239] offset:8
    v_smfmac_f32_16x16x64_bf16 a[248:251], a[252:255], v[192:199], v233
    ds_read_b64_tr_b16 v[210:211], v224 offset:26624
    v_cvt_pk_bf16_f32 v171, v206, v207
    v_mfma_f32_16x16x32_bf16 v[204:207], a[132:135], a[64:67], 0
    v_exp_f32 v200, v200
    v_mfma_f32_16x16x32_bf16 v[204:207], a[228:231], a[68:71], v[204:207]
    s_waitcnt vmcnt(6)
    ds_read_b128 a[228:231], v229 offset:28672
    v_lshlrev_b32 v252, 16, v240
    v_mfma_f32_16x16x32_bf16 v[204:207], a[232:235], a[72:75], v[204:207]
    v_exp_f32 v201, v201
    v_mfma_f32_16x16x32_bf16 v[204:207], a[236:239], a[76:79], v[204:207]
    ds_read_b128 a[232:235], v235 offset:28672
    v_and_b32 v240, s26, v240
    v_mul_f32 v252, s25, v252
    v_mul_f32 v240, s25, v240
    v_cvt_pk_bf16_f32 v240, v252, v240
    v_mfma_f32_16x16x32_bf16 v[88:91], v[216:219], v[188:191], v[88:91]
    v_exp_f32 v202, v202
    v_mfma_f32_16x16x32_bf16 v[120:123], v[216:219], v[192:195], v[120:123]
    ds_read_b128 a[236:239], v231 offset:28672
    v_cvt_pk_bf16_f32 v174, v200, v201
    v_mfma_f32_16x16x32_bf16 v[152:155], v[216:219], v[196:199], v[152:155]
    s_waitcnt lgkmcnt(6)
    v_exp_f32 v203, v203
    v_mfma_f32_16x16x32_bf16 v[28:31], v[220:223], v[180:183], v[28:31]
    ds_read_b64_tr_b16 v[212:213], v224 offset:24584
    v_cvt_pk_bf16_f32 v175, v202, v203
    v_mfma_f32_16x16x32_bf16 v[200:203], a[136:139], a[0:3], 0
    s_add_u32 s40, s40, 8192
    v_exp_f32 v204, v204
    v_mfma_f32_16x16x32_bf16 v[200:203], a[212:215], a[4:7], v[200:203]
    buffer_load_dwordx4 v[236:239], v234, s[12:15], s40 offen offset:0 nt
    v_mfma_f32_16x16x32_bf16 v[200:203], a[216:219], a[8:11], v[200:203]
    v_exp_f32 v205, v205
    v_mfma_f32_16x16x32_bf16 v[200:203], a[220:223], a[12:15], v[200:203]
    ds_read_b64_tr_b16 v[214:215], v224 offset:26632
    v_lshlrev_b32 v253, 16, v241
    v_and_b32 v241, s26, v241
    v_mul_f32 v253, s25, v253
    v_mul_f32 v241, s25, v241
    v_cvt_pk_bf16_f32 v241, v253, v241
    v_mfma_f32_16x16x32_bf16 v[60:63], v[220:223], v[184:187], v[60:63]
    v_exp_f32 v206, v206
    v_mfma_f32_16x16x32_bf16 v[92:95], v[220:223], v[188:191], v[92:95]
    v_exp_f32 v207, v207
    v_mfma_f32_16x16x32_bf16 v[124:127], v[220:223], v[192:195], v[124:127]
    ds_write_b64 v254, v[240:241] offset:128
    v_mfma_f32_16x16x32_bf16 v[156:159], v[220:223], v[196:199], v[156:159]
    ds_read_b64_tr_b16 v[216:217], v225 offset:24576
    v_cvt_pk_bf16_f32 v178, v204, v205
    v_cvt_pk_bf16_f32 v179, v206, v207
    v_mfma_f32_16x16x32_bf16 v[204:207], a[136:139], a[16:19], 0
    v_exp_f32 v200, v200
    v_mfma_f32_16x16x32_bf16 v[204:207], a[212:215], a[20:23], v[204:207]
    ds_read_b64_tr_b16 v[218:219], v225 offset:26624
    v_lshlrev_b32 v252, 16, v242
    v_mfma_f32_16x16x32_bf16 v[204:207], a[216:219], a[24:27], v[204:207]
    v_exp_f32 v201, v201
    v_mfma_f32_16x16x32_bf16 v[204:207], a[220:223], a[28:31], v[204:207]
    s_waitcnt lgkmcnt(8)
    v_and_b32 v242, s26, v242
    v_mul_f32 v252, s25, v252
    v_mul_f32 v242, s25, v242
    v_cvt_pk_bf16_f32 v242, v252, v242
    v_mfma_f32_16x16x32_bf16 v[0:3], v[208:211], v[160:163], v[0:3]
    v_exp_f32 v202, v202
    v_mfma_f32_16x16x32_bf16 v[32:35], v[208:211], v[164:167], v[32:35]
    v_lshlrev_b32 v253, 16, v243
    v_cvt_pk_bf16_f32 v180, v200, v201
    v_mfma_f32_16x16x32_bf16 v[64:67], v[208:211], v[168:171], v[64:67]
    v_exp_f32 v203, v203
    v_mfma_f32_16x16x32_bf16 v[96:99], v[208:211], v[172:175], v[96:99]
    v_cvt_pk_bf16_f32 v181, v202, v203
    v_and_b32 v243, s26, v243
    v_smfmac_f32_16x16x64_bf16 a[240:243], a[252:255], v[160:167], v233
    v_mul_f32 v253, s25, v253
    v_mul_f32 v243, s25, v243
    v_mfma_f32_16x16x32_bf16 v[200:203], a[136:139], a[32:35], 0
    v_exp_f32 v204, v204
    v_mfma_f32_16x16x32_bf16 v[200:203], a[212:215], a[36:39], v[200:203]
    v_cvt_pk_bf16_f32 v243, v253, v243
    v_mfma_f32_16x16x32_bf16 v[200:203], a[216:219], a[40:43], v[200:203]
    v_exp_f32 v205, v205
    v_mfma_f32_16x16x32_bf16 v[200:203], a[220:223], a[44:47], v[200:203]
    v_exp_f32 v206, v206
    v_mfma_f32_16x16x32_bf16 v[128:131], v[208:211], v[176:179], v[128:131]
    s_waitcnt lgkmcnt(3)
    v_exp_f32 v207, v207
    v_mfma_f32_16x16x32_bf16 v[4:7], v[212:215], v[160:163], v[4:7]
    ds_write_b64 v254, v[242:243] offset:136
    v_mfma_f32_16x16x32_bf16 v[36:39], v[212:215], v[164:167], v[36:39]
    buffer_load_dwordx4 v[240:243], v234, s[12:15], s40 offen offset:2048 nt
    v_mfma_f32_16x16x32_bf16 v[68:71], v[212:215], v[168:171], v[68:71]
    ds_read_b64_tr_b16 v[220:221], v225 offset:24584
    v_cvt_pk_bf16_f32 v184, v204, v205
    v_cvt_pk_bf16_f32 v185, v206, v207
    v_mfma_f32_16x16x32_bf16 v[204:207], a[136:139], a[48:51], 0
    v_exp_f32 v200, v200
    v_mfma_f32_16x16x32_bf16 v[204:207], a[212:215], a[52:55], v[204:207]
    ds_read_b64_tr_b16 v[222:223], v225 offset:26632
    v_mfma_f32_16x16x32_bf16 v[204:207], a[216:219], a[56:59], v[204:207]
    v_exp_f32 v201, v201
    v_mfma_f32_16x16x32_bf16 v[204:207], a[220:223], a[60:63], v[204:207]
    v_exp_f32 v202, v202
    v_mfma_f32_16x16x32_bf16 v[100:103], v[212:215], v[172:175], v[100:103]
    v_exp_f32 v203, v203
    v_mfma_f32_16x16x32_bf16 v[132:135], v[212:215], v[176:179], v[132:135]
    s_waitcnt lgkmcnt(3)
    ds_read_b64_tr_b16 v[208:209], v224 offset:57344
    v_cvt_pk_bf16_f32 v188, v200, v201
    v_mfma_f32_16x16x32_bf16 v[8:11], v[216:219], v[160:163], v[8:11]
    ds_read_b64_tr_b16 v[210:211], v224 offset:59392
    v_cvt_pk_bf16_f32 v189, v202, v203
    v_mfma_f32_16x16x32_bf16 v[40:43], v[216:219], v[164:167], v[40:43]
    v_mfma_f32_16x16x32_bf16 v[200:203], a[136:139], a[64:67], 0
    v_exp_f32 v204, v204
    v_mfma_f32_16x16x32_bf16 v[200:203], a[212:215], a[68:71], v[200:203]
    v_exp_f32 v205, v205
    v_mfma_f32_16x16x32_bf16 v[200:203], a[216:219], a[72:75], v[200:203]
    v_exp_f32 v206, v206
    v_mfma_f32_16x16x32_bf16 v[200:203], a[220:223], a[76:79], v[200:203]
    s_waitcnt vmcnt(6) lgkmcnt(4)
    s_barrier
    ds_read_b128 a[144:147], v228 offset:0
    v_cvt_pk_bf16_f32 v192, v204, v205
    v_mfma_f32_16x16x32_bf16 v[72:75], v[216:219], v[168:171], v[72:75]
    v_exp_f32 v207, v207
    v_mfma_f32_16x16x32_bf16 v[104:107], v[216:219], v[172:175], v[104:107]
    ds_read_b128 a[212:215], v229 offset:0
    v_cvt_pk_bf16_f32 v193, v206, v207
    v_mfma_f32_16x16x32_bf16 v[136:139], v[216:219], v[176:179], v[136:139]
    s_waitcnt lgkmcnt(4)
    ds_read_b64_tr_b16 v[212:213], v224 offset:57352
    v_mfma_f32_16x16x32_bf16 v[12:15], v[220:223], v[160:163], v[12:15]
    ds_read_b64_tr_b16 v[214:215], v224 offset:59400
    v_mfma_f32_16x16x32_bf16 v[204:207], a[140:143], a[0:3], 0
    s_add_u32 s41, s41, 8192
    v_exp_f32 v200, v200
    v_mfma_f32_16x16x32_bf16 v[204:207], a[228:231], a[4:7], v[204:207]
    s_waitcnt vmcnt(5)
    s_add_u32 m0, s42, 69632
    ds_read_b128 a[216:219], v235 offset:0
    v_lshlrev_b32 v252, 16, v244
    v_mfma_f32_16x16x32_bf16 v[204:207], a[232:235], a[8:11], v[204:207]
    v_exp_f32 v201, v201
    v_mfma_f32_16x16x32_bf16 v[204:207], a[236:239], a[12:15], v[204:207]
    buffer_load_dwordx4 v234, s[16:19], s41 offen offset:0 nt lds
    v_mfma_f32_16x16x32_bf16 v[44:47], v[220:223], v[164:167], v[44:47]
    s_add_u32 m0, s42, 102272
    v_exp_f32 v202, v202
    v_mfma_f32_16x16x32_bf16 v[76:79], v[220:223], v[168:171], v[76:79]
    ds_read_b128 a[220:223], v231 offset:0
    v_and_b32 v244, s26, v244
    v_mul_f32 v252, s25, v252
    v_mul_f32 v244, s25, v244
    v_cvt_pk_bf16_f32 v244, v252, v244
    v_mfma_f32_16x16x32_bf16 v[108:111], v[220:223], v[172:175], v[108:111]
    v_exp_f32 v203, v203
    v_mfma_f32_16x16x32_bf16 v[140:143], v[220:223], v[176:179], v[140:143]
    ds_read_b64_tr_b16 v[216:217], v225 offset:57344
    v_cvt_pk_bf16_f32 v196, v200, v201
    v_cvt_pk_bf16_f32 v197, v202, v203
    v_mfma_f32_16x16x32_bf16 v[200:203], a[140:143], a[16:19], 0
    v_exp_f32 v204, v204
    v_mfma_f32_16x16x32_bf16 v[200:203], a[228:231], a[20:23], v[200:203]
    buffer_load_dwordx4 v234, s[16:19], s41 offen offset:128 nt lds
    v_mfma_f32_16x16x32_bf16 v[200:203], a[232:235], a[24:27], v[200:203]
    v_exp_f32 v205, v205
    v_mfma_f32_16x16x32_bf16 v[200:203], a[236:239], a[28:31], v[200:203]
    s_waitcnt lgkmcnt(7)
    ds_read_b64_tr_b16 v[218:219], v225 offset:59392
    v_lshlrev_b32 v253, 16, v245
    v_mfma_f32_16x16x32_bf16 v[16:19], v[208:211], v[160:163], v[16:19]
    v_exp_f32 v206, v206
    v_mfma_f32_16x16x32_bf16 v[48:51], v[208:211], v[164:167], v[48:51]
    ds_read_b128 a[148:151], v228 offset:4096
    v_and_b32 v245, s26, v245
    v_mul_f32 v253, s25, v253
    v_mul_f32 v245, s25, v245
    v_cvt_pk_bf16_f32 v245, v253, v245
    v_mfma_f32_16x16x32_bf16 v[80:83], v[208:211], v[168:171], v[80:83]
    v_exp_f32 v207, v207
    v_mfma_f32_16x16x32_bf16 v[112:115], v[208:211], v[172:175], v[112:115]
    v_cvt_pk_bf16_f32 v182, v204, v205
    v_cvt_pk_bf16_f32 v183, v206, v207
    v_smfmac_f32_16x16x64_bf16 a[244:247], a[252:255], v[168:175], v233
    ds_write_b64 v254, v[244:245] offset:8192
    v_mfma_f32_16x16x32_bf16 v[204:207], a[140:143], a[32:35], 0
    v_exp_f32 v200, v200
    v_mfma_f32_16x16x32_bf16 v[204:207], a[228:231], a[36:39], v[204:207]
    v_lshlrev_b32 v252, 16, v246
    v_and_b32 v246, s26, v246
    v_mfma_f32_16x16x32_bf16 v[204:207], a[232:235], a[40:43], v[204:207]
    v_exp_f32 v201, v201
    v_mfma_f32_16x16x32_bf16 v[204:207], a[236:239], a[44:47], v[204:207]
    v_mul_f32 v252, s25, v252
    v_mul_f32 v246, s25, v246
    v_mfma_f32_16x16x32_bf16 v[144:147], v[208:211], v[176:179], v[144:147]
    s_waitcnt lgkmcnt(6)
    v_exp_f32 v202, v202
    v_cvt_pk_bf16_f32 v246, v252, v246
    v_mfma_f32_16x16x32_bf16 v[20:23], v[212:215], v[160:163], v[20:23]
    ds_read_b64_tr_b16 v[220:221], v225 offset:57352
    v_cvt_pk_bf16_f32 v186, v200, v201
    v_mfma_f32_16x16x32_bf16 v[52:55], v[212:215], v[164:167], v[52:55]
    v_exp_f32 v203, v203
    v_mfma_f32_16x16x32_bf16 v[84:87], v[212:215], v[168:171], v[84:87]
    ds_read_b64_tr_b16 v[222:223], v225 offset:59400
    v_cvt_pk_bf16_f32 v187, v202, v203
    v_mfma_f32_16x16x32_bf16 v[200:203], a[140:143], a[48:51], 0
    v_exp_f32 v204, v204
    v_mfma_f32_16x16x32_bf16 v[200:203], a[228:231], a[52:55], v[200:203]
    v_lshlrev_b32 v253, 16, v247
    v_and_b32 v247, s26, v247
    v_mfma_f32_16x16x32_bf16 v[200:203], a[232:235], a[56:59], v[200:203]
    v_exp_f32 v205, v205
    v_mfma_f32_16x16x32_bf16 v[200:203], a[236:239], a[60:63], v[200:203]
L_pad2:
    s_cbranch_vccnz L_pad6
    v_mul_f32 v253, s25, v253
    v_mul_f32 v247, s25, v247
    v_mfma_f32_16x16x32_bf16 v[116:119], v[212:215], v[172:175], v[116:119]
    v_exp_f32 v206, v206
    v_cvt_pk_bf16_f32 v247, v253, v247
    v_mfma_f32_16x16x32_bf16 v[148:151], v[212:215], v[176:179], v[148:151]
    s_waitcnt lgkmcnt(4)
    ds_read_b64_tr_b16 v[208:209], v224 offset:28672
    v_cvt_pk_bf16_f32 v190, v204, v205
    v_mfma_f32_16x16x32_bf16 v[24:27], v[216:219], v[160:163], v[24:27]
    v_exp_f32 v207, v207
    v_mfma_f32_16x16x32_bf16 v[56:59], v[216:219], v[164:167], v[56:59]
    ds_write_b64 v254, v[246:247] offset:8200
    v_smfmac_f32_16x16x64_bf16 a[248:251], a[252:255], v[172:179], v233
    ds_read_b64_tr_b16 v[210:211], v224 offset:30720
    v_cvt_pk_bf16_f32 v191, v206, v207
    v_mfma_f32_16x16x32_bf16 v[204:207], a[140:143], a[64:67], 0
    v_exp_f32 v200, v200
    v_mfma_f32_16x16x32_bf16 v[204:207], a[228:231], a[68:71], v[204:207]
    s_waitcnt vmcnt(6)
    ds_read_b128 a[228:231], v229 offset:4096
    v_lshlrev_b32 v252, 16, v248
    v_mfma_f32_16x16x32_bf16 v[204:207], a[232:235], a[72:75], v[204:207]
    v_exp_f32 v201, v201
    v_mfma_f32_16x16x32_bf16 v[204:207], a[236:239], a[76:79], v[204:207]
    ds_read_b128 a[232:235], v235 offset:4096
    v_and_b32 v248, s26, v248
    v_mul_f32 v252, s25, v252
    v_mul_f32 v248, s25, v248
    v_cvt_pk_bf16_f32 v248, v252, v248
    v_mfma_f32_16x16x32_bf16 v[88:91], v[216:219], v[168:171], v[88:91]
    v_exp_f32 v202, v202
    v_mfma_f32_16x16x32_bf16 v[120:123], v[216:219], v[172:175], v[120:123]
    ds_read_b128 a[236:239], v231 offset:4096
    v_cvt_pk_bf16_f32 v194, v200, v201
    v_mfma_f32_16x16x32_bf16 v[152:155], v[216:219], v[176:179], v[152:155]
    s_waitcnt lgkmcnt(6)
    v_exp_f32 v203, v203
    v_mfma_f32_16x16x32_bf16 v[28:31], v[220:223], v[160:163], v[28:31]
    ds_read_b64_tr_b16 v[212:213], v224 offset:28680
    v_cvt_pk_bf16_f32 v195, v202, v203
    v_mfma_f32_16x16x32_bf16 v[200:203], a[144:147], a[0:3], 0
    s_add_u32 s40, s40, 8192
    v_exp_f32 v204, v204
    v_mfma_f32_16x16x32_bf16 v[200:203], a[212:215], a[4:7], v[200:203]
    buffer_load_dwordx4 v[244:247], v234, s[12:15], s40 offen offset:0 nt
    v_mfma_f32_16x16x32_bf16 v[200:203], a[216:219], a[8:11], v[200:203]
    v_exp_f32 v205, v205
    v_mfma_f32_16x16x32_bf16 v[200:203], a[220:223], a[12:15], v[200:203]
    ds_read_b64_tr_b16 v[214:215], v224 offset:30728
    v_lshlrev_b32 v253, 16, v249
    v_and_b32 v249, s26, v249
    v_mul_f32 v253, s25, v253
    v_mul_f32 v249, s25, v249
    v_cvt_pk_bf16_f32 v249, v253, v249
    v_mfma_f32_16x16x32_bf16 v[60:63], v[220:223], v[164:167], v[60:63]
    v_exp_f32 v206, v206
    v_mfma_f32_16x16x32_bf16 v[92:95], v[220:223], v[168:171], v[92:95]
    v_exp_f32 v207, v207
    v_mfma_f32_16x16x32_bf16 v[124:127], v[220:223], v[172:175], v[124:127]
    ds_write_b64 v254, v[248:249] offset:8320
    v_mfma_f32_16x16x32_bf16 v[156:159], v[220:223], v[176:179], v[156:159]
    ds_read_b64_tr_b16 v[216:217], v225 offset:28672
    v_cvt_pk_bf16_f32 v198, v204, v205
    v_cvt_pk_bf16_f32 v199, v206, v207
    v_mfma_f32_16x16x32_bf16 v[204:207], a[144:147], a[16:19], 0
    v_exp_f32 v200, v200
    v_mfma_f32_16x16x32_bf16 v[204:207], a[212:215], a[20:23], v[204:207]
    ds_read_b64_tr_b16 v[218:219], v225 offset:30720
    v_lshlrev_b32 v252, 16, v250
    v_mfma_f32_16x16x32_bf16 v[204:207], a[216:219], a[24:27], v[204:207]
    v_exp_f32 v201, v201
    v_mfma_f32_16x16x32_bf16 v[204:207], a[220:223], a[28:31], v[204:207]
    s_waitcnt lgkmcnt(8)
    v_and_b32 v250, s26, v250
    v_mul_f32 v252, s25, v252
    v_mul_f32 v250, s25, v250
    v_cvt_pk_bf16_f32 v250, v252, v250
    v_mfma_f32_16x16x32_bf16 v[0:3], v[208:211], v[180:183], v[0:3]
    v_exp_f32 v202, v202
    v_mfma_f32_16x16x32_bf16 v[32:35], v[208:211], v[184:187], v[32:35]
    v_lshlrev_b32 v253, 16, v251
    v_cvt_pk_bf16_f32 v160, v200, v201
    v_mfma_f32_16x16x32_bf16 v[64:67], v[208:211], v[188:191], v[64:67]
    v_exp_f32 v203, v203
    v_mfma_f32_16x16x32_bf16 v[96:99], v[208:211], v[192:195], v[96:99]
    v_cvt_pk_bf16_f32 v161, v202, v203
    v_and_b32 v251, s26, v251
    v_smfmac_f32_16x16x64_bf16 a[240:243], a[252:255], v[180:187], v233
    v_mul_f32 v253, s25, v253
    v_mul_f32 v251, s25, v251
    v_mfma_f32_16x16x32_bf16 v[200:203], a[144:147], a[32:35], 0
    v_exp_f32 v204, v204
    v_mfma_f32_16x16x32_bf16 v[200:203], a[212:215], a[36:39], v[200:203]
    v_cvt_pk_bf16_f32 v251, v253, v251
    v_mfma_f32_16x16x32_bf16 v[200:203], a[216:219], a[40:43], v[200:203]
    v_exp_f32 v205, v205
    v_mfma_f32_16x16x32_bf16 v[200:203], a[220:223], a[44:47], v[200:203]
    v_exp_f32 v206, v206
    v_mfma_f32_16x16x32_bf16 v[128:131], v[208:211], v[196:199], v[128:131]
    s_waitcnt lgkmcnt(3)
    v_exp_f32 v207, v207
    v_mfma_f32_16x16x32_bf16 v[4:7], v[212:215], v[180:183], v[4:7]
    ds_write_b64 v254, v[250:251] offset:8328
    v_mfma_f32_16x16x32_bf16 v[36:39], v[212:215], v[184:187], v[36:39]
    buffer_load_dwordx4 v[248:251], v234, s[12:15], s40 offen offset:2048 nt
    v_mfma_f32_16x16x32_bf16 v[68:71], v[212:215], v[188:191], v[68:71]
    ds_read_b64_tr_b16 v[220:221], v225 offset:28680
    v_cvt_pk_bf16_f32 v164, v204, v205
    v_cvt_pk_bf16_f32 v165, v206, v207
    v_mfma_f32_16x16x32_bf16 v[204:207], a[144:147], a[48:51], 0
    v_exp_f32 v200, v200
    v_mfma_f32_16x16x32_bf16 v[204:207], a[212:215], a[52:55], v[204:207]
    ds_read_b64_tr_b16 v[222:223], v225 offset:30728
    v_mfma_f32_16x16x32_bf16 v[204:207], a[216:219], a[56:59], v[204:207]
    v_exp_f32 v201, v201
    v_mfma_f32_16x16x32_bf16 v[204:207], a[220:223], a[60:63], v[204:207]
    v_exp_f32 v202, v202
    v_mfma_f32_16x16x32_bf16 v[100:103], v[212:215], v[192:195], v[100:103]
    v_exp_f32 v203, v203
    v_mfma_f32_16x16x32_bf16 v[132:135], v[212:215], v[196:199], v[132:135]
    s_waitcnt lgkmcnt(3)
    ds_read_b64_tr_b16 v[208:209], v224 offset:61440
    v_cvt_pk_bf16_f32 v168, v200, v201
    v_mfma_f32_16x16x32_bf16 v[8:11], v[216:219], v[180:183], v[8:11]
    ds_read_b64_tr_b16 v[210:211], v224 offset:63488
    v_cvt_pk_bf16_f32 v169, v202, v203
    v_mfma_f32_16x16x32_bf16 v[40:43], v[216:219], v[184:187], v[40:43]
    v_mfma_f32_16x16x32_bf16 v[200:203], a[144:147], a[64:67], 0
    v_exp_f32 v204, v204
    v_mfma_f32_16x16x32_bf16 v[200:203], a[212:215], a[68:71], v[200:203]
    v_exp_f32 v205, v205
    v_mfma_f32_16x16x32_bf16 v[200:203], a[216:219], a[72:75], v[200:203]
    v_exp_f32 v206, v206
    v_mfma_f32_16x16x32_bf16 v[200:203], a[220:223], a[76:79], v[200:203]
    s_waitcnt vmcnt(6) lgkmcnt(4)
    s_barrier
    ds_read_b128 a[152:155], v228 offset:8192
    v_cvt_pk_bf16_f32 v172, v204, v205
    v_mfma_f32_16x16x32_bf16 v[72:75], v[216:219], v[188:191], v[72:75]
    v_exp_f32 v207, v207
    v_mfma_f32_16x16x32_bf16 v[104:107], v[216:219], v[192:195], v[104:107]
    ds_read_b128 a[212:215], v229 offset:8192
    v_cvt_pk_bf16_f32 v173, v206, v207
    v_mfma_f32_16x16x32_bf16 v[136:139], v[216:219], v[196:199], v[136:139]
    s_waitcnt lgkmcnt(4)
    ds_read_b64_tr_b16 v[212:213], v224 offset:61448
    v_mfma_f32_16x16x32_bf16 v[12:15], v[220:223], v[180:183], v[12:15]
    ds_read_b64_tr_b16 v[214:215], v224 offset:63496
    v_xor_b32 v224, 0x10000, v224
    v_mfma_f32_16x16x32_bf16 v[204:207], a[148:151], a[0:3], 0
    s_add_u32 s41, s41, 8192
    v_exp_f32 v200, v200
    v_mfma_f32_16x16x32_bf16 v[204:207], a[228:231], a[4:7], v[204:207]
    s_waitcnt vmcnt(5)
    s_add_u32 m0, s42, 73728
    ds_read_b128 a[216:219], v235 offset:8192
    v_lshlrev_b32 v252, 16, v236
    v_mfma_f32_16x16x32_bf16 v[204:207], a[232:235], a[8:11], v[204:207]
    v_exp_f32 v201, v201
    v_mfma_f32_16x16x32_bf16 v[204:207], a[236:239], a[12:15], v[204:207]
    buffer_load_dwordx4 v234, s[16:19], s41 offen offset:0 nt lds
    v_mfma_f32_16x16x32_bf16 v[44:47], v[220:223], v[184:187], v[44:47]
    s_add_u32 m0, s42, 106368
    v_exp_f32 v202, v202
    v_mfma_f32_16x16x32_bf16 v[76:79], v[220:223], v[188:191], v[76:79]
    ds_read_b128 a[220:223], v231 offset:8192
    v_and_b32 v236, s26, v236
    v_mul_f32 v252, s25, v252
    v_mul_f32 v236, s25, v236
    v_cvt_pk_bf16_f32 v236, v252, v236
    v_mfma_f32_16x16x32_bf16 v[108:111], v[220:223], v[192:195], v[108:111]
    v_exp_f32 v203, v203
    v_mfma_f32_16x16x32_bf16 v[140:143], v[220:223], v[196:199], v[140:143]
    ds_read_b64_tr_b16 v[216:217], v225 offset:61440
    v_cvt_pk_bf16_f32 v176, v200, v201
    v_cvt_pk_bf16_f32 v177, v202, v203
    v_mfma_f32_16x16x32_bf16 v[200:203], a[148:151], a[16:19], 0
    v_exp_f32 v204, v204
    v_mfma_f32_16x16x32_bf16 v[200:203], a[228:231], a[20:23], v[200:203]
    buffer_load_dwordx4 v234, s[16:19], s41 offen offset:128 nt lds
    v_mfma_f32_16x16x32_bf16 v[200:203], a[232:235], a[24:27], v[200:203]
    v_exp_f32 v205, v205
    v_mfma_f32_16x16x32_bf16 v[200:203], a[236:239], a[28:31], v[200:203]
    s_waitcnt lgkmcnt(7)
    ds_read_b64_tr_b16 v[218:219], v225 offset:63488
    v_lshlrev_b32 v253, 16, v237
    v_mfma_f32_16x16x32_bf16 v[16:19], v[208:211], v[180:183], v[16:19]
    v_exp_f32 v206, v206
    v_mfma_f32_16x16x32_bf16 v[48:51], v[208:211], v[184:187], v[48:51]
    ds_read_b128 a[156:159], v228 offset:12288
    v_and_b32 v237, s26, v237
    v_mul_f32 v253, s25, v253
    v_mul_f32 v237, s25, v237
    v_cvt_pk_bf16_f32 v237, v253, v237
    v_mfma_f32_16x16x32_bf16 v[80:83], v[208:211], v[188:191], v[80:83]
    v_exp_f32 v207, v207
    v_mfma_f32_16x16x32_bf16 v[112:115], v[208:211], v[192:195], v[112:115]
    v_cvt_pk_bf16_f32 v162, v204, v205
    v_cvt_pk_bf16_f32 v163, v206, v207
    v_smfmac_f32_16x16x64_bf16 a[244:247], a[252:255], v[188:195], v233
    ds_write_b64 v254, v[236:237] offset:16384
    v_mfma_f32_16x16x32_bf16 v[204:207], a[148:151], a[32:35], 0
    v_exp_f32 v200, v200
    v_mfma_f32_16x16x32_bf16 v[204:207], a[228:231], a[36:39], v[204:207]
    v_lshlrev_b32 v252, 16, v238
    v_and_b32 v238, s26, v238
    v_mfma_f32_16x16x32_bf16 v[204:207], a[232:235], a[40:43], v[204:207]
    v_exp_f32 v201, v201
    v_mfma_f32_16x16x32_bf16 v[204:207], a[236:239], a[44:47], v[204:207]
    v_mul_f32 v252, s25, v252
    v_mul_f32 v238, s25, v238
    v_mfma_f32_16x16x32_bf16 v[144:147], v[208:211], v[196:199], v[144:147]
    s_waitcnt lgkmcnt(6)
    v_exp_f32 v202, v202
    v_cvt_pk_bf16_f32 v238, v252, v238
    v_mfma_f32_16x16x32_bf16 v[20:23], v[212:215], v[180:183], v[20:23]
    ds_read_b64_tr_b16 v[220:221], v225 offset:61448
    v_cvt_pk_bf16_f32 v166, v200, v201
    v_mfma_f32_16x16x32_bf16 v[52:55], v[212:215], v[184:187], v[52:55]
    v_exp_f32 v203, v203
    v_mfma_f32_16x16x32_bf16 v[84:87], v[212:215], v[188:191], v[84:87]
    ds_read_b64_tr_b16 v[222:223], v225 offset:63496
    v_cvt_pk_bf16_f32 v167, v202, v203
    v_mfma_f32_16x16x32_bf16 v[200:203], a[148:151], a[48:51], 0
    v_exp_f32 v204, v204
    v_mfma_f32_16x16x32_bf16 v[200:203], a[228:231], a[52:55], v[200:203]
    v_lshlrev_b32 v253, 16, v239
    v_and_b32 v239, s26, v239
    v_mfma_f32_16x16x32_bf16 v[200:203], a[232:235], a[56:59], v[200:203]
    v_exp_f32 v205, v205
    v_mfma_f32_16x16x32_bf16 v[200:203], a[236:239], a[60:63], v[200:203]
    v_mul_f32 v253, s25, v253
    v_mul_f32 v239, s25, v239
    v_mfma_f32_16x16x32_bf16 v[116:119], v[212:215], v[192:195], v[116:119]
    v_exp_f32 v206, v206
    v_cvt_pk_bf16_f32 v239, v253, v239
    v_mfma_f32_16x16x32_bf16 v[148:151], v[212:215], v[196:199], v[148:151]
    s_waitcnt lgkmcnt(4)
    ds_read_b64_tr_b16 v[208:209], v224 offset:0
    v_cvt_pk_bf16_f32 v170, v204, v205
    v_mfma_f32_16x16x32_bf16 v[24:27], v[216:219], v[180:183], v[24:27]
    v_exp_f32 v207, v207
    v_mfma_f32_16x16x32_bf16 v[56:59], v[216:219], v[184:187], v[56:59]
    ds_write_b64 v254, v[238:239] offset:16392
    v_smfmac_f32_16x16x64_bf16 a[248:251], a[252:255], v[192:199], v233
    ds_read_b64_tr_b16 v[210:211], v224 offset:2048
    v_cvt_pk_bf16_f32 v171, v206, v207
    v_mfma_f32_16x16x32_bf16 v[204:207], a[148:151], a[64:67], 0
    v_exp_f32 v200, v200
    v_mfma_f32_16x16x32_bf16 v[204:207], a[228:231], a[68:71], v[204:207]
    s_waitcnt vmcnt(6)
    ds_read_b128 a[228:231], v229 offset:12288
    v_lshlrev_b32 v252, 16, v240
    v_mfma_f32_16x16x32_bf16 v[204:207], a[232:235], a[72:75], v[204:207]
    v_exp_f32 v201, v201
    v_mfma_f32_16x16x32_bf16 v[204:207], a[236:239], a[76:79], v[204:207]
    ds_read_b128 a[232:235], v235 offset:12288
    v_and_b32 v240, s26, v240
    v_mul_f32 v252, s25, v252
    v_mul_f32 v240, s25, v240
    v_cvt_pk_bf16_f32 v240, v252, v240
    v_mfma_f32_16x16x32_bf16 v[88:91], v[216:219], v[188:191], v[88:91]
    v_exp_f32 v202, v202
    v_mfma_f32_16x16x32_bf16 v[120:123], v[216:219], v[192:195], v[120:123]
    ds_read_b128 a[236:239], v231 offset:12288
    v_xor_b32 v225, 0x10000, v225
    v_mfma_f32_16x16x32_bf16 v[152:155], v[216:219], v[196:199], v[152:155]
    s_waitcnt lgkmcnt(6)
    v_exp_f32 v203, v203
    v_mfma_f32_16x16x32_bf16 v[28:31], v[220:223], v[180:183], v[28:31]
    ds_read_b64_tr_b16 v[212:213], v224 offset:8
    v_cvt_pk_bf16_f32 v174, v200, v201
    v_cvt_pk_bf16_f32 v175, v202, v203
    v_mfma_f32_16x16x32_bf16 v[200:203], a[152:155], a[0:3], 0
    s_add_u32 s40, s40, 8192
    v_exp_f32 v204, v204
    v_mfma_f32_16x16x32_bf16 v[200:203], a[212:215], a[4:7], v[200:203]
    buffer_load_dwordx4 v[236:239], v234, s[12:15], s40 offen offset:0 nt
    v_mfma_f32_16x16x32_bf16 v[200:203], a[216:219], a[8:11], v[200:203]
    v_exp_f32 v205, v205
    v_mfma_f32_16x16x32_bf16 v[200:203], a[220:223], a[12:15], v[200:203]
    ds_read_b64_tr_b16 v[214:215], v224 offset:2056
    v_lshlrev_b32 v253, 16, v241
    v_and_b32 v241, s26, v241
    v_mul_f32 v253, s25, v253
    v_mul_f32 v241, s25, v241
    v_cvt_pk_bf16_f32 v241, v253, v241
    v_mfma_f32_16x16x32_bf16 v[60:63], v[220:223], v[184:187], v[60:63]
    v_exp_f32 v206, v206
    v_mfma_f32_16x16x32_bf16 v[92:95], v[220:223], v[188:191], v[92:95]
    v_exp_f32 v207, v207
    v_mfma_f32_16x16x32_bf16 v[124:127], v[220:223], v[192:195], v[124:127]
    ds_write_b64 v254, v[240:241] offset:16512
    v_mfma_f32_16x16x32_bf16 v[156:159], v[220:223], v[196:199], v[156:159]
    ds_read_b64_tr_b16 v[216:217], v225 offset:0
    v_cvt_pk_bf16_f32 v178, v204, v205
    v_cvt_pk_bf16_f32 v179, v206, v207
    v_mfma_f32_16x16x32_bf16 v[204:207], a[152:155], a[16:19], 0
    v_exp_f32 v200, v200
    v_mfma_f32_16x16x32_bf16 v[204:207], a[212:215], a[20:23], v[204:207]
    ds_read_b64_tr_b16 v[218:219], v225 offset:2048
    v_lshlrev_b32 v252, 16, v242
    v_mfma_f32_16x16x32_bf16 v[204:207], a[216:219], a[24:27], v[204:207]
    v_exp_f32 v201, v201
    v_mfma_f32_16x16x32_bf16 v[204:207], a[220:223], a[28:31], v[204:207]
    s_waitcnt lgkmcnt(8)
    v_and_b32 v242, s26, v242
    v_mul_f32 v252, s25, v252
    v_mul_f32 v242, s25, v242
    v_cvt_pk_bf16_f32 v242, v252, v242
    v_mfma_f32_16x16x32_bf16 v[0:3], v[208:211], v[160:163], v[0:3]
    v_exp_f32 v202, v202
    v_mfma_f32_16x16x32_bf16 v[32:35], v[208:211], v[164:167], v[32:35]
    v_lshlrev_b32 v253, 16, v243
    v_cvt_pk_bf16_f32 v180, v200, v201
    v_mfma_f32_16x16x32_bf16 v[64:67], v[208:211], v[168:171], v[64:67]
    v_exp_f32 v203, v203
    v_mfma_f32_16x16x32_bf16 v[96:99], v[208:211], v[172:175], v[96:99]
    v_cvt_pk_bf16_f32 v181, v202, v203
    v_and_b32 v243, s26, v243
    v_smfmac_f32_16x16x64_bf16 a[240:243], a[252:255], v[160:167], v233
    v_mul_f32 v253, s25, v253
    v_mul_f32 v243, s25, v243
    v_mfma_f32_16x16x32_bf16 v[200:203], a[152:155], a[32:35], 0
    v_exp_f32 v204, v204
    v_mfma_f32_16x16x32_bf16 v[200:203], a[212:215], a[36:39], v[200:203]
    v_cvt_pk_bf16_f32 v243, v253, v243
    v_mfma_f32_16x16x32_bf16 v[200:203], a[216:219], a[40:43], v[200:203]
    v_exp_f32 v205, v205
    v_mfma_f32_16x16x32_bf16 v[200:203], a[220:223], a[44:47], v[200:203]
    v_exp_f32 v206, v206
    v_mfma_f32_16x16x32_bf16 v[128:131], v[208:211], v[176:179], v[128:131]
    s_waitcnt lgkmcnt(3)
    v_exp_f32 v207, v207
    v_mfma_f32_16x16x32_bf16 v[4:7], v[212:215], v[160:163], v[4:7]
    ds_write_b64 v254, v[242:243] offset:16520
    v_mfma_f32_16x16x32_bf16 v[36:39], v[212:215], v[164:167], v[36:39]
    buffer_load_dwordx4 v[240:243], v234, s[12:15], s40 offen offset:2048 nt
    v_mfma_f32_16x16x32_bf16 v[68:71], v[212:215], v[168:171], v[68:71]
    ds_read_b64_tr_b16 v[220:221], v225 offset:8
    v_cvt_pk_bf16_f32 v184, v204, v205
    v_cvt_pk_bf16_f32 v185, v206, v207
    v_mfma_f32_16x16x32_bf16 v[204:207], a[152:155], a[48:51], 0
    v_exp_f32 v200, v200
    v_mfma_f32_16x16x32_bf16 v[204:207], a[212:215], a[52:55], v[204:207]
    ds_read_b64_tr_b16 v[222:223], v225 offset:2056
    v_mfma_f32_16x16x32_bf16 v[204:207], a[216:219], a[56:59], v[204:207]
    v_exp_f32 v201, v201
    v_mfma_f32_16x16x32_bf16 v[204:207], a[220:223], a[60:63], v[204:207]
    v_exp_f32 v202, v202
    v_mfma_f32_16x16x32_bf16 v[100:103], v[212:215], v[172:175], v[100:103]
    v_exp_f32 v203, v203
    v_mfma_f32_16x16x32_bf16 v[132:135], v[212:215], v[176:179], v[132:135]
    s_waitcnt lgkmcnt(3)
    ds_read_b64_tr_b16 v[208:209], v224 offset:32768
    v_cvt_pk_bf16_f32 v188, v200, v201
    v_mfma_f32_16x16x32_bf16 v[8:11], v[216:219], v[160:163], v[8:11]
    ds_read_b64_tr_b16 v[210:211], v224 offset:34816
    v_cvt_pk_bf16_f32 v189, v202, v203
    v_mfma_f32_16x16x32_bf16 v[40:43], v[216:219], v[164:167], v[40:43]
    v_mfma_f32_16x16x32_bf16 v[200:203], a[152:155], a[64:67], 0
    v_exp_f32 v204, v204
    v_mfma_f32_16x16x32_bf16 v[200:203], a[212:215], a[68:71], v[200:203]
    v_exp_f32 v205, v205
    v_mfma_f32_16x16x32_bf16 v[200:203], a[216:219], a[72:75], v[200:203]
    v_exp_f32 v206, v206
    v_mfma_f32_16x16x32_bf16 v[200:203], a[220:223], a[76:79], v[200:203]
    s_waitcnt vmcnt(6) lgkmcnt(4)
    s_barrier
    ds_read_b128 a[160:163], v228 offset:16384
    v_cvt_pk_bf16_f32 v192, v204, v205
    v_mfma_f32_16x16x32_bf16 v[72:75], v[216:219], v[168:171], v[72:75]
    v_exp_f32 v207, v207
    v_mfma_f32_16x16x32_bf16 v[104:107], v[216:219], v[172:175], v[104:107]
    ds_read_b128 a[212:215], v229 offset:16384
    v_cvt_pk_bf16_f32 v193, v206, v207
    v_mfma_f32_16x16x32_bf16 v[136:139], v[216:219], v[176:179], v[136:139]
    s_waitcnt lgkmcnt(4)
    ds_read_b64_tr_b16 v[212:213], v224 offset:32776
    v_mfma_f32_16x16x32_bf16 v[12:15], v[220:223], v[160:163], v[12:15]
    ds_read_b64_tr_b16 v[214:215], v224 offset:34824
    v_mfma_f32_16x16x32_bf16 v[204:207], a[156:159], a[0:3], 0
    s_add_u32 s41, s41, 8192
    v_exp_f32 v200, v200
    v_mfma_f32_16x16x32_bf16 v[204:207], a[228:231], a[4:7], v[204:207]
    s_waitcnt vmcnt(5)
    s_add_u32 m0, s42, 77824
    ds_read_b128 a[216:219], v235 offset:16384
    v_lshlrev_b32 v252, 16, v244
    v_mfma_f32_16x16x32_bf16 v[204:207], a[232:235], a[8:11], v[204:207]
    v_exp_f32 v201, v201
    v_mfma_f32_16x16x32_bf16 v[204:207], a[236:239], a[12:15], v[204:207]
    buffer_load_dwordx4 v234, s[16:19], s41 offen offset:0 nt lds
    v_mfma_f32_16x16x32_bf16 v[44:47], v[220:223], v[164:167], v[44:47]
    s_add_u32 m0, s42, 110464
    v_exp_f32 v202, v202
    v_mfma_f32_16x16x32_bf16 v[76:79], v[220:223], v[168:171], v[76:79]
    ds_read_b128 a[220:223], v231 offset:16384
    v_and_b32 v244, s26, v244
    v_mul_f32 v252, s25, v252
    v_mul_f32 v244, s25, v244
    v_cvt_pk_bf16_f32 v244, v252, v244
    v_mfma_f32_16x16x32_bf16 v[108:111], v[220:223], v[172:175], v[108:111]
    v_exp_f32 v203, v203
    v_mfma_f32_16x16x32_bf16 v[140:143], v[220:223], v[176:179], v[140:143]
    ds_read_b64_tr_b16 v[216:217], v225 offset:32768
    v_cvt_pk_bf16_f32 v196, v200, v201
    v_cvt_pk_bf16_f32 v197, v202, v203
    v_mfma_f32_16x16x32_bf16 v[200:203], a[156:159], a[16:19], 0
    v_exp_f32 v204, v204
    v_mfma_f32_16x16x32_bf16 v[200:203], a[228:231], a[20:23], v[200:203]
    buffer_load_dwordx4 v234, s[16:19], s41 offen offset:128 nt lds
    v_mfma_f32_16x16x32_bf16 v[200:203], a[232:235], a[24:27], v[200:203]
    v_exp_f32 v205, v205
    v_mfma_f32_16x16x32_bf16 v[200:203], a[236:239], a[28:31], v[200:203]
    s_waitcnt lgkmcnt(7)
    ds_read_b64_tr_b16 v[218:219], v225 offset:34816
    v_lshlrev_b32 v253, 16, v245
    v_mfma_f32_16x16x32_bf16 v[16:19], v[208:211], v[160:163], v[16:19]
    v_exp_f32 v206, v206
    v_mfma_f32_16x16x32_bf16 v[48:51], v[208:211], v[164:167], v[48:51]
    ds_read_b128 a[164:167], v228 offset:20480
    v_and_b32 v245, s26, v245
    v_mul_f32 v253, s25, v253
    v_mul_f32 v245, s25, v245
    v_cvt_pk_bf16_f32 v245, v253, v245
    v_mfma_f32_16x16x32_bf16 v[80:83], v[208:211], v[168:171], v[80:83]
    v_exp_f32 v207, v207
    v_mfma_f32_16x16x32_bf16 v[112:115], v[208:211], v[172:175], v[112:115]
    v_cvt_pk_bf16_f32 v182, v204, v205
    v_cvt_pk_bf16_f32 v183, v206, v207
    v_smfmac_f32_16x16x64_bf16 a[244:247], a[252:255], v[168:175], v233
    ds_write_b64 v254, v[244:245] offset:24576
    v_mfma_f32_16x16x32_bf16 v[204:207], a[156:159], a[32:35], 0
    v_exp_f32 v200, v200
    v_mfma_f32_16x16x32_bf16 v[204:207], a[228:231], a[36:39], v[204:207]
    v_lshlrev_b32 v252, 16, v246
    v_and_b32 v246, s26, v246
    v_mfma_f32_16x16x32_bf16 v[204:207], a[232:235], a[40:43], v[204:207]
    v_exp_f32 v201, v201
    v_mfma_f32_16x16x32_bf16 v[204:207], a[236:239], a[44:47], v[204:207]
    v_mul_f32 v252, s25, v252
    v_mul_f32 v246, s25, v246
    v_mfma_f32_16x16x32_bf16 v[144:147], v[208:211], v[176:179], v[144:147]
    s_waitcnt lgkmcnt(6)
    v_exp_f32 v202, v202
    v_cvt_pk_bf16_f32 v246, v252, v246
    v_mfma_f32_16x16x32_bf16 v[20:23], v[212:215], v[160:163], v[20:23]
    ds_read_b64_tr_b16 v[220:221], v225 offset:32776
    v_cvt_pk_bf16_f32 v186, v200, v201
    v_mfma_f32_16x16x32_bf16 v[52:55], v[212:215], v[164:167], v[52:55]
    v_exp_f32 v203, v203
    v_mfma_f32_16x16x32_bf16 v[84:87], v[212:215], v[168:171], v[84:87]
    ds_read_b64_tr_b16 v[222:223], v225 offset:34824
    v_cvt_pk_bf16_f32 v187, v202, v203
    v_mfma_f32_16x16x32_bf16 v[200:203], a[156:159], a[48:51], 0
    v_exp_f32 v204, v204
    v_mfma_f32_16x16x32_bf16 v[200:203], a[228:231], a[52:55], v[200:203]
    v_lshlrev_b32 v253, 16, v247
    v_and_b32 v247, s26, v247
    v_mfma_f32_16x16x32_bf16 v[200:203], a[232:235], a[56:59], v[200:203]
    v_exp_f32 v205, v205
    v_mfma_f32_16x16x32_bf16 v[200:203], a[236:239], a[60:63], v[200:203]
    v_mul_f32 v253, s25, v253
    v_mul_f32 v247, s25, v247
    v_mfma_f32_16x16x32_bf16 v[116:119], v[212:215], v[172:175], v[116:119]
    v_exp_f32 v206, v206
    v_cvt_pk_bf16_f32 v247, v253, v247
    v_mfma_f32_16x16x32_bf16 v[148:151], v[212:215], v[176:179], v[148:151]
    s_waitcnt lgkmcnt(4)
    ds_read_b64_tr_b16 v[208:209], v224 offset:4096
    v_cvt_pk_bf16_f32 v190, v204, v205
    v_mfma_f32_16x16x32_bf16 v[24:27], v[216:219], v[160:163], v[24:27]
    v_exp_f32 v207, v207
    v_mfma_f32_16x16x32_bf16 v[56:59], v[216:219], v[164:167], v[56:59]
    ds_write_b64 v254, v[246:247] offset:24584
    v_smfmac_f32_16x16x64_bf16 a[248:251], a[252:255], v[172:179], v233
    ds_read_b64_tr_b16 v[210:211], v224 offset:6144
    v_cvt_pk_bf16_f32 v191, v206, v207
    v_mfma_f32_16x16x32_bf16 v[204:207], a[156:159], a[64:67], 0
    v_exp_f32 v200, v200
    v_mfma_f32_16x16x32_bf16 v[204:207], a[228:231], a[68:71], v[204:207]
    s_waitcnt vmcnt(6)
    ds_read_b128 a[228:231], v229 offset:20480
    v_lshlrev_b32 v252, 16, v248
    v_mfma_f32_16x16x32_bf16 v[204:207], a[232:235], a[72:75], v[204:207]
    v_exp_f32 v201, v201
    v_mfma_f32_16x16x32_bf16 v[204:207], a[236:239], a[76:79], v[204:207]
    ds_read_b128 a[232:235], v235 offset:20480
    v_and_b32 v248, s26, v248
    v_mul_f32 v252, s25, v252
    v_mul_f32 v248, s25, v248
    v_cvt_pk_bf16_f32 v248, v252, v248
    v_mfma_f32_16x16x32_bf16 v[88:91], v[216:219], v[168:171], v[88:91]
    v_exp_f32 v202, v202
    v_mfma_f32_16x16x32_bf16 v[120:123], v[216:219], v[172:175], v[120:123]
    ds_read_b128 a[236:239], v231 offset:20480
    v_cvt_pk_bf16_f32 v194, v200, v201
    v_mfma_f32_16x16x32_bf16 v[152:155], v[216:219], v[176:179], v[152:155]
    s_waitcnt lgkmcnt(6)
    v_exp_f32 v203, v203
    v_mfma_f32_16x16x32_bf16 v[28:31], v[220:223], v[160:163], v[28:31]
    ds_read_b64_tr_b16 v[212:213], v224 offset:4104
    v_cvt_pk_bf16_f32 v195, v202, v203
    v_mfma_f32_16x16x32_bf16 v[200:203], a[160:163], a[0:3], 0
    s_add_u32 s40, s40, 8192
    v_exp_f32 v204, v204
    v_mfma_f32_16x16x32_bf16 v[200:203], a[212:215], a[4:7], v[200:203]
    buffer_load_dwordx4 v[244:247], v234, s[12:15], s40 offen offset:0 nt
    v_mfma_f32_16x16x32_bf16 v[200:203], a[216:219], a[8:11], v[200:203]
    v_exp_f32 v205, v205
    v_mfma_f32_16x16x32_bf16 v[200:203], a[220:223], a[12:15], v[200:203]
    ds_read_b64_tr_b16 v[214:215], v224 offset:6152
    v_lshlrev_b32 v253, 16, v249
    v_and_b32 v249, s26, v249
    v_mul_f32 v253, s25, v253
    v_mul_f32 v249, s25, v249
    v_cvt_pk_bf16_f32 v249, v253, v249
    v_mfma_f32_16x16x32_bf16 v[60:63], v[220:223], v[164:167], v[60:63]
    v_exp_f32 v206, v206
    v_mfma_f32_16x16x32_bf16 v[92:95], v[220:223], v[168:171], v[92:95]
    v_exp_f32 v207, v207
    v_mfma_f32_16x16x32_bf16 v[124:127], v[220:223], v[172:175], v[124:127]
    ds_write_b64 v254, v[248:249] offset:24704
    v_mfma_f32_16x16x32_bf16 v[156:159], v[220:223], v[176:179], v[156:159]
    ds_read_b64_tr_b16 v[216:217], v225 offset:4096
    v_cvt_pk_bf16_f32 v198, v204, v205
    v_cvt_pk_bf16_f32 v199, v206, v207
    v_mfma_f32_16x16x32_bf16 v[204:207], a[160:163], a[16:19], 0
    v_exp_f32 v200, v200
    v_mfma_f32_16x16x32_bf16 v[204:207], a[212:215], a[20:23], v[204:207]
    ds_read_b64_tr_b16 v[218:219], v225 offset:6144
    v_lshlrev_b32 v252, 16, v250
    v_mfma_f32_16x16x32_bf16 v[204:207], a[216:219], a[24:27], v[204:207]
    v_exp_f32 v201, v201
    v_mfma_f32_16x16x32_bf16 v[204:207], a[220:223], a[28:31], v[204:207]
    s_waitcnt lgkmcnt(8)
    v_and_b32 v250, s26, v250
    v_mul_f32 v252, s25, v252
    v_mul_f32 v250, s25, v250
    v_cvt_pk_bf16_f32 v250, v252, v250
    v_mfma_f32_16x16x32_bf16 v[0:3], v[208:211], v[180:183], v[0:3]
    v_exp_f32 v202, v202
    v_mfma_f32_16x16x32_bf16 v[32:35], v[208:211], v[184:187], v[32:35]
    v_lshlrev_b32 v253, 16, v251
    v_cvt_pk_bf16_f32 v160, v200, v201
    v_mfma_f32_16x16x32_bf16 v[64:67], v[208:211], v[188:191], v[64:67]
    v_exp_f32 v203, v203
    v_mfma_f32_16x16x32_bf16 v[96:99], v[208:211], v[192:195], v[96:99]
    v_cvt_pk_bf16_f32 v161, v202, v203
    v_and_b32 v251, s26, v251
    v_smfmac_f32_16x16x64_bf16 a[240:243], a[252:255], v[180:187], v233
    v_mul_f32 v253, s25, v253
    v_mul_f32 v251, s25, v251
    v_mfma_f32_16x16x32_bf16 v[200:203], a[160:163], a[32:35], 0
    v_exp_f32 v204, v204
    v_mfma_f32_16x16x32_bf16 v[200:203], a[212:215], a[36:39], v[200:203]
    v_cvt_pk_bf16_f32 v251, v253, v251
    v_mfma_f32_16x16x32_bf16 v[200:203], a[216:219], a[40:43], v[200:203]
    v_exp_f32 v205, v205
    v_mfma_f32_16x16x32_bf16 v[200:203], a[220:223], a[44:47], v[200:203]
    v_exp_f32 v206, v206
    v_mfma_f32_16x16x32_bf16 v[128:131], v[208:211], v[196:199], v[128:131]
    s_waitcnt lgkmcnt(3)
    v_exp_f32 v207, v207
    v_mfma_f32_16x16x32_bf16 v[4:7], v[212:215], v[180:183], v[4:7]
    ds_write_b64 v254, v[250:251] offset:24712
    v_mfma_f32_16x16x32_bf16 v[36:39], v[212:215], v[184:187], v[36:39]
    buffer_load_dwordx4 v[248:251], v234, s[12:15], s40 offen offset:2048 nt
    v_mfma_f32_16x16x32_bf16 v[68:71], v[212:215], v[188:191], v[68:71]
    ds_read_b64_tr_b16 v[220:221], v225 offset:4104
    v_cvt_pk_bf16_f32 v164, v204, v205
    v_cvt_pk_bf16_f32 v165, v206, v207
    v_mfma_f32_16x16x32_bf16 v[204:207], a[160:163], a[48:51], 0
    v_exp_f32 v200, v200
    v_mfma_f32_16x16x32_bf16 v[204:207], a[212:215], a[52:55], v[204:207]
    ds_read_b64_tr_b16 v[222:223], v225 offset:6152
    v_mfma_f32_16x16x32_bf16 v[204:207], a[216:219], a[56:59], v[204:207]
    v_exp_f32 v201, v201
    v_mfma_f32_16x16x32_bf16 v[204:207], a[220:223], a[60:63], v[204:207]
    v_exp_f32 v202, v202
    v_mfma_f32_16x16x32_bf16 v[100:103], v[212:215], v[192:195], v[100:103]
    v_exp_f32 v203, v203
    v_mfma_f32_16x16x32_bf16 v[132:135], v[212:215], v[196:199], v[132:135]
    s_waitcnt lgkmcnt(3)
    ds_read_b64_tr_b16 v[208:209], v224 offset:36864
    v_cvt_pk_bf16_f32 v168, v200, v201
    v_mfma_f32_16x16x32_bf16 v[8:11], v[216:219], v[180:183], v[8:11]
    ds_read_b64_tr_b16 v[210:211], v224 offset:38912
    v_cvt_pk_bf16_f32 v169, v202, v203
    v_mfma_f32_16x16x32_bf16 v[40:43], v[216:219], v[184:187], v[40:43]
    v_mfma_f32_16x16x32_bf16 v[200:203], a[160:163], a[64:67], 0
    v_exp_f32 v204, v204
    v_mfma_f32_16x16x32_bf16 v[200:203], a[212:215], a[68:71], v[200:203]
    v_exp_f32 v205, v205
    v_mfma_f32_16x16x32_bf16 v[200:203], a[216:219], a[72:75], v[200:203]
    v_exp_f32 v206, v206
    v_mfma_f32_16x16x32_bf16 v[200:203], a[220:223], a[76:79], v[200:203]
    s_waitcnt vmcnt(6) lgkmcnt(4)
    s_barrier
    ds_read_b128 a[168:171], v228 offset:24576
    v_cvt_pk_bf16_f32 v172, v204, v205
    v_mfma_f32_16x16x32_bf16 v[72:75], v[216:219], v[188:191], v[72:75]
    v_exp_f32 v207, v207
    v_mfma_f32_16x16x32_bf16 v[104:107], v[216:219], v[192:195], v[104:107]
    ds_read_b128 a[212:215], v229 offset:24576
    v_cvt_pk_bf16_f32 v173, v206, v207
    v_mfma_f32_16x16x32_bf16 v[136:139], v[216:219], v[196:199], v[136:139]
    s_waitcnt lgkmcnt(4)
    ds_read_b64_tr_b16 v[212:213], v224 offset:36872
    v_mfma_f32_16x16x32_bf16 v[12:15], v[220:223], v[180:183], v[12:15]
    ds_read_b64_tr_b16 v[214:215], v224 offset:38920
    v_mfma_f32_16x16x32_bf16 v[204:207], a[164:167], a[0:3], 0
    s_add_u32 s41, s41, 8192
    v_exp_f32 v200, v200
    v_mfma_f32_16x16x32_bf16 v[204:207], a[228:231], a[4:7], v[204:207]
    s_waitcnt vmcnt(5)
    s_add_u32 m0, s42, 81920
    ds_read_b128 a[216:219], v235 offset:24576
    v_lshlrev_b32 v252, 16, v236
    v_mfma_f32_16x16x32_bf16 v[204:207], a[232:235], a[8:11], v[204:207]
    v_exp_f32 v201, v201
    v_mfma_f32_16x16x32_bf16 v[204:207], a[236:239], a[12:15], v[204:207]
L_pad3:
    s_cbranch_vccnz L_pad7
    buffer_load_dwordx4 v234, s[16:19], s41 offen offset:0 nt lds
    v_mfma_f32_16x16x32_bf16 v[44:47], v[220:223], v[184:187], v[44:47]
    s_add_u32 m0, s42, 114560
    v_exp_f32 v202, v202
    v_mfma_f32_16x16x32_bf16 v[76:79], v[220:223], v[188:191], v[76:79]
    ds_read_b128 a[220:223], v231 offset:24576
    v_and_b32 v236, s26, v236
    v_mul_f32 v252, s25, v252
    v_mul_f32 v236, s25, v236
    v_cvt_pk_bf16_f32 v236, v252, v236
    v_mfma_f32_16x16x32_bf16 v[108:111], v[220:223], v[192:195], v[108:111]
    v_exp_f32 v203, v203
    v_mfma_f32_16x16x32_bf16 v[140:143], v[220:223], v[196:199], v[140:143]
    ds_read_b64_tr_b16 v[216:217], v225 offset:36864
    v_cvt_pk_bf16_f32 v176, v200, v201
    v_cvt_pk_bf16_f32 v177, v202, v203
    v_mfma_f32_16x16x32_bf16 v[200:203], a[164:167], a[16:19], 0
    v_exp_f32 v204, v204
    v_mfma_f32_16x16x32_bf16 v[200:203], a[228:231], a[20:23], v[200:203]
    buffer_load_dwordx4 v234, s[16:19], s41 offen offset:128 nt lds
    v_mfma_f32_16x16x32_bf16 v[200:203], a[232:235], a[24:27], v[200:203]
    v_exp_f32 v205, v205
    v_mfma_f32_16x16x32_bf16 v[200:203], a[236:239], a[28:31], v[200:203]
    s_waitcnt lgkmcnt(7)
    ds_read_b64_tr_b16 v[218:219], v225 offset:38912
    v_lshlrev_b32 v253, 16, v237
    v_mfma_f32_16x16x32_bf16 v[16:19], v[208:211], v[180:183], v[16:19]
    v_exp_f32 v206, v206
    v_mfma_f32_16x16x32_bf16 v[48:51], v[208:211], v[184:187], v[48:51]
    ds_read_b128 a[172:175], v228 offset:28672
    v_and_b32 v237, s26, v237
    v_mul_f32 v253, s25, v253
    v_mul_f32 v237, s25, v237
    v_cvt_pk_bf16_f32 v237, v253, v237
    v_mfma_f32_16x16x32_bf16 v[80:83], v[208:211], v[188:191], v[80:83]
    v_exp_f32 v207, v207
    v_mfma_f32_16x16x32_bf16 v[112:115], v[208:211], v[192:195], v[112:115]
    v_cvt_pk_bf16_f32 v162, v204, v205
    v_cvt_pk_bf16_f32 v163, v206, v207
    v_smfmac_f32_16x16x64_bf16 a[244:247], a[252:255], v[188:195], v233
    ds_write_b64 v254, v[236:237] offset:0
    v_mfma_f32_16x16x32_bf16 v[204:207], a[164:167], a[32:35], 0
    v_exp_f32 v200, v200
    v_mfma_f32_16x16x32_bf16 v[204:207], a[228:231], a[36:39], v[204:207]
    v_lshlrev_b32 v252, 16, v238
    v_and_b32 v238, s26, v238
    v_mfma_f32_16x16x32_bf16 v[204:207], a[232:235], a[40:43], v[204:207]
    v_exp_f32 v201, v201
    v_mfma_f32_16x16x32_bf16 v[204:207], a[236:239], a[44:47], v[204:207]
    v_mul_f32 v252, s25, v252
    v_mul_f32 v238, s25, v238
    v_mfma_f32_16x16x32_bf16 v[144:147], v[208:211], v[196:199], v[144:147]
    s_waitcnt lgkmcnt(6)
    v_exp_f32 v202, v202
    v_cvt_pk_bf16_f32 v238, v252, v238
    v_mfma_f32_16x16x32_bf16 v[20:23], v[212:215], v[180:183], v[20:23]
    ds_read_b64_tr_b16 v[220:221], v225 offset:36872
    v_cvt_pk_bf16_f32 v166, v200, v201
    v_mfma_f32_16x16x32_bf16 v[52:55], v[212:215], v[184:187], v[52:55]
    v_exp_f32 v203, v203
    v_mfma_f32_16x16x32_bf16 v[84:87], v[212:215], v[188:191], v[84:87]
    ds_read_b64_tr_b16 v[222:223], v225 offset:38920
    v_cvt_pk_bf16_f32 v167, v202, v203
    v_mfma_f32_16x16x32_bf16 v[200:203], a[164:167], a[48:51], 0
    v_exp_f32 v204, v204
    v_mfma_f32_16x16x32_bf16 v[200:203], a[228:231], a[52:55], v[200:203]
    v_lshlrev_b32 v253, 16, v239
    v_and_b32 v239, s26, v239
    v_mfma_f32_16x16x32_bf16 v[200:203], a[232:235], a[56:59], v[200:203]
    v_exp_f32 v205, v205
    v_mfma_f32_16x16x32_bf16 v[200:203], a[236:239], a[60:63], v[200:203]
    v_mul_f32 v253, s25, v253
    v_mul_f32 v239, s25, v239
    v_mfma_f32_16x16x32_bf16 v[116:119], v[212:215], v[192:195], v[116:119]
    v_exp_f32 v206, v206
    v_cvt_pk_bf16_f32 v239, v253, v239
    v_mfma_f32_16x16x32_bf16 v[148:151], v[212:215], v[196:199], v[148:151]
    s_waitcnt lgkmcnt(4)
    ds_read_b64_tr_b16 v[208:209], v224 offset:8192
    v_cvt_pk_bf16_f32 v170, v204, v205
    v_mfma_f32_16x16x32_bf16 v[24:27], v[216:219], v[180:183], v[24:27]
    v_exp_f32 v207, v207
    v_mfma_f32_16x16x32_bf16 v[56:59], v[216:219], v[184:187], v[56:59]
    ds_write_b64 v254, v[238:239] offset:8
    v_smfmac_f32_16x16x64_bf16 a[248:251], a[252:255], v[192:199], v233
    ds_read_b64_tr_b16 v[210:211], v224 offset:10240
    v_cvt_pk_bf16_f32 v171, v206, v207
    v_mfma_f32_16x16x32_bf16 v[204:207], a[164:167], a[64:67], 0
    v_exp_f32 v200, v200
    v_mfma_f32_16x16x32_bf16 v[204:207], a[228:231], a[68:71], v[204:207]
    s_waitcnt vmcnt(6)
    ds_read_b128 a[228:231], v229 offset:28672
    v_lshlrev_b32 v252, 16, v240
    v_mfma_f32_16x16x32_bf16 v[204:207], a[232:235], a[72:75], v[204:207]
    v_exp_f32 v201, v201
    v_mfma_f32_16x16x32_bf16 v[204:207], a[236:239], a[76:79], v[204:207]
    ds_read_b128 a[232:235], v235 offset:28672
    v_and_b32 v240, s26, v240
    v_mul_f32 v252, s25, v252
    v_mul_f32 v240, s25, v240
    v_cvt_pk_bf16_f32 v240, v252, v240
    v_mfma_f32_16x16x32_bf16 v[88:91], v[216:219], v[188:191], v[88:91]
    v_exp_f32 v202, v202
    v_mfma_f32_16x16x32_bf16 v[120:123], v[216:219], v[192:195], v[120:123]
    ds_read_b128 a[236:239], v231 offset:28672
    v_cvt_pk_bf16_f32 v174, v200, v201
    v_mfma_f32_16x16x32_bf16 v[152:155], v[216:219], v[196:199], v[152:155]
    s_waitcnt lgkmcnt(6)
    v_exp_f32 v203, v203
    v_mfma_f32_16x16x32_bf16 v[28:31], v[220:223], v[180:183], v[28:31]
    ds_read_b64_tr_b16 v[212:213], v224 offset:8200
    v_cvt_pk_bf16_f32 v175, v202, v203
    v_mfma_f32_16x16x32_bf16 v[200:203], a[168:171], a[0:3], 0
    s_add_u32 s40, s40, 8192
    v_exp_f32 v204, v204
    v_mfma_f32_16x16x32_bf16 v[200:203], a[212:215], a[4:7], v[200:203]
    buffer_load_dwordx4 v[236:239], v234, s[12:15], s40 offen offset:0 nt
    v_mfma_f32_16x16x32_bf16 v[200:203], a[216:219], a[8:11], v[200:203]
    v_exp_f32 v205, v205
    v_mfma_f32_16x16x32_bf16 v[200:203], a[220:223], a[12:15], v[200:203]
    ds_read_b64_tr_b16 v[214:215], v224 offset:10248
    v_lshlrev_b32 v253, 16, v241
    v_and_b32 v241, s26, v241
    v_mul_f32 v253, s25, v253
    v_mul_f32 v241, s25, v241
    v_cvt_pk_bf16_f32 v241, v253, v241
    v_mfma_f32_16x16x32_bf16 v[60:63], v[220:223], v[184:187], v[60:63]
    v_exp_f32 v206, v206
    v_mfma_f32_16x16x32_bf16 v[92:95], v[220:223], v[188:191], v[92:95]
    v_exp_f32 v207, v207
    v_mfma_f32_16x16x32_bf16 v[124:127], v[220:223], v[192:195], v[124:127]
    ds_write_b64 v254, v[240:241] offset:128
    v_mfma_f32_16x16x32_bf16 v[156:159], v[220:223], v[196:199], v[156:159]
    ds_read_b64_tr_b16 v[216:217], v225 offset:8192
    v_cvt_pk_bf16_f32 v178, v204, v205
    v_cvt_pk_bf16_f32 v179, v206, v207
    v_mfma_f32_16x16x32_bf16 v[204:207], a[168:171], a[16:19], 0
    v_exp_f32 v200, v200
    v_mfma_f32_16x16x32_bf16 v[204:207], a[212:215], a[20:23], v[204:207]
    ds_read_b64_tr_b16 v[218:219], v225 offset:10240
    v_lshlrev_b32 v252, 16, v242
    v_mfma_f32_16x16x32_bf16 v[204:207], a[216:219], a[24:27], v[204:207]
    v_exp_f32 v201, v201
    v_mfma_f32_16x16x32_bf16 v[204:207], a[220:223], a[28:31], v[204:207]
    s_waitcnt lgkmcnt(8)
    v_and_b32 v242, s26, v242
    v_mul_f32 v252, s25, v252
    v_mul_f32 v242, s25, v242
    v_cvt_pk_bf16_f32 v242, v252, v242
    v_mfma_f32_16x16x32_bf16 v[0:3], v[208:211], v[160:163], v[0:3]
    v_exp_f32 v202, v202
    v_mfma_f32_16x16x32_bf16 v[32:35], v[208:211], v[164:167], v[32:35]
    v_lshlrev_b32 v253, 16, v243
    v_cvt_pk_bf16_f32 v180, v200, v201
    v_mfma_f32_16x16x32_bf16 v[64:67], v[208:211], v[168:171], v[64:67]
    v_exp_f32 v203, v203
    v_mfma_f32_16x16x32_bf16 v[96:99], v[208:211], v[172:175], v[96:99]
    v_cvt_pk_bf16_f32 v181, v202, v203
    v_and_b32 v243, s26, v243
    v_smfmac_f32_16x16x64_bf16 a[240:243], a[252:255], v[160:167], v233
    v_mul_f32 v253, s25, v253
    v_mul_f32 v243, s25, v243
    v_mfma_f32_16x16x32_bf16 v[200:203], a[168:171], a[32:35], 0
    v_exp_f32 v204, v204
    v_mfma_f32_16x16x32_bf16 v[200:203], a[212:215], a[36:39], v[200:203]
    v_cvt_pk_bf16_f32 v243, v253, v243
    v_mfma_f32_16x16x32_bf16 v[200:203], a[216:219], a[40:43], v[200:203]
    v_exp_f32 v205, v205
    v_mfma_f32_16x16x32_bf16 v[200:203], a[220:223], a[44:47], v[200:203]
    v_exp_f32 v206, v206
    v_mfma_f32_16x16x32_bf16 v[128:131], v[208:211], v[176:179], v[128:131]
    s_waitcnt lgkmcnt(3)
    v_exp_f32 v207, v207
    v_mfma_f32_16x16x32_bf16 v[4:7], v[212:215], v[160:163], v[4:7]
    ds_write_b64 v254, v[242:243] offset:136
    v_mfma_f32_16x16x32_bf16 v[36:39], v[212:215], v[164:167], v[36:39]
    buffer_load_dwordx4 v[240:243], v234, s[12:15], s40 offen offset:2048 nt
    v_mfma_f32_16x16x32_bf16 v[68:71], v[212:215], v[168:171], v[68:71]
    ds_read_b64_tr_b16 v[220:221], v225 offset:8200
    v_cvt_pk_bf16_f32 v184, v204, v205
    v_cvt_pk_bf16_f32 v185, v206, v207
    v_mfma_f32_16x16x32_bf16 v[204:207], a[168:171], a[48:51], 0
    v_exp_f32 v200, v200
    v_mfma_f32_16x16x32_bf16 v[204:207], a[212:215], a[52:55], v[204:207]
    ds_read_b64_tr_b16 v[222:223], v225 offset:10248
    v_mfma_f32_16x16x32_bf16 v[204:207], a[216:219], a[56:59], v[204:207]
    v_exp_f32 v201, v201
    v_mfma_f32_16x16x32_bf16 v[204:207], a[220:223], a[60:63], v[204:207]
    v_exp_f32 v202, v202
    v_mfma_f32_16x16x32_bf16 v[100:103], v[212:215], v[172:175], v[100:103]
    v_exp_f32 v203, v203
    v_mfma_f32_16x16x32_bf16 v[132:135], v[212:215], v[176:179], v[132:135]
    s_waitcnt lgkmcnt(3)
    ds_read_b64_tr_b16 v[208:209], v224 offset:40960
    v_cvt_pk_bf16_f32 v188, v200, v201
    v_mfma_f32_16x16x32_bf16 v[8:11], v[216:219], v[160:163], v[8:11]
    ds_read_b64_tr_b16 v[210:211], v224 offset:43008
    v_cvt_pk_bf16_f32 v189, v202, v203
    v_mfma_f32_16x16x32_bf16 v[40:43], v[216:219], v[164:167], v[40:43]
    v_mfma_f32_16x16x32_bf16 v[200:203], a[168:171], a[64:67], 0
    v_exp_f32 v204, v204
    v_mfma_f32_16x16x32_bf16 v[200:203], a[212:215], a[68:71], v[200:203]
    v_exp_f32 v205, v205
    v_mfma_f32_16x16x32_bf16 v[200:203], a[216:219], a[72:75], v[200:203]
    v_exp_f32 v206, v206
    v_mfma_f32_16x16x32_bf16 v[200:203], a[220:223], a[76:79], v[200:203]
    s_waitcnt vmcnt(6) lgkmcnt(4)
    s_barrier
    ds_read_b128 a[176:179], v228 offset:0
    v_cvt_pk_bf16_f32 v192, v204, v205
    v_mfma_f32_16x16x32_bf16 v[72:75], v[216:219], v[168:171], v[72:75]
    v_exp_f32 v207, v207
    v_mfma_f32_16x16x32_bf16 v[104:107], v[216:219], v[172:175], v[104:107]
    ds_read_b128 a[212:215], v229 offset:0
    v_cvt_pk_bf16_f32 v193, v206, v207
    v_mfma_f32_16x16x32_bf16 v[136:139], v[216:219], v[176:179], v[136:139]
    s_waitcnt lgkmcnt(4)
    ds_read_b64_tr_b16 v[212:213], v224 offset:40968
    v_mfma_f32_16x16x32_bf16 v[12:15], v[220:223], v[160:163], v[12:15]
    ds_read_b64_tr_b16 v[214:215], v224 offset:43016
    v_mfma_f32_16x16x32_bf16 v[204:207], a[172:175], a[0:3], 0
    s_add_u32 s41, s41, 8192
    v_exp_f32 v200, v200
    v_mfma_f32_16x16x32_bf16 v[204:207], a[228:231], a[4:7], v[204:207]
    s_waitcnt vmcnt(5)
    s_add_u32 m0, s42, 86016
    ds_read_b128 a[216:219], v235 offset:0
    v_lshlrev_b32 v252, 16, v244
    v_mfma_f32_16x16x32_bf16 v[204:207], a[232:235], a[8:11], v[204:207]
    v_exp_f32 v201, v201
    v_mfma_f32_16x16x32_bf16 v[204:207], a[236:239], a[12:15], v[204:207]
    buffer_load_dwordx4 v234, s[16:19], s41 offen offset:0 nt lds
    v_mfma_f32_16x16x32_bf16 v[44:47], v[220:223], v[164:167], v[44:47]
    s_add_u32 m0, s42, 118656
    v_exp_f32 v202, v202
    v_mfma_f32_16x16x32_bf16 v[76:79], v[220:223], v[168:171], v[76:79]
    ds_read_b128 a[220:223], v231 offset:0
    v_and_b32 v244, s26, v244
    v_mul_f32 v252, s25, v252
    v_mul_f32 v244, s25, v244
    v_cvt_pk_bf16_f32 v244, v252, v244
    v_mfma_f32_16x16x32_bf16 v[108:111], v[220:223], v[172:175], v[108:111]
    v_exp_f32 v203, v203
    v_mfma_f32_16x16x32_bf16 v[140:143], v[220:223], v[176:179], v[140:143]
    ds_read_b64_tr_b16 v[216:217], v225 offset:40960
    v_cvt_pk_bf16_f32 v196, v200, v201
    v_cvt_pk_bf16_f32 v197, v202, v203
    v_mfma_f32_16x16x32_bf16 v[200:203], a[172:175], a[16:19], 0
    v_exp_f32 v204, v204
    v_mfma_f32_16x16x32_bf16 v[200:203], a[228:231], a[20:23], v[200:203]
    buffer_load_dwordx4 v234, s[16:19], s41 offen offset:128 nt lds
    v_mfma_f32_16x16x32_bf16 v[200:203], a[232:235], a[24:27], v[200:203]
    v_exp_f32 v205, v205
    v_mfma_f32_16x16x32_bf16 v[200:203], a[236:239], a[28:31], v[200:203]
    s_waitcnt lgkmcnt(7)
    ds_read_b64_tr_b16 v[218:219], v225 offset:43008
    v_lshlrev_b32 v253, 16, v245
    v_mfma_f32_16x16x32_bf16 v[16:19], v[208:211], v[160:163], v[16:19]
    v_exp_f32 v206, v206
    v_mfma_f32_16x16x32_bf16 v[48:51], v[208:211], v[164:167], v[48:51]
    ds_read_b128 a[180:183], v228 offset:4096
    v_and_b32 v245, s26, v245
    v_mul_f32 v253, s25, v253
    v_mul_f32 v245, s25, v245
    v_cvt_pk_bf16_f32 v245, v253, v245
    v_mfma_f32_16x16x32_bf16 v[80:83], v[208:211], v[168:171], v[80:83]
    v_exp_f32 v207, v207
    v_mfma_f32_16x16x32_bf16 v[112:115], v[208:211], v[172:175], v[112:115]
    s_add_u32 s43, s35, s28
    buffer_load_dwordx4 a[208:211], v230, s[8:11], s43 offen nt
    v_smfmac_f32_16x16x64_bf16 a[244:247], a[252:255], v[168:175], v233
    ds_write_b64 v254, v[244:245] offset:8192
    v_cvt_pk_bf16_f32 v182, v204, v205
    v_cvt_pk_bf16_f32 v183, v206, v207
    v_mfma_f32_16x16x32_bf16 v[204:207], a[172:175], a[32:35], 0
    v_exp_f32 v200, v200
    v_mfma_f32_16x16x32_bf16 v[204:207], a[228:231], a[36:39], v[204:207]
    v_lshlrev_b32 v252, 16, v246
    v_and_b32 v246, s26, v246
    v_mfma_f32_16x16x32_bf16 v[204:207], a[232:235], a[40:43], v[204:207]
    v_exp_f32 v201, v201
    v_mfma_f32_16x16x32_bf16 v[204:207], a[236:239], a[44:47], v[204:207]
    v_mul_f32 v252, s25, v252
    v_mul_f32 v246, s25, v246
    v_mfma_f32_16x16x32_bf16 v[144:147], v[208:211], v[176:179], v[144:147]
    s_waitcnt lgkmcnt(6)
    v_exp_f32 v202, v202
    v_cvt_pk_bf16_f32 v246, v252, v246
    v_mfma_f32_16x16x32_bf16 v[20:23], v[212:215], v[160:163], v[20:23]
    ds_read_b64_tr_b16 v[220:221], v225 offset:40968
    v_cvt_pk_bf16_f32 v186, v200, v201
    v_mfma_f32_16x16x32_bf16 v[52:55], v[212:215], v[164:167], v[52:55]
    v_exp_f32 v203, v203
    v_mfma_f32_16x16x32_bf16 v[84:87], v[212:215], v[168:171], v[84:87]
    ds_read_b64_tr_b16 v[222:223], v225 offset:43016
    v_cvt_pk_bf16_f32 v187, v202, v203
    v_mfma_f32_16x16x32_bf16 v[200:203], a[172:175], a[48:51], 0
    v_exp_f32 v204, v204
    v_mfma_f32_16x16x32_bf16 v[200:203], a[228:231], a[52:55], v[200:203]
    v_lshlrev_b32 v253, 16, v247
    v_and_b32 v247, s26, v247
    v_mfma_f32_16x16x32_bf16 v[200:203], a[232:235], a[56:59], v[200:203]
    v_exp_f32 v205, v205
    v_mfma_f32_16x16x32_bf16 v[200:203], a[236:239], a[60:63], v[200:203]
    v_mul_f32 v253, s25, v253
    v_mul_f32 v247, s25, v247
    v_mfma_f32_16x16x32_bf16 v[116:119], v[212:215], v[172:175], v[116:119]
    v_exp_f32 v206, v206
    v_cvt_pk_bf16_f32 v247, v253, v247
    v_mfma_f32_16x16x32_bf16 v[148:151], v[212:215], v[176:179], v[148:151]
    s_waitcnt lgkmcnt(4)
    s_add_u32 s43, s35, s46
    buffer_load_dwordx4 a[224:227], v230, s[8:11], s43 offen nt
    v_mfma_f32_16x16x32_bf16 v[24:27], v[216:219], v[160:163], v[24:27]
    v_exp_f32 v207, v207
    v_mfma_f32_16x16x32_bf16 v[56:59], v[216:219], v[164:167], v[56:59]
    ds_write_b64 v254, v[246:247] offset:8200
    v_smfmac_f32_16x16x64_bf16 a[248:251], a[252:255], v[172:179], v233
    ds_read_b64_tr_b16 v[208:209], v224 offset:12288
    v_cvt_pk_bf16_f32 v190, v204, v205
    v_cvt_pk_bf16_f32 v191, v206, v207
    v_mfma_f32_16x16x32_bf16 v[204:207], a[172:175], a[64:67], 0
    v_exp_f32 v200, v200
    v_mfma_f32_16x16x32_bf16 v[204:207], a[228:231], a[68:71], v[204:207]
    s_waitcnt vmcnt(8)
    ds_read_b64_tr_b16 v[210:211], v224 offset:14336
    v_lshlrev_b32 v252, 16, v248
    v_mfma_f32_16x16x32_bf16 v[204:207], a[232:235], a[72:75], v[204:207]
    v_exp_f32 v201, v201
    v_mfma_f32_16x16x32_bf16 v[204:207], a[236:239], a[76:79], v[204:207]
    ds_read_b128 a[228:231], v229 offset:4096
    v_and_b32 v248, s26, v248
    v_mul_f32 v252, s25, v252
    v_mul_f32 v248, s25, v248
    v_cvt_pk_bf16_f32 v248, v252, v248
    v_mfma_f32_16x16x32_bf16 v[88:91], v[216:219], v[168:171], v[88:91]
    v_exp_f32 v202, v202
    v_mfma_f32_16x16x32_bf16 v[120:123], v[216:219], v[172:175], v[120:123]
    ds_read_b128 a[232:235], v235 offset:4096
    v_cvt_pk_bf16_f32 v194, v200, v201
    v_mfma_f32_16x16x32_bf16 v[152:155], v[216:219], v[176:179], v[152:155]
    s_waitcnt lgkmcnt(5)
    v_exp_f32 v203, v203
    v_mfma_f32_16x16x32_bf16 v[28:31], v[220:223], v[160:163], v[28:31]
    ds_read_b64_tr_b16 v[212:213], v224 offset:12296
    v_cvt_pk_bf16_f32 v195, v202, v203
L_p12:
    v_mfma_f32_16x16x32_bf16 v[200:203], a[176:179], a[0:3], 0
    s_add_u32 s40, s40, 8192
    v_exp_f32 v204, v204
    v_mfma_f32_16x16x32_bf16 v[200:203], a[212:215], a[4:7], v[200:203]
    ds_read_b64_tr_b16 v[214:215], v224 offset:14344
    v_lshlrev_b32 v253, 16, v249
    v_mfma_f32_16x16x32_bf16 v[200:203], a[216:219], a[8:11], v[200:203]
    v_exp_f32 v205, v205
    v_mfma_f32_16x16x32_bf16 v[200:203], a[220:223], a[12:15], v[200:203]
    buffer_load_dwordx4 v[244:247], v234, s[12:15], s40 offen offset:0 nt
    v_and_b32 v249, s26, v249
    v_mul_f32 v253, s25, v253
    v_mul_f32 v249, s25, v249
    v_cvt_pk_bf16_f32 v249, v253, v249
    v_mfma_f32_16x16x32_bf16 v[60:63], v[220:223], v[164:167], v[60:63]
    v_exp_f32 v206, v206
    v_mfma_f32_16x16x32_bf16 v[92:95], v[220:223], v[168:171], v[92:95]
    ds_read_b128 a[236:239], v231 offset:4096
    v_cvt_pk_bf16_f32 v198, v204, v205
    v_mfma_f32_16x16x32_bf16 v[124:127], v[220:223], v[172:175], v[124:127]
    ds_write_b64 v254, v[248:249] offset:8320
    v_mfma_f32_16x16x32_bf16 v[156:159], v[220:223], v[176:179], v[156:159]
    ds_read_b64_tr_b16 v[216:217], v225 offset:12288
    v_lshlrev_b32 v252, 16, v250
    v_exp_f32 v207, v207
    v_and_b32 v250, s26, v250
    v_cvt_pk_bf16_f32 v199, v206, v207
    v_mfma_f32_16x16x32_bf16 v[204:207], a[176:179], a[16:19], 0
    v_exp_f32 v200, v200
    v_mfma_f32_16x16x32_bf16 v[204:207], a[212:215], a[20:23], v[204:207]
    ds_read_b64_tr_b16 v[218:219], v225 offset:14336
    v_mul_f32 v252, s25, v252
    v_mfma_f32_16x16x32_bf16 v[204:207], a[216:219], a[24:27], v[204:207]
    v_exp_f32 v201, v201
    v_mfma_f32_16x16x32_bf16 v[204:207], a[220:223], a[28:31], v[204:207]
    s_waitcnt lgkmcnt(8)
    v_mul_f32 v250, s25, v250
    v_cvt_pk_bf16_f32 v250, v252, v250
    v_mfma_f32_16x16x32_bf16 v[0:3], v[208:211], v[180:183], v[0:3]
    v_exp_f32 v202, v202
    v_mfma_f32_16x16x32_bf16 v[32:35], v[208:211], v[184:187], v[32:35]
    v_lshlrev_b32 v253, 16, v251
    v_cvt_pk_bf16_f32 v160, v200, v201
    v_mfma_f32_16x16x32_bf16 v[64:67], v[208:211], v[188:191], v[64:67]
    v_exp_f32 v203, v203
    v_mfma_f32_16x16x32_bf16 v[96:99], v[208:211], v[192:195], v[96:99]
    v_cvt_pk_bf16_f32 v161, v202, v203
    v_and_b32 v251, s26, v251
    v_smfmac_f32_16x16x64_bf16 a[240:243], a[252:255], v[180:187], v233
    v_mul_f32 v253, s25, v253
    v_mul_f32 v251, s25, v251
    v_mfma_f32_16x16x32_bf16 v[200:203], a[176:179], a[32:35], 0
    v_exp_f32 v204, v204
    v_mfma_f32_16x16x32_bf16 v[200:203], a[212:215], a[36:39], v[200:203]
    v_cvt_pk_bf16_f32 v251, v253, v251
    v_mfma_f32_16x16x32_bf16 v[200:203], a[216:219], a[40:43], v[200:203]
    v_exp_f32 v205, v205
    v_mfma_f32_16x16x32_bf16 v[200:203], a[220:223], a[44:47], v[200:203]
    v_exp_f32 v206, v206
    v_mfma_f32_16x16x32_bf16 v[128:131], v[208:211], v[196:199], v[128:131]
    s_waitcnt lgkmcnt(4)
    v_exp_f32 v207, v207
    v_mfma_f32_16x16x32_bf16 v[4:7], v[212:215], v[180:183], v[4:7]
    ds_write_b64 v254, v[250:251] offset:8328
    v_mfma_f32_16x16x32_bf16 v[36:39], v[212:215], v[184:187], v[36:39]
    buffer_load_dwordx4 v[248:251], v234, s[12:15], s40 offen offset:2048 nt
    v_mfma_f32_16x16x32_bf16 v[68:71], v[212:215], v[188:191], v[68:71]
    ds_read_b64_tr_b16 v[220:221], v225 offset:12296
    v_cvt_pk_bf16_f32 v164, v204, v205
    v_cvt_pk_bf16_f32 v165, v206, v207
    v_mfma_f32_16x16x32_bf16 v[204:207], a[176:179], a[48:51], 0
    v_exp_f32 v200, v200
    v_mfma_f32_16x16x32_bf16 v[204:207], a[212:215], a[52:55], v[204:207]
    ds_read_b64_tr_b16 v[222:223], v225 offset:14344
    v_mfma_f32_16x16x32_bf16 v[204:207], a[216:219], a[56:59], v[204:207]
    v_exp_f32 v201, v201
    v_mfma_f32_16x16x32_bf16 v[204:207], a[220:223], a[60:63], v[204:207]
    v_exp_f32 v202, v202
    v_mfma_f32_16x16x32_bf16 v[100:103], v[212:215], v[192:195], v[100:103]
    v_exp_f32 v203, v203
    v_mfma_f32_16x16x32_bf16 v[132:135], v[212:215], v[196:199], v[132:135]
    s_waitcnt lgkmcnt(3)
    ds_read_b64_tr_b16 v[208:209], v224 offset:45056
    v_cvt_pk_bf16_f32 v168, v200, v201
    v_mfma_f32_16x16x32_bf16 v[8:11], v[216:219], v[180:183], v[8:11]
    ds_read_b64_tr_b16 v[210:211], v224 offset:47104
    v_cvt_pk_bf16_f32 v169, v202, v203
    v_mfma_f32_16x16x32_bf16 v[40:43], v[216:219], v[184:187], v[40:43]
    v_mfma_f32_16x16x32_bf16 v[200:203], a[176:179], a[64:67], 0
    v_exp_f32 v204, v204
    v_mfma_f32_16x16x32_bf16 v[200:203], a[212:215], a[68:71], v[200:203]
    v_exp_f32 v205, v205
    v_mfma_f32_16x16x32_bf16 v[200:203], a[216:219], a[72:75], v[200:203]
    v_exp_f32 v206, v206
    v_mfma_f32_16x16x32_bf16 v[200:203], a[220:223], a[76:79], v[200:203]
    s_waitcnt vmcnt(8) lgkmcnt(4)
    s_barrier
    ds_read_b128 a[184:187], v228 offset:8192
    v_cvt_pk_bf16_f32 v172, v204, v205
    v_mfma_f32_16x16x32_bf16 v[72:75], v[216:219], v[188:191], v[72:75]
    v_exp_f32 v207, v207
    v_mfma_f32_16x16x32_bf16 v[104:107], v[216:219], v[192:195], v[104:107]
    ds_read_b128 a[212:215], v229 offset:8192
    v_cvt_pk_bf16_f32 v173, v206, v207
    v_mfma_f32_16x16x32_bf16 v[136:139], v[216:219], v[196:199], v[136:139]
    s_waitcnt lgkmcnt(4)
    ds_read_b64_tr_b16 v[212:213], v224 offset:45064
    v_mfma_f32_16x16x32_bf16 v[12:15], v[220:223], v[180:183], v[12:15]
    ds_read_b64_tr_b16 v[214:215], v224 offset:47112
    v_mfma_f32_16x16x32_bf16 v[204:207], a[180:183], a[0:3], 0
    s_add_u32 s41, s41, 8192
    v_exp_f32 v200, v200
    v_mfma_f32_16x16x32_bf16 v[204:207], a[228:231], a[4:7], v[204:207]
    s_waitcnt vmcnt(7)
    s_add_u32 m0, s42, 90112
    ds_read_b128 a[216:219], v235 offset:8192
    v_lshlrev_b32 v252, 16, v236
    v_mfma_f32_16x16x32_bf16 v[204:207], a[232:235], a[8:11], v[204:207]
    v_exp_f32 v201, v201
    v_mfma_f32_16x16x32_bf16 v[204:207], a[236:239], a[12:15], v[204:207]
    buffer_load_dwordx4 v234, s[16:19], s41 offen offset:0 nt lds
    v_mfma_f32_16x16x32_bf16 v[44:47], v[220:223], v[184:187], v[44:47]
    s_add_u32 m0, s42, 122752
    v_exp_f32 v202, v202
    v_mfma_f32_16x16x32_bf16 v[76:79], v[220:223], v[188:191], v[76:79]
    ds_read_b128 a[220:223], v231 offset:8192
    v_and_b32 v236, s26, v236
    v_mul_f32 v252, s25, v252
    v_mul_f32 v236, s25, v236
    v_cvt_pk_bf16_f32 v236, v252, v236
    v_mfma_f32_16x16x32_bf16 v[108:111], v[220:223], v[192:195], v[108:111]
    v_exp_f32 v203, v203
    v_mfma_f32_16x16x32_bf16 v[140:143], v[220:223], v[196:199], v[140:143]
    ds_read_b64_tr_b16 v[216:217], v225 offset:45056
    v_cvt_pk_bf16_f32 v176, v200, v201
    v_cvt_pk_bf16_f32 v177, v202, v203
    v_mfma_f32_16x16x32_bf16 v[200:203], a[180:183], a[16:19], 0
    v_exp_f32 v204, v204
    v_mfma_f32_16x16x32_bf16 v[200:203], a[228:231], a[20:23], v[200:203]
    buffer_load_dwordx4 v234, s[16:19], s41 offen offset:128 nt lds
    v_mfma_f32_16x16x32_bf16 v[200:203], a[232:235], a[24:27], v[200:203]
    v_exp_f32 v205, v205
    v_mfma_f32_16x16x32_bf16 v[200:203], a[236:239], a[28:31], v[200:203]
    s_waitcnt lgkmcnt(7)
    ds_read_b64_tr_b16 v[218:219], v225 offset:47104
    v_lshlrev_b32 v253, 16, v237
    v_mfma_f32_16x16x32_bf16 v[16:19], v[208:211], v[180:183], v[16:19]
    v_exp_f32 v206, v206
    v_mfma_f32_16x16x32_bf16 v[48:51], v[208:211], v[184:187], v[48:51]
    ds_read_b128 a[188:191], v228 offset:12288
    v_and_b32 v237, s26, v237
    v_mul_f32 v253, s25, v253
    v_mul_f32 v237, s25, v237
    v_cvt_pk_bf16_f32 v237, v253, v237
    v_mfma_f32_16x16x32_bf16 v[80:83], v[208:211], v[188:191], v[80:83]
    v_exp_f32 v207, v207
    v_mfma_f32_16x16x32_bf16 v[112:115], v[208:211], v[192:195], v[112:115]
    v_cvt_pk_bf16_f32 v162, v204, v205
    v_cvt_pk_bf16_f32 v163, v206, v207
    v_smfmac_f32_16x16x64_bf16 a[244:247], a[252:255], v[188:195], v233
    ds_write_b64 v254, v[236:237] offset:16384
    v_mfma_f32_16x16x32_bf16 v[204:207], a[180:183], a[32:35], 0
    v_exp_f32 v200, v200
    v_mfma_f32_16x16x32_bf16 v[204:207], a[228:231], a[36:39], v[204:207]
    v_lshlrev_b32 v252, 16, v238
    v_and_b32 v238, s26, v238
    v_mfma_f32_16x16x32_bf16 v[204:207], a[232:235], a[40:43], v[204:207]
    v_exp_f32 v201, v201
    v_mfma_f32_16x16x32_bf16 v[204:207], a[236:239], a[44:47], v[204:207]
    v_mul_f32 v252, s25, v252
    v_mul_f32 v238, s25, v238
    v_mfma_f32_16x16x32_bf16 v[144:147], v[208:211], v[196:199], v[144:147]
    s_waitcnt lgkmcnt(6)
    v_exp_f32 v202, v202
    v_cvt_pk_bf16_f32 v238, v252, v238
    v_mfma_f32_16x16x32_bf16 v[20:23], v[212:215], v[180:183], v[20:23]
    ds_read_b64_tr_b16 v[220:221], v225 offset:45064
    v_cvt_pk_bf16_f32 v166, v200, v201
    v_mfma_f32_16x16x32_bf16 v[52:55], v[212:215], v[184:187], v[52:55]
    v_exp_f32 v203, v203
    v_mfma_f32_16x16x32_bf16 v[84:87], v[212:215], v[188:191], v[84:87]
    ds_read_b64_tr_b16 v[222:223], v225 offset:47112
    v_cvt_pk_bf16_f32 v167, v202, v203
    v_mfma_f32_16x16x32_bf16 v[200:203], a[180:183], a[48:51], 0
    v_exp_f32 v204, v204
    v_mfma_f32_16x16x32_bf16 v[200:203], a[228:231], a[52:55], v[200:203]
    v_lshlrev_b32 v253, 16, v239
    v_and_b32 v239, s26, v239
    v_mfma_f32_16x16x32_bf16 v[200:203], a[232:235], a[56:59], v[200:203]
    v_exp_f32 v205, v205
    v_mfma_f32_16x16x32_bf16 v[200:203], a[236:239], a[60:63], v[200:203]
    v_mul_f32 v253, s25, v253
    v_mul_f32 v239, s25, v239
    v_mfma_f32_16x16x32_bf16 v[116:119], v[212:215], v[192:195], v[116:119]
    v_exp_f32 v206, v206
    v_cvt_pk_bf16_f32 v239, v253, v239
    v_mfma_f32_16x16x32_bf16 v[148:151], v[212:215], v[196:199], v[148:151]
    s_waitcnt lgkmcnt(4)
    ds_read_b64_tr_b16 v[208:209], v224 offset:16384
    v_cvt_pk_bf16_f32 v170, v204, v205
    v_mfma_f32_16x16x32_bf16 v[24:27], v[216:219], v[180:183], v[24:27]
    v_exp_f32 v207, v207
    v_mfma_f32_16x16x32_bf16 v[56:59], v[216:219], v[184:187], v[56:59]
    ds_write_b64 v254, v[238:239] offset:16392
    v_smfmac_f32_16x16x64_bf16 a[248:251], a[252:255], v[192:199], v233
    ds_read_b64_tr_b16 v[210:211], v224 offset:18432
    v_cvt_pk_bf16_f32 v171, v206, v207
    v_mfma_f32_16x16x32_bf16 v[204:207], a[180:183], a[64:67], 0
    v_exp_f32 v200, v200
    v_mfma_f32_16x16x32_bf16 v[204:207], a[228:231], a[68:71], v[204:207]
    s_waitcnt vmcnt(8)
    ds_read_b128 a[228:231], v229 offset:12288
    v_lshlrev_b32 v252, 16, v240
    v_mfma_f32_16x16x32_bf16 v[204:207], a[232:235], a[72:75], v[204:207]
    v_exp_f32 v201, v201
    v_mfma_f32_16x16x32_bf16 v[204:207], a[236:239], a[76:79], v[204:207]
    ds_read_b128 a[232:235], v235 offset:12288
    v_and_b32 v240, s26, v240
    v_mul_f32 v252, s25, v252
    v_mul_f32 v240, s25, v240
    v_cvt_pk_bf16_f32 v240, v252, v240
    v_mfma_f32_16x16x32_bf16 v[88:91], v[216:219], v[188:191], v[88:91]
    v_exp_f32 v202, v202
    v_mfma_f32_16x16x32_bf16 v[120:123], v[216:219], v[192:195], v[120:123]
    ds_read_b128 a[236:239], v231 offset:12288
    v_cvt_pk_bf16_f32 v174, v200, v201
    v_mfma_f32_16x16x32_bf16 v[152:155], v[216:219], v[196:199], v[152:155]
    s_waitcnt lgkmcnt(6)
    v_exp_f32 v203, v203
    v_mfma_f32_16x16x32_bf16 v[28:31], v[220:223], v[180:183], v[28:31]
    ds_read_b64_tr_b16 v[212:213], v224 offset:16392
    v_cvt_pk_bf16_f32 v175, v202, v203
    v_mfma_f32_16x16x32_bf16 v[200:203], a[184:187], a[0:3], 0
    v_exp_f32 v204, v204
    v_mfma_f32_16x16x32_bf16 v[200:203], a[212:215], a[4:7], v[200:203]
    ds_read_b64_tr_b16 v[214:215], v224 offset:18440
    v_lshlrev_b32 v253, 16, v241
    v_mfma_f32_16x16x32_bf16 v[200:203], a[216:219], a[8:11], v[200:203]
    v_exp_f32 v205, v205
    v_mfma_f32_16x16x32_bf16 v[200:203], a[220:223], a[12:15], v[200:203]
    v_and_b32 v241, s26, v241
    v_mul_f32 v253, s25, v253
    v_mul_f32 v241, s25, v241
    v_cvt_pk_bf16_f32 v241, v253, v241
    v_mfma_f32_16x16x32_bf16 v[60:63], v[220:223], v[184:187], v[60:63]
    v_exp_f32 v206, v206
    v_mfma_f32_16x16x32_bf16 v[92:95], v[220:223], v[188:191], v[92:95]
    v_exp_f32 v207, v207
    v_mfma_f32_16x16x32_bf16 v[124:127], v[220:223], v[192:195], v[124:127]
    ds_write_b64 v254, v[240:241] offset:16512
    v_mfma_f32_16x16x32_bf16 v[156:159], v[220:223], v[196:199], v[156:159]
    ds_read_b64_tr_b16 v[216:217], v225 offset:16384
    v_cvt_pk_bf16_f32 v178, v204, v205
    v_cvt_pk_bf16_f32 v179, v206, v207
    v_mfma_f32_16x16x32_bf16 v[204:207], a[184:187], a[16:19], 0
    v_exp_f32 v200, v200
    v_mfma_f32_16x16x32_bf16 v[204:207], a[212:215], a[20:23], v[204:207]
    ds_read_b64_tr_b16 v[218:219], v225 offset:18432
    v_lshlrev_b32 v252, 16, v242
    v_mfma_f32_16x16x32_bf16 v[204:207], a[216:219], a[24:27], v[204:207]
    v_exp_f32 v201, v201
    v_mfma_f32_16x16x32_bf16 v[204:207], a[220:223], a[28:31], v[204:207]
    s_waitcnt lgkmcnt(8)
    v_and_b32 v242, s26, v242
    v_mul_f32 v252, s25, v252
    v_mul_f32 v242, s25, v242
    v_cvt_pk_bf16_f32 v242, v252, v242
    v_mfma_f32_16x16x32_bf16 v[0:3], v[208:211], v[160:163], v[0:3]
    v_exp_f32 v202, v202
    v_mfma_f32_16x16x32_bf16 v[32:35], v[208:211], v[164:167], v[32:35]
    v_lshlrev_b32 v253, 16, v243
    v_cvt_pk_bf16_f32 v180, v200, v201
    v_mfma_f32_16x16x32_bf16 v[64:67], v[208:211], v[168:171], v[64:67]
    v_exp_f32 v203, v203
    v_mfma_f32_16x16x32_bf16 v[96:99], v[208:211], v[172:175], v[96:99]
    v_cvt_pk_bf16_f32 v181, v202, v203
    v_and_b32 v243, s26, v243
    v_smfmac_f32_16x16x64_bf16 a[240:243], a[252:255], v[160:167], v233
    v_mul_f32 v253, s25, v253
    v_mul_f32 v243, s25, v243
    v_mfma_f32_16x16x32_bf16 v[200:203], a[184:187], a[32:35], 0
    v_exp_f32 v204, v204
    v_mfma_f32_16x16x32_bf16 v[200:203], a[212:215], a[36:39], v[200:203]
L_pad4:
    s_cbranch_vccnz L_pad8
    v_cvt_pk_bf16_f32 v243, v253, v243
    v_mfma_f32_16x16x32_bf16 v[200:203], a[216:219], a[40:43], v[200:203]
    v_exp_f32 v205, v205
    v_mfma_f32_16x16x32_bf16 v[200:203], a[220:223], a[44:47], v[200:203]
    v_exp_f32 v206, v206
    v_mfma_f32_16x16x32_bf16 v[128:131], v[208:211], v[176:179], v[128:131]
    s_waitcnt lgkmcnt(3)
    v_exp_f32 v207, v207
    v_mfma_f32_16x16x32_bf16 v[4:7], v[212:215], v[160:163], v[4:7]
    ds_write_b64 v254, v[242:243] offset:16520
    v_mfma_f32_16x16x32_bf16 v[36:39], v[212:215], v[164:167], v[36:39]
    s_add_u32 s43, s35, s47
    buffer_load_dwordx4 v[236:239], v230, s[8:11], s43 offen nt
    v_mfma_f32_16x16x32_bf16 v[68:71], v[212:215], v[168:171], v[68:71]
    ds_read_b64_tr_b16 v[220:221], v225 offset:16392
    v_cvt_pk_bf16_f32 v184, v204, v205
    v_cvt_pk_bf16_f32 v185, v206, v207
    v_mfma_f32_16x16x32_bf16 v[204:207], a[184:187], a[48:51], 0
    v_exp_f32 v200, v200
    v_mfma_f32_16x16x32_bf16 v[204:207], a[212:215], a[52:55], v[204:207]
    ds_read_b64_tr_b16 v[222:223], v225 offset:18440
    v_mfma_f32_16x16x32_bf16 v[204:207], a[216:219], a[56:59], v[204:207]
    v_exp_f32 v201, v201
    v_mfma_f32_16x16x32_bf16 v[204:207], a[220:223], a[60:63], v[204:207]
    v_exp_f32 v202, v202
    v_mfma_f32_16x16x32_bf16 v[100:103], v[212:215], v[172:175], v[100:103]
    v_exp_f32 v203, v203
    v_mfma_f32_16x16x32_bf16 v[132:135], v[212:215], v[176:179], v[132:135]
    s_waitcnt lgkmcnt(3)
    ds_read_b64_tr_b16 v[208:209], v224 offset:49152
    v_cvt_pk_bf16_f32 v188, v200, v201
    v_mfma_f32_16x16x32_bf16 v[8:11], v[216:219], v[160:163], v[8:11]
    ds_read_b64_tr_b16 v[210:211], v224 offset:51200
    v_cvt_pk_bf16_f32 v189, v202, v203
    v_mfma_f32_16x16x32_bf16 v[40:43], v[216:219], v[164:167], v[40:43]
    v_mfma_f32_16x16x32_bf16 v[200:203], a[184:187], a[64:67], 0
    v_exp_f32 v204, v204
    v_mfma_f32_16x16x32_bf16 v[200:203], a[212:215], a[68:71], v[200:203]
    v_exp_f32 v205, v205
    v_mfma_f32_16x16x32_bf16 v[200:203], a[216:219], a[72:75], v[200:203]
    v_exp_f32 v206, v206
    v_mfma_f32_16x16x32_bf16 v[200:203], a[220:223], a[76:79], v[200:203]
    s_waitcnt vmcnt(7) lgkmcnt(4)
    s_barrier
    ds_read_b128 a[192:195], v228 offset:16384
    v_cvt_pk_bf16_f32 v192, v204, v205
    v_mfma_f32_16x16x32_bf16 v[72:75], v[216:219], v[168:171], v[72:75]
    v_exp_f32 v207, v207
    v_mfma_f32_16x16x32_bf16 v[104:107], v[216:219], v[172:175], v[104:107]
    ds_read_b128 a[212:215], v229 offset:16384
    v_cvt_pk_bf16_f32 v193, v206, v207
    v_mfma_f32_16x16x32_bf16 v[136:139], v[216:219], v[176:179], v[136:139]
    s_waitcnt lgkmcnt(4)
    s_add_u32 s43, s35, s48
    buffer_load_dwordx4 v[240:243], v230, s[8:11], s43 offen nt
    v_mfma_f32_16x16x32_bf16 v[12:15], v[220:223], v[160:163], v[12:15]
    ds_write_b64 v228, a[80:81] offset:0
    v_mfma_f32_16x16x32_bf16 v[204:207], a[188:191], a[0:3], 0
    s_add_u32 s41, s41, 8192
    v_exp_f32 v200, v200
    v_mfma_f32_16x16x32_bf16 v[204:207], a[228:231], a[4:7], v[204:207]
    s_waitcnt vmcnt(5)
    s_add_u32 m0, s42, 94208
    ds_read_b64_tr_b16 v[212:213], v224 offset:49160
    v_lshlrev_b32 v252, 16, v244
    v_mfma_f32_16x16x32_bf16 v[204:207], a[232:235], a[8:11], v[204:207]
    v_exp_f32 v201, v201
    v_mfma_f32_16x16x32_bf16 v[204:207], a[236:239], a[12:15], v[204:207]
    ds_read_b64_tr_b16 v[214:215], v224 offset:51208
    v_and_b32 v244, s26, v244
    v_mfma_f32_16x16x32_bf16 v[44:47], v[220:223], v[164:167], v[44:47]
    v_exp_f32 v202, v202
    v_mfma_f32_16x16x32_bf16 v[76:79], v[220:223], v[168:171], v[76:79]
    ds_read_b128 a[216:219], v235 offset:16384
    v_mul_f32 v252, s25, v252
    v_mul_f32 v244, s25, v244
    v_cvt_pk_bf16_f32 v244, v252, v244
    v_mfma_f32_16x16x32_bf16 v[108:111], v[220:223], v[172:175], v[108:111]
    v_exp_f32 v203, v203
    v_mfma_f32_16x16x32_bf16 v[140:143], v[220:223], v[176:179], v[140:143]
    ds_read_b64_tr_b16 v[216:217], v225 offset:49152
    v_cvt_pk_bf16_f32 v196, v200, v201
    v_cvt_pk_bf16_f32 v197, v202, v203
    v_mfma_f32_16x16x32_bf16 v[200:203], a[188:191], a[16:19], 0
    v_exp_f32 v204, v204
    v_mfma_f32_16x16x32_bf16 v[200:203], a[228:231], a[20:23], v[200:203]
    ds_read_b64_tr_b16 v[218:219], v225 offset:51200
    v_lshlrev_b32 v253, 16, v245
    v_mfma_f32_16x16x32_bf16 v[200:203], a[232:235], a[24:27], v[200:203]
    v_exp_f32 v205, v205
    v_mfma_f32_16x16x32_bf16 v[200:203], a[236:239], a[28:31], v[200:203]
    s_waitcnt lgkmcnt(8)
    ds_read_b128 a[220:223], v231 offset:16384
    v_and_b32 v245, s26, v245
    v_mfma_f32_16x16x32_bf16 v[16:19], v[208:211], v[160:163], v[16:19]
    v_exp_f32 v206, v206
    v_mfma_f32_16x16x32_bf16 v[48:51], v[208:211], v[164:167], v[48:51]
    buffer_load_dwordx4 v234, s[16:19], s41 offen offset:0 nt lds
    v_mul_f32 v253, s25, v253
    v_mul_f32 v245, s25, v245
    v_cvt_pk_bf16_f32 v245, v253, v245
    v_mfma_f32_16x16x32_bf16 v[80:83], v[208:211], v[168:171], v[80:83]
    s_add_u32 m0, s42, 126848
    v_exp_f32 v207, v207
    v_mfma_f32_16x16x32_bf16 v[112:115], v[208:211], v[172:175], v[112:115]
    ds_read_b128 a[196:199], v228 offset:20480
    v_cvt_pk_bf16_f32 v182, v204, v205
    v_smfmac_f32_16x16x64_bf16 a[244:247], a[252:255], v[168:175], v233
    ds_write_b64 v254, v[244:245] offset:24576
    v_cvt_pk_bf16_f32 v183, v206, v207
    v_mfma_f32_16x16x32_bf16 v[204:207], a[188:191], a[32:35], 0
    v_exp_f32 v200, v200
    v_mfma_f32_16x16x32_bf16 v[204:207], a[228:231], a[36:39], v[204:207]
    buffer_load_dwordx4 v234, s[16:19], s41 offen offset:128 nt lds
    v_mfma_f32_16x16x32_bf16 v[204:207], a[232:235], a[40:43], v[204:207]
    v_exp_f32 v201, v201
    v_mfma_f32_16x16x32_bf16 v[204:207], a[236:239], a[44:47], v[204:207]
    v_lshlrev_b32 v252, 16, v246
    v_and_b32 v246, s26, v246
    v_mfma_f32_16x16x32_bf16 v[144:147], v[208:211], v[176:179], v[144:147]
    s_waitcnt lgkmcnt(6)
    v_exp_f32 v202, v202
    v_mul_f32 v252, s25, v252
    v_mul_f32 v246, s25, v246
    v_cvt_pk_bf16_f32 v246, v252, v246
    v_mfma_f32_16x16x32_bf16 v[20:23], v[212:215], v[160:163], v[20:23]
    ds_read_b64_tr_b16 v[220:221], v225 offset:49160
    v_cvt_pk_bf16_f32 v186, v200, v201
    v_mfma_f32_16x16x32_bf16 v[52:55], v[212:215], v[164:167], v[52:55]
    v_exp_f32 v203, v203
    v_mfma_f32_16x16x32_bf16 v[84:87], v[212:215], v[168:171], v[84:87]
    ds_read_b64_tr_b16 v[222:223], v225 offset:51208
    v_cvt_pk_bf16_f32 v187, v202, v203
    v_mfma_f32_16x16x32_bf16 v[200:203], a[188:191], a[48:51], 0
    v_exp_f32 v204, v204
    v_mfma_f32_16x16x32_bf16 v[200:203], a[228:231], a[52:55], v[200:203]
    v_lshlrev_b32 v253, 16, v247
    v_and_b32 v247, s26, v247
    v_mfma_f32_16x16x32_bf16 v[200:203], a[232:235], a[56:59], v[200:203]
    v_exp_f32 v205, v205
    v_mfma_f32_16x16x32_bf16 v[200:203], a[236:239], a[60:63], v[200:203]
    v_mul_f32 v253, s25, v253
    v_mul_f32 v247, s25, v247
    v_mfma_f32_16x16x32_bf16 v[116:119], v[212:215], v[172:175], v[116:119]
    v_exp_f32 v206, v206
    v_cvt_pk_bf16_f32 v247, v253, v247
    v_mfma_f32_16x16x32_bf16 v[148:151], v[212:215], v[176:179], v[148:151]
    s_waitcnt lgkmcnt(5)
    ds_read_b64_tr_b16 v[208:209], v224 offset:20480
    v_cvt_pk_bf16_f32 v190, v204, v205
    v_mfma_f32_16x16x32_bf16 v[24:27], v[216:219], v[160:163], v[24:27]
    v_exp_f32 v207, v207
    v_mfma_f32_16x16x32_bf16 v[56:59], v[216:219], v[164:167], v[56:59]
    ds_write_b64 v254, v[246:247] offset:24584
    v_smfmac_f32_16x16x64_bf16 a[248:251], a[252:255], v[172:179], v233
    ds_write_b64 v228, a[82:83] offset:8
    v_cvt_pk_bf16_f32 v191, v206, v207
    v_mfma_f32_16x16x32_bf16 v[204:207], a[188:191], a[64:67], 0
    v_exp_f32 v200, v200
    v_mfma_f32_16x16x32_bf16 v[204:207], a[228:231], a[68:71], v[204:207]
    s_waitcnt vmcnt(6)
    ds_read_b64_tr_b16 v[210:211], v224 offset:22528
    v_lshlrev_b32 v252, 16, v248
    v_mfma_f32_16x16x32_bf16 v[204:207], a[232:235], a[72:75], v[204:207]
    v_exp_f32 v201, v201
    v_mfma_f32_16x16x32_bf16 v[204:207], a[236:239], a[76:79], v[204:207]
    ds_read_b128 a[228:231], v229 offset:20480
    v_and_b32 v248, s26, v248
    v_mul_f32 v252, s25, v252
    v_mul_f32 v248, s25, v248
    v_cvt_pk_bf16_f32 v248, v252, v248
    v_mfma_f32_16x16x32_bf16 v[88:91], v[216:219], v[168:171], v[88:91]
    v_exp_f32 v202, v202
    v_mfma_f32_16x16x32_bf16 v[120:123], v[216:219], v[172:175], v[120:123]
    ds_read_b128 a[232:235], v235 offset:20480
    v_cvt_pk_bf16_f32 v194, v200, v201
    v_mfma_f32_16x16x32_bf16 v[152:155], v[216:219], v[176:179], v[152:155]
    s_waitcnt lgkmcnt(6)
    v_exp_f32 v203, v203
    v_mfma_f32_16x16x32_bf16 v[28:31], v[220:223], v[160:163], v[28:31]
    ds_read_b64_tr_b16 v[212:213], v224 offset:20488
    v_cvt_pk_bf16_f32 v195, v202, v203
    v_mfma_f32_16x16x32_bf16 v[200:203], a[192:195], a[0:3], 0
    v_exp_f32 v204, v204
    v_mfma_f32_16x16x32_bf16 v[200:203], a[212:215], a[4:7], v[200:203]
    ds_read_b64_tr_b16 v[214:215], v224 offset:22536
    v_lshlrev_b32 v253, 16, v249
    v_mfma_f32_16x16x32_bf16 v[200:203], a[216:219], a[8:11], v[200:203]
    v_exp_f32 v205, v205
    v_mfma_f32_16x16x32_bf16 v[200:203], a[220:223], a[12:15], v[200:203]
    ds_read_b128 a[236:239], v231 offset:20480
    v_and_b32 v249, s26, v249
    v_mul_f32 v253, s25, v253
    v_mul_f32 v249, s25, v249
    v_cvt_pk_bf16_f32 v249, v253, v249
    v_mfma_f32_16x16x32_bf16 v[60:63], v[220:223], v[164:167], v[60:63]
    v_exp_f32 v206, v206
    v_mfma_f32_16x16x32_bf16 v[92:95], v[220:223], v[168:171], v[92:95]
    v_exp_f32 v207, v207
    v_mfma_f32_16x16x32_bf16 v[124:127], v[220:223], v[172:175], v[124:127]
    ds_write_b64 v254, v[248:249] offset:24704
    v_mfma_f32_16x16x32_bf16 v[156:159], v[220:223], v[176:179], v[156:159]
    ds_read_b64_tr_b16 v[216:217], v225 offset:20480
    v_cvt_pk_bf16_f32 v198, v204, v205
    v_cvt_pk_bf16_f32 v199, v206, v207
    v_mfma_f32_16x16x32_bf16 v[204:207], a[192:195], a[16:19], 0
    v_exp_f32 v200, v200
    v_mfma_f32_16x16x32_bf16 v[204:207], a[212:215], a[20:23], v[204:207]
    ds_read_b64_tr_b16 v[218:219], v225 offset:22528
    v_lshlrev_b32 v252, 16, v250
    v_mfma_f32_16x16x32_bf16 v[204:207], a[216:219], a[24:27], v[204:207]
    v_exp_f32 v201, v201
    v_mfma_f32_16x16x32_bf16 v[204:207], a[220:223], a[28:31], v[204:207]
    s_waitcnt lgkmcnt(8)
    ds_write_b64 v228, a[84:85] offset:4096
    v_and_b32 v250, s26, v250
    v_mul_f32 v252, s25, v252
    v_mul_f32 v250, s25, v250
    v_cvt_pk_bf16_f32 v250, v252, v250
    v_mfma_f32_16x16x32_bf16 v[0:3], v[208:211], v[180:183], v[0:3]
    v_exp_f32 v202, v202
    v_mfma_f32_16x16x32_bf16 v[32:35], v[208:211], v[184:187], v[32:35]
    v_lshlrev_b32 v253, 16, v251
    v_cvt_pk_bf16_f32 v160, v200, v201
    v_mfma_f32_16x16x32_bf16 v[64:67], v[208:211], v[188:191], v[64:67]
    v_exp_f32 v203, v203
    v_mfma_f32_16x16x32_bf16 v[96:99], v[208:211], v[192:195], v[96:99]
    v_cvt_pk_bf16_f32 v161, v202, v203
    v_and_b32 v251, s26, v251
    v_smfmac_f32_16x16x64_bf16 a[240:243], a[252:255], v[180:187], v233
    v_mul_f32 v253, s25, v253
    v_mul_f32 v251, s25, v251
    v_mfma_f32_16x16x32_bf16 v[200:203], a[192:195], a[32:35], 0
    v_exp_f32 v204, v204
    v_mfma_f32_16x16x32_bf16 v[200:203], a[212:215], a[36:39], v[200:203]
    v_cvt_pk_bf16_f32 v251, v253, v251
    v_mfma_f32_16x16x32_bf16 v[200:203], a[216:219], a[40:43], v[200:203]
    v_exp_f32 v205, v205
    v_mfma_f32_16x16x32_bf16 v[200:203], a[220:223], a[44:47], v[200:203]
    v_exp_f32 v206, v206
    v_mfma_f32_16x16x32_bf16 v[128:131], v[208:211], v[196:199], v[128:131]
    s_waitcnt lgkmcnt(5)
    v_exp_f32 v207, v207
    v_mfma_f32_16x16x32_bf16 v[4:7], v[212:215], v[180:183], v[4:7]
    ds_write_b64 v254, v[250:251] offset:24712
    v_mfma_f32_16x16x32_bf16 v[36:39], v[212:215], v[184:187], v[36:39]
    s_add_u32 s43, s36, s28
    buffer_load_dwordx4 v[244:247], v230, s[8:11], s43 offen nt
    v_mfma_f32_16x16x32_bf16 v[68:71], v[212:215], v[188:191], v[68:71]
    ds_read_b64_tr_b16 v[220:221], v225 offset:20488
    v_cvt_pk_bf16_f32 v164, v204, v205
    v_cvt_pk_bf16_f32 v165, v206, v207
    v_mfma_f32_16x16x32_bf16 v[204:207], a[192:195], a[48:51], 0
    v_exp_f32 v200, v200
    v_mfma_f32_16x16x32_bf16 v[204:207], a[212:215], a[52:55], v[204:207]
    ds_write_b64 v228, a[86:87] offset:4104
    v_mfma_f32_16x16x32_bf16 v[204:207], a[216:219], a[56:59], v[204:207]
    v_exp_f32 v201, v201
    v_mfma_f32_16x16x32_bf16 v[204:207], a[220:223], a[60:63], v[204:207]
    ds_read_b64_tr_b16 v[222:223], v225 offset:22536
    v_cvt_pk_bf16_f32 v168, v200, v201
    v_mfma_f32_16x16x32_bf16 v[100:103], v[212:215], v[192:195], v[100:103]
    v_exp_f32 v202, v202
    v_mfma_f32_16x16x32_bf16 v[132:135], v[212:215], v[196:199], v[132:135]
    s_waitcnt lgkmcnt(5)
    ds_write_b64 v228, a[88:89] offset:8192
    v_mfma_f32_16x16x32_bf16 v[8:11], v[216:219], v[180:183], v[8:11]
    v_exp_f32 v203, v203
    v_mfma_f32_16x16x32_bf16 v[40:43], v[216:219], v[184:187], v[40:43]
    ds_read_b64_tr_b16 v[208:209], v224 offset:53248
    v_cvt_pk_bf16_f32 v169, v202, v203
    v_mfma_f32_16x16x32_bf16 v[200:203], a[192:195], a[64:67], 0
    v_exp_f32 v204, v204
    v_mfma_f32_16x16x32_bf16 v[200:203], a[212:215], a[68:71], v[200:203]
    ds_write_b64 v228, a[90:91] offset:8200
    v_mfma_f32_16x16x32_bf16 v[200:203], a[216:219], a[72:75], v[200:203]
    v_exp_f32 v205, v205
    v_mfma_f32_16x16x32_bf16 v[200:203], a[220:223], a[76:79], v[200:203]
    s_waitcnt vmcnt(5) lgkmcnt(6)
    s_barrier
    ds_read_b64_tr_b16 v[210:211], v224 offset:55296
    v_cvt_pk_bf16_f32 v172, v204, v205
    v_mfma_f32_16x16x32_bf16 v[72:75], v[216:219], v[188:191], v[72:75]
    v_exp_f32 v206, v206
    v_mfma_f32_16x16x32_bf16 v[104:107], v[216:219], v[192:195], v[104:107]
    s_add_u32 s43, s36, s46
    buffer_load_dwordx4 v[248:251], v230, s[8:11], s43 offen nt
    v_mfma_f32_16x16x32_bf16 v[136:139], v[216:219], v[196:199], v[136:139]
    s_waitcnt lgkmcnt(4)
    v_exp_f32 v207, v207
    v_mfma_f32_16x16x32_bf16 v[12:15], v[220:223], v[180:183], v[12:15]
    ds_read_b64_tr_b16 v[212:213], v224 offset:53256
    v_cvt_pk_bf16_f32 v173, v206, v207
    v_mfma_f32_16x16x32_bf16 v[204:207], a[196:199], a[0:3], 0
    v_exp_f32 v200, v200
    v_mfma_f32_16x16x32_bf16 v[204:207], a[228:231], a[4:7], v[204:207]
    ds_write_b64 v228, a[92:93] offset:12288
    v_mfma_f32_16x16x32_bf16 v[204:207], a[232:235], a[8:11], v[204:207]
    v_exp_f32 v201, v201
    v_mfma_f32_16x16x32_bf16 v[204:207], a[236:239], a[12:15], v[204:207]
    ds_read_b64_tr_b16 v[214:215], v224 offset:55304
    v_cvt_pk_bf16_f32 v176, v200, v201
    v_mfma_f32_16x16x32_bf16 v[44:47], v[220:223], v[184:187], v[44:47]
    v_exp_f32 v202, v202
    v_mfma_f32_16x16x32_bf16 v[76:79], v[220:223], v[188:191], v[76:79]
    ds_write_b64 v228, a[94:95] offset:12296
    v_mfma_f32_16x16x32_bf16 v[108:111], v[220:223], v[192:195], v[108:111]
    v_exp_f32 v203, v203
    v_mfma_f32_16x16x32_bf16 v[140:143], v[220:223], v[196:199], v[140:143]
    ds_read_b64_tr_b16 v[216:217], v225 offset:53248
    v_cvt_pk_bf16_f32 v177, v202, v203
    v_mfma_f32_16x16x32_bf16 v[200:203], a[196:199], a[16:19], 0
    v_exp_f32 v204, v204
    v_mfma_f32_16x16x32_bf16 v[200:203], a[228:231], a[20:23], v[200:203]
    ds_read_b64_tr_b16 v[218:219], v225 offset:55296
    v_mfma_f32_16x16x32_bf16 v[200:203], a[232:235], a[24:27], v[200:203]
    v_exp_f32 v205, v205
    v_mfma_f32_16x16x32_bf16 v[200:203], a[236:239], a[28:31], v[200:203]
    s_waitcnt lgkmcnt(6)
    ds_read_b128 a[200:203], v228 offset:24576
    v_cvt_pk_bf16_f32 v162, v204, v205
    v_mfma_f32_16x16x32_bf16 v[16:19], v[208:211], v[180:183], v[16:19]
    v_exp_f32 v206, v206
    v_mfma_f32_16x16x32_bf16 v[48:51], v[208:211], v[184:187], v[48:51]
    ds_read_b128 a[212:215], v229 offset:24576
    v_mfma_f32_16x16x32_bf16 v[80:83], v[208:211], v[188:191], v[80:83]
    v_exp_f32 v207, v207
    v_mfma_f32_16x16x32_bf16 v[112:115], v[208:211], v[192:195], v[112:115]
    ds_read_b128 a[216:219], v235 offset:24576
    v_cvt_pk_bf16_f32 v163, v206, v207
    v_smfmac_f32_16x16x64_bf16 a[244:247], a[252:255], v[188:195], v233
    ds_read_b128 a[220:223], v231 offset:24576
    v_mfma_f32_16x16x32_bf16 v[204:207], a[196:199], a[32:35], 0
    v_exp_f32 v200, v200
    v_mfma_f32_16x16x32_bf16 v[204:207], a[228:231], a[36:39], v[204:207]
    ds_read_b128 a[204:207], v228 offset:28672
    v_mfma_f32_16x16x32_bf16 v[204:207], a[232:235], a[40:43], v[204:207]
    v_exp_f32 v201, v201
    v_mfma_f32_16x16x32_bf16 v[204:207], a[236:239], a[44:47], v[204:207]
    v_exp_f32 v202, v202
    v_mfma_f32_16x16x32_bf16 v[144:147], v[208:211], v[196:199], v[144:147]
    s_waitcnt lgkmcnt(8)
    v_exp_f32 v203, v203
    v_mfma_f32_16x16x32_bf16 v[20:23], v[212:215], v[180:183], v[20:23]
    ds_read_b64_tr_b16 v[220:221], v225 offset:53256
    v_cvt_pk_bf16_f32 v166, v200, v201
    v_mfma_f32_16x16x32_bf16 v[52:55], v[212:215], v[184:187], v[52:55]
    ds_read_b64_tr_b16 v[222:223], v225 offset:55304
    v_cvt_pk_bf16_f32 v167, v202, v203
    v_mfma_f32_16x16x32_bf16 v[84:87], v[212:215], v[188:191], v[84:87]
    v_mfma_f32_16x16x32_bf16 v[200:203], a[196:199], a[48:51], 0
    v_exp_f32 v204, v204
    v_mfma_f32_16x16x32_bf16 v[200:203], a[228:231], a[52:55], v[200:203]
    v_exp_f32 v205, v205
    v_mfma_f32_16x16x32_bf16 v[200:203], a[232:235], a[56:59], v[200:203]
    v_exp_f32 v206, v206
    v_mfma_f32_16x16x32_bf16 v[200:203], a[236:239], a[60:63], v[200:203]
    v_exp_f32 v207, v207
    v_mfma_f32_16x16x32_bf16 v[116:119], v[212:215], v[192:195], v[116:119]
    v_cvt_pk_bf16_f32 v170, v204, v205
    v_cvt_pk_bf16_f32 v171, v206, v207
    v_mfma_f32_16x16x32_bf16 v[148:151], v[212:215], v[196:199], v[148:151]
    s_waitcnt lgkmcnt(7)
    ds_read_b64_tr_b16 v[208:209], v224 offset:24576
    v_mfma_f32_16x16x32_bf16 v[24:27], v[216:219], v[180:183], v[24:27]
    ds_read_b64_tr_b16 v[210:211], v224 offset:26624
    v_mfma_f32_16x16x32_bf16 v[56:59], v[216:219], v[184:187], v[56:59]
    v_smfmac_f32_16x16x64_bf16 a[248:251], a[252:255], v[192:199], v233
    v_mfma_f32_16x16x32_bf16 v[204:207], a[196:199], a[64:67], 0
    v_exp_f32 v200, v200
    v_mfma_f32_16x16x32_bf16 v[204:207], a[228:231], a[68:71], v[204:207]
    ds_read_b128 a[228:231], v229 offset:28672
    v_mfma_f32_16x16x32_bf16 v[204:207], a[232:235], a[72:75], v[204:207]
    v_exp_f32 v201, v201
    v_mfma_f32_16x16x32_bf16 v[204:207], a[236:239], a[76:79], v[204:207]
    ds_read_b128 a[232:235], v235 offset:28672
    v_cvt_pk_bf16_f32 v174, v200, v201
    v_mfma_f32_16x16x32_bf16 v[88:91], v[216:219], v[188:191], v[88:91]
    v_exp_f32 v202, v202
    v_mfma_f32_16x16x32_bf16 v[120:123], v[216:219], v[192:195], v[120:123]
    ds_read_b128 a[236:239], v231 offset:28672
    v_mfma_f32_16x16x32_bf16 v[152:155], v[216:219], v[196:199], v[152:155]
    s_waitcnt lgkmcnt(5)
    v_exp_f32 v203, v203
    v_mfma_f32_16x16x32_bf16 v[28:31], v[220:223], v[180:183], v[28:31]
    ds_read_b64_tr_b16 v[212:213], v224 offset:24584
    v_cvt_pk_bf16_f32 v175, v202, v203
    v_mfma_f32_16x16x32_bf16 v[200:203], a[200:203], a[0:3], 0
    v_exp_f32 v204, v204
    v_mfma_f32_16x16x32_bf16 v[200:203], a[212:215], a[4:7], v[200:203]
    ds_read_b64_tr_b16 v[214:215], v224 offset:26632
    v_mfma_f32_16x16x32_bf16 v[200:203], a[216:219], a[8:11], v[200:203]
    v_exp_f32 v205, v205
    v_mfma_f32_16x16x32_bf16 v[200:203], a[220:223], a[12:15], v[200:203]
    v_exp_f32 v206, v206
    v_mfma_f32_16x16x32_bf16 v[60:63], v[220:223], v[184:187], v[60:63]
    v_exp_f32 v207, v207
    v_mfma_f32_16x16x32_bf16 v[92:95], v[220:223], v[188:191], v[92:95]
    v_cvt_pk_bf16_f32 v178, v204, v205
    v_cvt_pk_bf16_f32 v179, v206, v207
    v_mfma_f32_16x16x32_bf16 v[124:127], v[220:223], v[192:195], v[124:127]
    v_mfma_f32_16x16x32_bf16 v[156:159], v[220:223], v[196:199], v[156:159]
    ds_read_b64_tr_b16 v[216:217], v225 offset:24576
    v_mfma_f32_16x16x32_bf16 v[204:207], a[204:207], a[0:3], 0
    s_waitcnt lgkmcnt(5)
    v_exp_f32 v200, v200
    v_mfma_f32_16x16x32_bf16 v[204:207], a[228:231], a[4:7], v[204:207]
    s_waitcnt lgkmcnt(4)
    ds_read_b64_tr_b16 v[218:219], v225 offset:26624
    v_mfma_f32_16x16x32_bf16 v[204:207], a[232:235], a[8:11], v[204:207]
    s_waitcnt lgkmcnt(4)
    v_exp_f32 v201, v201
    v_mfma_f32_16x16x32_bf16 v[204:207], a[236:239], a[12:15], v[204:207]
    v_exp_f32 v202, v202
    v_mfma_f32_16x16x32_bf16 v[0:3], v[208:211], v[160:163], v[0:3]
    v_exp_f32 v203, v203
    v_mfma_f32_16x16x32_bf16 v[32:35], v[208:211], v[164:167], v[32:35]
    v_cvt_pk_bf16_f32 v180, v200, v201
    v_cvt_pk_bf16_f32 v181, v202, v203
    v_mfma_f32_16x16x32_bf16 v[64:67], v[208:211], v[168:171], v[64:67]
    v_mfma_f32_16x16x32_bf16 v[96:99], v[208:211], v[172:175], v[96:99]
    v_smfmac_f32_16x16x64_bf16 a[240:243], a[252:255], v[160:167], v233
    v_mfma_f32_16x16x32_bf16 v[200:203], a[200:203], a[16:19], 0
    v_exp_f32 v204, v204
    v_mfma_f32_16x16x32_bf16 v[200:203], a[212:215], a[20:23], v[200:203]
    v_exp_f32 v205, v205
    v_mfma_f32_16x16x32_bf16 v[200:203], a[216:219], a[24:27], v[200:203]
    v_exp_f32 v206, v206
    v_mfma_f32_16x16x32_bf16 v[200:203], a[220:223], a[28:31], v[200:203]
    v_exp_f32 v207, v207
    v_mfma_f32_16x16x32_bf16 v[128:131], v[208:211], v[176:179], v[128:131]
    s_waitcnt lgkmcnt(2)
    ds_read_b64_tr_b16 v[220:221], v225 offset:24584
    v_cvt_pk_bf16_f32 v182, v204, v205
    v_mfma_f32_16x16x32_bf16 v[4:7], v[212:215], v[160:163], v[4:7]
    ds_read_b64_tr_b16 v[222:223], v225 offset:26632
    v_cvt_pk_bf16_f32 v183, v206, v207
    v_mfma_f32_16x16x32_bf16 v[36:39], v[212:215], v[164:167], v[36:39]
    v_mfma_f32_16x16x32_bf16 v[68:71], v[212:215], v[168:171], v[68:71]
    v_mfma_f32_16x16x32_bf16 v[204:207], a[204:207], a[16:19], 0
    v_exp_f32 v200, v200
    v_mfma_f32_16x16x32_bf16 v[204:207], a[228:231], a[20:23], v[204:207]
    v_exp_f32 v201, v201
    v_mfma_f32_16x16x32_bf16 v[204:207], a[232:235], a[24:27], v[204:207]
    v_exp_f32 v202, v202
    v_mfma_f32_16x16x32_bf16 v[204:207], a[236:239], a[28:31], v[204:207]
    s_add_u32 s43, s36, s47
    buffer_load_dwordx4 a[24:27], v230, s[8:11], s43 offen nt
    v_mfma_f32_16x16x32_bf16 v[100:103], v[212:215], v[172:175], v[100:103]
    v_exp_f32 v203, v203
    v_mfma_f32_16x16x32_bf16 v[132:135], v[212:215], v[176:179], v[132:135]
    s_waitcnt lgkmcnt(2)
    ds_read_b64_tr_b16 v[208:209], v224 offset:57344
    v_cvt_pk_bf16_f32 v184, v200, v201
    s_add_u32 s43, s36, s48
    buffer_load_dwordx4 a[28:31], v230, s[8:11], s43 offen nt
    v_mfma_f32_16x16x32_bf16 v[8:11], v[216:219], v[160:163], v[8:11]
    ds_read_b64_tr_b16 v[210:211], v224 offset:59392
    v_cvt_pk_bf16_f32 v185, v202, v203
    v_mfma_f32_16x16x32_bf16 v[40:43], v[216:219], v[164:167], v[40:43]
    v_mfma_f32_16x16x32_bf16 v[200:203], a[200:203], a[32:35], 0
    v_exp_f32 v204, v204
    v_mfma_f32_16x16x32_bf16 v[200:203], a[212:215], a[36:39], v[200:203]
    v_exp_f32 v205, v205
    v_mfma_f32_16x16x32_bf16 v[200:203], a[216:219], a[40:43], v[200:203]
    v_exp_f32 v206, v206
    v_mfma_f32_16x16x32_bf16 v[200:203], a[220:223], a[44:47], v[200:203]
    s_waitcnt vmcnt(4)
    s_barrier
    v_exp_f32 v207, v207
    v_mfma_f32_16x16x32_bf16 v[72:75], v[216:219], v[168:171], v[72:75]
    v_cvt_pk_bf16_f32 v186, v204, v205
    v_cvt_pk_bf16_f32 v187, v206, v207
    v_mfma_f32_16x16x32_bf16 v[104:107], v[216:219], v[172:175], v[104:107]
    ds_write_b64 v228, a[96:97] offset:16384
    v_mfma_f32_16x16x32_bf16 v[136:139], v[216:219], v[176:179], v[136:139]
    s_waitcnt lgkmcnt(3)
    ds_write_b64 v228, a[98:99] offset:16392
    v_mfma_f32_16x16x32_bf16 v[12:15], v[220:223], v[160:163], v[12:15]
    ds_write_b64 v228, a[100:101] offset:20480
    v_mfma_f32_16x16x32_bf16 v[204:207], a[204:207], a[32:35], 0
    v_exp_f32 v200, v200
    v_mfma_f32_16x16x32_bf16 v[204:207], a[228:231], a[36:39], v[204:207]
    ds_write_b64 v228, a[102:103] offset:20488
    v_mfma_f32_16x16x32_bf16 v[204:207], a[232:235], a[40:43], v[204:207]
    v_exp_f32 v201, v201
    v_mfma_f32_16x16x32_bf16 v[204:207], a[236:239], a[44:47], v[204:207]
    ds_read_b64_tr_b16 v[212:213], v224 offset:57352
    v_cvt_pk_bf16_f32 v188, v200, v201
    v_mfma_f32_16x16x32_bf16 v[44:47], v[220:223], v[164:167], v[44:47]
    v_exp_f32 v202, v202
    v_mfma_f32_16x16x32_bf16 v[76:79], v[220:223], v[168:171], v[76:79]
    ds_write_b64 v228, a[104:105] offset:24576
    v_mfma_f32_16x16x32_bf16 v[108:111], v[220:223], v[172:175], v[108:111]
    v_exp_f32 v203, v203
    v_mfma_f32_16x16x32_bf16 v[140:143], v[220:223], v[176:179], v[140:143]
    ds_read_b64_tr_b16 v[214:215], v224 offset:59400
    v_cvt_pk_bf16_f32 v189, v202, v203
    v_mfma_f32_16x16x32_bf16 v[200:203], a[200:203], a[48:51], 0
    v_exp_f32 v204, v204
    v_mfma_f32_16x16x32_bf16 v[200:203], a[212:215], a[52:55], v[200:203]
    ds_read_b64_tr_b16 v[216:217], v225 offset:57344
    v_accvgpr_mov_b32 a0, a208
    v_mfma_f32_16x16x32_bf16 v[200:203], a[216:219], a[56:59], v[200:203]
    v_exp_f32 v205, v205
    v_mfma_f32_16x16x32_bf16 v[200:203], a[220:223], a[60:63], v[200:203]
    s_waitcnt lgkmcnt(8)
    ds_read_b64_tr_b16 v[218:219], v225 offset:59392
    v_cvt_pk_bf16_f32 v190, v204, v205
    v_mfma_f32_16x16x32_bf16 v[16:19], v[208:211], v[160:163], v[16:19]
    v_exp_f32 v206, v206
    v_mfma_f32_16x16x32_bf16 v[48:51], v[208:211], v[164:167], v[48:51]
    v_exp_f32 v207, v207
    v_mfma_f32_16x16x32_bf16 v[80:83], v[208:211], v[168:171], v[80:83]
    v_cvt_pk_bf16_f32 v191, v206, v207
    v_accvgpr_mov_b32 a1, a209
    v_mfma_f32_16x16x32_bf16 v[112:115], v[208:211], v[172:175], v[112:115]
    v_accvgpr_mov_b32 a2, a210
    v_accvgpr_mov_b32 a3, a211
    v_smfmac_f32_16x16x64_bf16 a[244:247], a[252:255], v[168:175], v233
    s_add_u32 s43, s37, s28
    buffer_load_dwordx4 a[32:35], v230, s[8:11], s43 offen nt
    v_mfma_f32_16x16x32_bf16 v[204:207], a[204:207], a[48:51], 0
    v_exp_f32 v200, v200
    v_mfma_f32_16x16x32_bf16 v[204:207], a[228:231], a[52:55], v[204:207]
    v_exp_f32 v201, v201
    v_mfma_f32_16x16x32_bf16 v[204:207], a[232:235], a[56:59], v[204:207]
    v_exp_f32 v202, v202
    v_mfma_f32_16x16x32_bf16 v[204:207], a[236:239], a[60:63], v[204:207]
    v_exp_f32 v203, v203
    v_mfma_f32_16x16x32_bf16 v[144:147], v[208:211], v[176:179], v[144:147]
    s_waitcnt lgkmcnt(2)
    ds_read_b64_tr_b16 v[220:221], v225 offset:57352
    v_cvt_pk_bf16_f32 v192, v200, v201
    v_mfma_f32_16x16x32_bf16 v[20:23], v[212:215], v[160:163], v[20:23]
    ds_read_b64_tr_b16 v[222:223], v225 offset:59400
    v_cvt_pk_bf16_f32 v193, v202, v203
    v_mfma_f32_16x16x32_bf16 v[52:55], v[212:215], v[164:167], v[52:55]
    v_accvgpr_mov_b32 a4, a224
    v_accvgpr_mov_b32 a5, a225
    v_mfma_f32_16x16x32_bf16 v[84:87], v[212:215], v[168:171], v[84:87]
    v_accvgpr_mov_b32 a6, a226
    v_accvgpr_mov_b32 a7, a227
    v_mfma_f32_16x16x32_bf16 v[200:203], a[200:203], a[64:67], 0
    v_exp_f32 v204, v204
    v_mfma_f32_16x16x32_bf16 v[200:203], a[212:215], a[68:71], v[200:203]
    ds_read_b128 a[212:215], v229 offset:0
    v_accvgpr_write_b32 a8, v236
    v_mfma_f32_16x16x32_bf16 v[200:203], a[216:219], a[72:75], v[200:203]
    v_exp_f32 v205, v205
    v_mfma_f32_16x16x32_bf16 v[200:203], a[220:223], a[76:79], v[200:203]
    ds_read_b128 a[216:219], v235 offset:0
    v_cvt_pk_bf16_f32 v194, v204, v205
    v_mfma_f32_16x16x32_bf16 v[116:119], v[212:215], v[172:175], v[116:119]
    v_exp_f32 v206, v206
    v_mfma_f32_16x16x32_bf16 v[148:151], v[212:215], v[176:179], v[148:151]
    s_waitcnt lgkmcnt(4)
    ds_read_b64_tr_b16 v[208:209], v224 offset:28672
    v_accvgpr_write_b32 a9, v237
    v_mfma_f32_16x16x32_bf16 v[24:27], v[216:219], v[160:163], v[24:27]
    v_exp_f32 v207, v207
    v_mfma_f32_16x16x32_bf16 v[56:59], v[216:219], v[164:167], v[56:59]
    s_add_u32 s43, s37, s46
    buffer_load_dwordx4 a[36:39], v230, s[8:11], s43 offen nt
    v_smfmac_f32_16x16x64_bf16 a[248:251], a[252:255], v[172:179], v233
    ds_read_b64_tr_b16 v[210:211], v224 offset:30720
    v_cvt_pk_bf16_f32 v195, v206, v207
    v_mfma_f32_16x16x32_bf16 v[204:207], a[204:207], a[64:67], 0
    v_exp_f32 v200, v200
    v_mfma_f32_16x16x32_bf16 v[204:207], a[228:231], a[68:71], v[204:207]
    ds_read_b128 a[220:223], v231 offset:0
    v_accvgpr_write_b32 a10, v238
    v_mfma_f32_16x16x32_bf16 v[204:207], a[232:235], a[72:75], v[204:207]
    v_exp_f32 v201, v201
    v_mfma_f32_16x16x32_bf16 v[204:207], a[236:239], a[76:79], v[204:207]
    ds_read_b128 a[228:231], v229 offset:4096
    v_accvgpr_write_b32 a11, v239
    v_mfma_f32_16x16x32_bf16 v[88:91], v[216:219], v[168:171], v[88:91]
    v_exp_f32 v202, v202
    v_mfma_f32_16x16x32_bf16 v[120:123], v[216:219], v[172:175], v[120:123]
    ds_read_b128 a[232:235], v235 offset:4096
    v_accvgpr_write_b32 a12, v240
    v_mfma_f32_16x16x32_bf16 v[152:155], v[216:219], v[176:179], v[152:155]
    s_waitcnt lgkmcnt(7)
    v_exp_f32 v203, v203
    v_mfma_f32_16x16x32_bf16 v[28:31], v[220:223], v[160:163], v[28:31]
    s_waitcnt vmcnt(4)
    ds_read_b64_tr_b16 v[212:213], v224 offset:28680
    v_accvgpr_write_b32 a13, v241
    v_accvgpr_write_b32 a14, v242
    v_accvgpr_write_b32 a15, v243
    v_accvgpr_write_b32 a16, v244
    v_accvgpr_write_b32 a17, v245
    v_accvgpr_write_b32 a18, v246
    v_accvgpr_write_b32 a19, v247
    v_accvgpr_write_b32 a20, v248
    v_accvgpr_write_b32 a21, v249
    v_accvgpr_write_b32 a22, v250
    v_accvgpr_write_b32 a23, v251
    v_mfma_f32_16x16x32_bf16 v[60:63], v[220:223], v[164:167], v[60:63]
    v_exp_f32 v204, v204
    v_mfma_f32_16x16x32_bf16 v[92:95], v[220:223], v[168:171], v[92:95]
    v_exp_f32 v205, v205
    v_mfma_f32_16x16x32_bf16 v[124:127], v[220:223], v[172:175], v[124:127]
    v_exp_f32 v206, v206
    v_mfma_f32_16x16x32_bf16 v[156:159], v[220:223], v[176:179], v[156:159]
    v_exp_f32 v207, v207
    v_smfmac_f32_16x16x64_bf16 a[240:243], a[252:255], v[180:187], v233
    s_waitcnt lgkmcnt(4)
    s_add_u32 s43, s37, s47
    buffer_load_dwordx4 a[40:43], v230, s[8:11], s43 offen nt
    v_mfma_f32_16x16x32_bf16 v[0:3], v[208:211], v[180:183], v[0:3]
L_pad5:
    s_cbranch_vccnz L_pad9
    ds_read_b64_tr_b16 v[214:215], v224 offset:30728
    v_cvt_pk_bf16_f32 v196, v200, v201
    v_mfma_f32_16x16x32_bf16 v[32:35], v[208:211], v[184:187], v[32:35]
    ds_read_b64_tr_b16 v[216:217], v225 offset:28672
    v_cvt_pk_bf16_f32 v197, v202, v203
    v_mfma_f32_16x16x32_bf16 v[64:67], v[208:211], v[188:191], v[64:67]
    ds_read_b64_tr_b16 v[218:219], v225 offset:30720
    v_cvt_pk_bf16_f32 v198, v204, v205
    v_mfma_f32_16x16x32_bf16 v[96:99], v[208:211], v[192:195], v[96:99]
    ds_read_b128 a[236:239], v231 offset:4096
    v_accvgpr_read_b32 v253, a240
    v_smfmac_f32_16x16x64_bf16 a[244:247], a[252:255], v[188:195], v233
    v_accvgpr_read_b32 v254, a241
    v_add_f32 v253, v253, v254
    v_cvt_pk_bf16_f32 v199, v206, v207
    s_nop 1
    v_smfmac_f32_16x16x64_bf16 a[248:251], a[252:255], v[192:199], v233
    v_rcp_f32 v248, v253
    v_mfma_f32_16x16x32_bf16 v[128:131], v[208:211], v[196:199], v[128:131]
    s_waitcnt lgkmcnt(3)
    ds_read_b64_tr_b16 v[220:221], v225 offset:28680
    v_accvgpr_read_b32 v232, a242
    v_mfma_f32_16x16x32_bf16 v[4:7], v[212:215], v[180:183], v[4:7]
    ds_read_b64_tr_b16 v[222:223], v225 offset:30728
    v_accvgpr_read_b32 v254, a243
    v_mfma_f32_16x16x32_bf16 v[36:39], v[212:215], v[184:187], v[36:39]
    v_add_f32 v232, v232, v254
    v_mul_f32 v0, v0, v248
    v_mfma_f32_16x16x32_bf16 v[68:71], v[212:215], v[188:191], v[68:71]
    v_rcp_f32 v249, v232
    v_mfma_f32_16x16x32_bf16 v[100:103], v[212:215], v[192:195], v[100:103]
    v_mul_f32 v1, v1, v248
    v_mul_f32 v2, v2, v248
    v_mfma_f32_16x16x32_bf16 v[132:135], v[212:215], v[196:199], v[132:135]
    s_waitcnt lgkmcnt(3)
    ds_read_b64_tr_b16 v[208:209], v224 offset:61440
    v_mul_f32 v3, v3, v248
    v_mfma_f32_16x16x32_bf16 v[8:11], v[216:219], v[180:183], v[8:11]
    ds_read_b64_tr_b16 v[210:211], v224 offset:63488
    v_cvt_pk_bf16_f32 v236, v0, v1
    v_mfma_f32_16x16x32_bf16 v[40:43], v[216:219], v[184:187], v[40:43]
    v_cvt_pk_bf16_f32 v237, v2, v3
    v_mul_f32 v32, v32, v249
    v_mfma_f32_16x16x32_bf16 v[72:75], v[216:219], v[188:191], v[72:75]
    v_mul_f32 v33, v33, v249
    v_mul_f32 v34, v34, v249
    v_mfma_f32_16x16x32_bf16 v[104:107], v[216:219], v[192:195], v[104:107]
    s_add_u32 s43, s37, s48
    buffer_load_dwordx4 a[44:47], v230, s[8:11], s43 offen nt
    v_mfma_f32_16x16x32_bf16 v[136:139], v[216:219], v[196:199], v[136:139]
    s_waitcnt lgkmcnt(2)
    ds_read_b64_tr_b16 v[212:213], v224 offset:61448
    v_mul_f32 v35, v35, v249
    v_mfma_f32_16x16x32_bf16 v[12:15], v[220:223], v[180:183], v[12:15]
    ds_read_b64_tr_b16 v[214:215], v224 offset:63496
    v_xor_b32 v224, 0x10000, v224
    v_mfma_f32_16x16x32_bf16 v[44:47], v[220:223], v[184:187], v[44:47]
    v_cvt_pk_bf16_f32 v240, v32, v33
    v_cvt_pk_bf16_f32 v241, v34, v35
    v_mfma_f32_16x16x32_bf16 v[76:79], v[220:223], v[188:191], v[76:79]
    v_mul_f32 v4, v4, v248
    v_mul_f32 v5, v5, v248
    v_mfma_f32_16x16x32_bf16 v[108:111], v[220:223], v[192:195], v[108:111]
    v_mul_f32 v6, v6, v248
    v_mul_f32 v7, v7, v248
    v_mfma_f32_16x16x32_bf16 v[140:143], v[220:223], v[196:199], v[140:143]
    s_waitcnt lgkmcnt(2)
    ds_read_b64_tr_b16 v[216:217], v225 offset:61440
    v_cvt_pk_bf16_f32 v238, v4, v5
    v_mfma_f32_16x16x32_bf16 v[16:19], v[208:211], v[180:183], v[16:19]
    ds_read_b64_tr_b16 v[218:219], v225 offset:63488
    v_cvt_pk_bf16_f32 v239, v6, v7
    v_mfma_f32_16x16x32_bf16 v[48:51], v[208:211], v[184:187], v[48:51]
    v_accvgpr_write_b32 a240, 0
    v_accvgpr_write_b32 a241, 0
    v_mfma_f32_16x16x32_bf16 v[80:83], v[208:211], v[188:191], v[80:83]
    v_accvgpr_write_b32 a242, 0
    v_accvgpr_write_b32 a243, 0
    v_mfma_f32_16x16x32_bf16 v[112:115], v[208:211], v[192:195], v[112:115]
    v_mul_f32 v36, v36, v249
    v_mul_f32 v37, v37, v249
    v_mfma_f32_16x16x32_bf16 v[144:147], v[208:211], v[196:199], v[144:147]
    s_waitcnt lgkmcnt(2)
    ds_read_b64_tr_b16 v[220:221], v225 offset:61448
    v_mul_f32 v38, v38, v249
    v_mfma_f32_16x16x32_bf16 v[20:23], v[212:215], v[180:183], v[20:23]
    ds_read_b64_tr_b16 v[222:223], v225 offset:63496
    v_xor_b32 v225, 0x10000, v225
    v_mfma_f32_16x16x32_bf16 v[52:55], v[212:215], v[184:187], v[52:55]
    ds_read_b64_tr_b16 v[208:209], v224 offset:0
    v_mul_f32 v39, v39, v249
    v_mfma_f32_16x16x32_bf16 v[84:87], v[212:215], v[188:191], v[84:87]
    ds_write_b64 v228, a[106:107] offset:24584
    v_mfma_f32_16x16x32_bf16 v[116:119], v[212:215], v[192:195], v[116:119]
    ds_read_b64_tr_b16 v[210:211], v224 offset:2048
    v_cvt_pk_bf16_f32 v242, v36, v37
    v_mfma_f32_16x16x32_bf16 v[148:151], v[212:215], v[196:199], v[148:151]
    s_waitcnt lgkmcnt(5)
    s_add_u32 s43, s38, s28
    buffer_load_dwordx4 a[48:51], v230, s[8:11], s43 offen nt
    v_mfma_f32_16x16x32_bf16 v[24:27], v[216:219], v[180:183], v[24:27]
    ds_read_b64_tr_b16 v[212:213], v224 offset:8
    v_cvt_pk_bf16_f32 v243, v38, v39
    v_mfma_f32_16x16x32_bf16 v[56:59], v[216:219], v[184:187], v[56:59]
    ds_read_b64_tr_b16 v[214:215], v224 offset:2056
    v_mul_f32 v8, v8, v248
    v_mfma_f32_16x16x32_bf16 v[88:91], v[216:219], v[188:191], v[88:91]
    v_mul_f32 v9, v9, v248
    v_mul_f32 v10, v10, v248
    v_mfma_f32_16x16x32_bf16 v[120:123], v[216:219], v[192:195], v[120:123]
    v_mul_f32 v11, v11, v248
    v_cvt_pk_bf16_f32 v244, v8, v9
    v_mfma_f32_16x16x32_bf16 v[152:155], v[216:219], v[196:199], v[152:155]
    s_waitcnt lgkmcnt(5)
    ds_read_b64_tr_b16 v[216:217], v225 offset:0
    v_cvt_pk_bf16_f32 v245, v10, v11
    v_mfma_f32_16x16x32_bf16 v[28:31], v[220:223], v[180:183], v[28:31]
    ds_read_b64_tr_b16 v[218:219], v225 offset:2048
    v_mul_f32 v40, v40, v249
    v_mfma_f32_16x16x32_bf16 v[200:203], a[80:83], a[0:3], 0
    v_mul_f32 v41, v41, v249
    v_mul_f32 v42, v42, v249
    v_mfma_f32_16x16x32_bf16 v[200:203], a[212:215], a[4:7], v[200:203]
    v_mul_f32 v43, v43, v249
    v_cvt_pk_bf16_f32 v176, v40, v41
    v_mfma_f32_16x16x32_bf16 v[200:203], a[216:219], a[8:11], v[200:203]
    v_cvt_pk_bf16_f32 v177, v42, v43
    v_mul_f32 v12, v12, v248
    v_mfma_f32_16x16x32_bf16 v[200:203], a[220:223], a[12:15], v[200:203]
    v_mul_f32 v13, v13, v248
    v_mul_f32 v14, v14, v248
    v_mfma_f32_16x16x32_bf16 v[204:207], a[80:83], a[16:19], 0
    v_mul_f32 v15, v15, v248
    v_cvt_pk_bf16_f32 v246, v12, v13
    v_mfma_f32_16x16x32_bf16 v[204:207], a[212:215], a[20:23], v[204:207]
    s_waitcnt vmcnt(6)
    ds_write_b64 v228, a[108:109] offset:28672
    v_mfma_f32_16x16x32_bf16 v[204:207], a[216:219], a[24:27], v[204:207]
    s_waitcnt vmcnt(5)
    v_exp_f32 v200, v200
    v_mfma_f32_16x16x32_bf16 v[204:207], a[220:223], a[28:31], v[204:207]
    v_exp_f32 v201, v201
    v_exp_f32 v202, v202
    v_exp_f32 v203, v203
    v_cvt_pk_bf16_f32 v160, v200, v201
    v_cvt_pk_bf16_f32 v161, v202, v203
    v_mfma_f32_16x16x32_bf16 v[200:203], a[84:87], a[0:3], 0
    ds_read_b128 a[212:215], v229 offset:8192
    v_cvt_pk_bf16_f32 v247, v14, v15
    s_add_u32 s43, s38, s46
    buffer_load_dwordx4 a[52:55], v230, s[8:11], s43 offen nt
    v_mfma_f32_16x16x32_bf16 v[200:203], a[228:231], a[4:7], v[200:203]
    ds_read_b128 a[216:219], v235 offset:8192
    v_exp_f32 v204, v204
    v_mfma_f32_16x16x32_bf16 v[200:203], a[232:235], a[8:11], v[200:203]
    ds_read_b128 a[220:223], v231 offset:8192
    v_exp_f32 v205, v205
    v_mfma_f32_16x16x32_bf16 v[200:203], a[236:239], a[12:15], v[200:203]
    v_exp_f32 v206, v206
    v_exp_f32 v207, v207
    v_cvt_pk_bf16_f32 v164, v204, v205
    v_cvt_pk_bf16_f32 v165, v206, v207
    v_mfma_f32_16x16x32_bf16 v[204:207], a[84:87], a[16:19], 0
    v_mul_f32 v44, v44, v249
    v_mul_f32 v45, v45, v249
    v_mfma_f32_16x16x32_bf16 v[204:207], a[228:231], a[20:23], v[204:207]
    v_exp_f32 v200, v200
    v_mfma_f32_16x16x32_bf16 v[204:207], a[232:235], a[24:27], v[204:207]
    v_exp_f32 v201, v201
    v_mfma_f32_16x16x32_bf16 v[204:207], a[236:239], a[28:31], v[204:207]
    v_exp_f32 v202, v202
    v_exp_f32 v203, v203
    v_cvt_pk_bf16_f32 v162, v200, v201
    v_cvt_pk_bf16_f32 v163, v202, v203
    v_mfma_f32_16x16x32_bf16 v[200:203], a[88:91], a[0:3], 0
    s_waitcnt lgkmcnt(2)
    ds_read_b128 a[228:231], v229 offset:12288
    v_mul_f32 v46, v46, v249
    v_mfma_f32_16x16x32_bf16 v[200:203], a[212:215], a[4:7], v[200:203]
    s_waitcnt lgkmcnt(2)
    ds_read_b128 a[232:235], v235 offset:12288
    v_mul_f32 v47, v47, v249
    v_mfma_f32_16x16x32_bf16 v[200:203], a[216:219], a[8:11], v[200:203]
    s_waitcnt lgkmcnt(2)
    v_exp_f32 v204, v204
    s_add_u32 s43, s38, s47
    buffer_load_dwordx4 a[56:59], v230, s[8:11], s43 offen nt
    v_mfma_f32_16x16x32_bf16 v[200:203], a[220:223], a[12:15], v[200:203]
    ds_read_b128 a[236:239], v231 offset:12288
    v_cvt_pk_bf16_f32 v178, v44, v45
    v_mfma_f32_16x16x32_bf16 v[60:63], v[220:223], v[184:187], v[60:63]
    ds_write_b64 v228, a[110:111] offset:28680
    v_mfma_f32_16x16x32_bf16 v[92:95], v[220:223], v[188:191], v[92:95]
    v_exp_f32 v205, v205
    v_mfma_f32_16x16x32_bf16 v[124:127], v[220:223], v[192:195], v[124:127]
    v_exp_f32 v206, v206
    v_mfma_f32_16x16x32_bf16 v[156:159], v[220:223], v[196:199], v[156:159]
    ds_read_b64_tr_b16 v[220:221], v225 offset:8
    v_cvt_pk_bf16_f32 v166, v204, v205
    v_exp_f32 v207, v207
    v_cvt_pk_bf16_f32 v179, v46, v47
    v_cvt_pk_bf16_f32 v167, v206, v207
    v_mfma_f32_16x16x32_bf16 v[204:207], a[88:91], a[16:19], 0
    v_exp_f32 v200, v200
    v_mfma_f32_16x16x32_bf16 v[204:207], a[212:215], a[20:23], v[204:207]
    ds_read_b64_tr_b16 v[222:223], v225 offset:2056
    v_mul_f32 v16, v16, v248
    v_mfma_f32_16x16x32_bf16 v[204:207], a[216:219], a[24:27], v[204:207]
    v_exp_f32 v201, v201
    v_mfma_f32_16x16x32_bf16 v[204:207], a[220:223], a[28:31], v[204:207]
    s_waitcnt lgkmcnt(2)
    s_barrier
    ds_read_b128 a[212:215], v229 offset:16384
    v_cvt_pk_bf16_f32 v180, v200, v201
    v_mfma_f32_16x16x32_bf16 v[0:3], v[208:211], v[160:163], 0
    v_exp_f32 v202, v202
    s_add_u32 s43, s38, s48
    buffer_load_dwordx4 a[60:63], v230, s[8:11], s43 offen nt
    v_mfma_f32_16x16x32_bf16 v[32:35], v[208:211], v[164:167], 0
    ds_read_b64_tr_b16 v[208:209], v224 offset:32768
    v_mul_f32 v17, v17, v248
    v_mfma_f32_16x16x32_bf16 v[4:7], v[212:215], v[160:163], 0
    v_exp_f32 v203, v203
    v_mfma_f32_16x16x32_bf16 v[36:39], v[212:215], v[164:167], 0
    ds_read_b64_tr_b16 v[210:211], v224 offset:34816
    v_cvt_pk_bf16_f32 v181, v202, v203
    v_smfmac_f32_16x16x64_bf16 a[240:243], a[252:255], v[160:167], v233
    ds_read_b64_tr_b16 v[212:213], v224 offset:32776
    v_mul_f32 v18, v18, v248
    v_mfma_f32_16x16x32_bf16 v[200:203], a[92:95], a[0:3], 0
    v_exp_f32 v204, v204
    v_mfma_f32_16x16x32_bf16 v[200:203], a[228:231], a[4:7], v[200:203]
    ds_read_b64_tr_b16 v[214:215], v224 offset:34824
    v_mul_f32 v19, v19, v248
    v_mfma_f32_16x16x32_bf16 v[200:203], a[232:235], a[8:11], v[200:203]
    ds_write_b64 v228, a[112:113] offset:0
    v_mfma_f32_16x16x32_bf16 v[200:203], a[236:239], a[12:15], v[200:203]
    ds_read_b128 a[216:219], v235 offset:16384
    v_cvt_pk_bf16_f32 v168, v16, v17
    v_mfma_f32_16x16x32_bf16 v[8:11], v[216:219], v[160:163], 0
    v_exp_f32 v205, v205
    v_mfma_f32_16x16x32_bf16 v[40:43], v[216:219], v[164:167], 0
    s_waitcnt lgkmcnt(7)
    ds_read_b128 a[220:223], v231 offset:16384
    v_cvt_pk_bf16_f32 v184, v204, v205
    v_cvt_pk_bf16_f32 v169, v18, v19
    v_mul_f32 v20, v20, v248
    v_mul_f32 v21, v21, v248
    v_mul_f32 v22, v22, v248
    v_mul_f32 v23, v23, v248
    v_cvt_pk_bf16_f32 v170, v20, v21
    v_cvt_pk_bf16_f32 v171, v22, v23
    buffer_store_dwordx4 v[168:171], v230, s[20:23], s30 offen offset:128
    v_mfma_f32_16x16x32_bf16 v[12:15], v[220:223], v[160:163], 0
    v_exp_f32 v206, v206
    v_mfma_f32_16x16x32_bf16 v[44:47], v[220:223], v[164:167], 0
    ds_read_b64_tr_b16 v[216:217], v225 offset:32768
    v_mul_f32 v48, v48, v249
    v_exp_f32 v207, v207
    v_mul_f32 v49, v49, v249
    v_cvt_pk_bf16_f32 v185, v206, v207
    v_mfma_f32_16x16x32_bf16 v[204:207], a[92:95], a[16:19], 0
    v_exp_f32 v200, v200
    v_mfma_f32_16x16x32_bf16 v[204:207], a[228:231], a[20:23], v[204:207]
    ds_read_b64_tr_b16 v[218:219], v225 offset:34816
    v_mul_f32 v50, v50, v249
    v_mfma_f32_16x16x32_bf16 v[204:207], a[232:235], a[24:27], v[204:207]
    v_exp_f32 v201, v201
    v_mfma_f32_16x16x32_bf16 v[204:207], a[236:239], a[28:31], v[204:207]
    s_waitcnt lgkmcnt(7)
    ds_write_b64 v228, a[114:115] offset:8
    v_mfma_f32_16x16x32_bf16 v[16:19], v[208:211], v[160:163], 0
    v_exp_f32 v202, v202
    v_mul_f32 v51, v51, v249
    v_cvt_pk_bf16_f32 v172, v48, v49
    v_cvt_pk_bf16_f32 v173, v50, v51
    v_mfma_f32_16x16x32_bf16 v[48:51], v[208:211], v[164:167], 0
    s_waitcnt lgkmcnt(6)
    ds_read_b64_tr_b16 v[220:221], v225 offset:32776
    v_mul_f32 v52, v52, v249
    v_mfma_f32_16x16x32_bf16 v[20:23], v[212:215], v[160:163], 0
    ds_read_b64_tr_b16 v[222:223], v225 offset:34824
    v_exp_f32 v203, v203
    v_mul_f32 v53, v53, v249
    v_mul_f32 v54, v54, v249
    v_mul_f32 v55, v55, v249
    v_cvt_pk_bf16_f32 v174, v52, v53
    v_cvt_pk_bf16_f32 v175, v54, v55
    v_mfma_f32_16x16x32_bf16 v[52:55], v[212:215], v[164:167], 0
    ds_read_b64_tr_b16 v[208:209], v224 offset:4096
    v_cvt_pk_bf16_f32 v182, v200, v201
    v_cvt_pk_bf16_f32 v183, v202, v203
    v_mfma_f32_16x16x32_bf16 v[200:203], a[96:99], a[0:3], 0
    v_exp_f32 v204, v204
    v_mfma_f32_16x16x32_bf16 v[200:203], a[212:215], a[4:7], v[200:203]
    s_waitcnt lgkmcnt(7)
    ds_read_b64_tr_b16 v[210:211], v224 offset:6144
    v_mul_f32 v24, v24, v248
    v_mfma_f32_16x16x32_bf16 v[200:203], a[216:219], a[8:11], v[200:203]
    s_waitcnt lgkmcnt(7)
    v_exp_f32 v205, v205
    v_mfma_f32_16x16x32_bf16 v[200:203], a[220:223], a[12:15], v[200:203]
    s_waitcnt lgkmcnt(5)
    ds_read_b64_tr_b16 v[212:213], v224 offset:4104
    v_mul_f32 v25, v25, v248
    v_mul_f32 v26, v26, v248
    v_mul_f32 v27, v27, v248
    v_cvt_pk_bf16_f32 v188, v24, v25
    v_cvt_pk_bf16_f32 v189, v26, v27
    v_mfma_f32_16x16x32_bf16 v[24:27], v[216:219], v[160:163], 0
    ds_write_b64 v228, a[116:117] offset:4096
    v_mul_f32 v56, v56, v249
    v_mul_f32 v57, v57, v249
    v_mul_f32 v58, v58, v249
    v_mul_f32 v59, v59, v249
    v_cvt_pk_bf16_f32 v192, v56, v57
    v_cvt_pk_bf16_f32 v193, v58, v59
    v_mfma_f32_16x16x32_bf16 v[56:59], v[216:219], v[164:167], 0
    s_waitcnt lgkmcnt(4)
    buffer_store_dwordx4 v[172:175], v230, s[20:23], s31 offen offset:128
    v_mul_f32 v28, v28, v248
    v_mul_f32 v29, v29, v248
    v_mul_f32 v30, v30, v248
    v_mul_f32 v31, v31, v248
    v_cvt_pk_bf16_f32 v190, v28, v29
    v_cvt_pk_bf16_f32 v191, v30, v31
    v_mfma_f32_16x16x32_bf16 v[28:31], v[220:223], v[160:163], 0
    ds_read_b64_tr_b16 v[214:215], v224 offset:6152
    v_exp_f32 v206, v206
    v_mul_f32 v60, v60, v249
    v_mul_f32 v61, v61, v249
    v_mul_f32 v62, v62, v249
    v_mul_f32 v63, v63, v249
    v_cvt_pk_bf16_f32 v194, v60, v61
    v_cvt_pk_bf16_f32 v195, v62, v63
    v_mfma_f32_16x16x32_bf16 v[60:63], v[220:223], v[164:167], 0
    ds_read_b128 a[228:231], v229 offset:20480
    v_cvt_pk_bf16_f32 v186, v204, v205
    v_exp_f32 v207, v207
    v_max3_u32 v226, v226, v253, v232
    v_cvt_pk_bf16_f32 v187, v206, v207
    v_mfma_f32_16x16x32_bf16 v[204:207], a[96:99], a[16:19], 0
    v_exp_f32 v200, v200
    v_mfma_f32_16x16x32_bf16 v[204:207], a[212:215], a[20:23], v[204:207]
    ds_read_b128 a[232:235], v235 offset:20480
    v_min3_u32 v227, v227, v253, v232
    v_mfma_f32_16x16x32_bf16 v[204:207], a[216:219], a[24:27], v[204:207]
    ds_read_b128 a[236:239], v231 offset:20480
    v_exp_f32 v201, v201
    v_mfma_f32_16x16x32_bf16 v[204:207], a[220:223], a[28:31], v[204:207]
    s_waitcnt lgkmcnt(6)
    ds_read_b64_tr_b16 v[216:217], v225 offset:4096
    v_accvgpr_read_b32 v253, a244
    v_mfma_f32_16x16x32_bf16 v[0:3], v[208:211], v[180:183], v[0:3]
    v_exp_f32 v202, v202
    v_mfma_f32_16x16x32_bf16 v[32:35], v[208:211], v[184:187], v[32:35]
    s_waitcnt lgkmcnt(4)
    ds_read_b64_tr_b16 v[218:219], v225 offset:6144
    v_accvgpr_read_b32 v254, a245
    v_mfma_f32_16x16x32_bf16 v[4:7], v[212:215], v[180:183], v[4:7]
    ds_write_b64 v228, a[118:119] offset:4104
    v_mfma_f32_16x16x32_bf16 v[36:39], v[212:215], v[184:187], v[36:39]
    ds_read_b64_tr_b16 v[220:221], v225 offset:4104
    v_add_f32 v253, v253, v254
    v_smfmac_f32_16x16x64_bf16 a[240:243], a[252:255], v[180:187], v233
    buffer_store_dwordx4 v[188:191], v230, s[20:23], s30 offen offset:192
    v_exp_f32 v203, v203
    v_cvt_pk_bf16_f32 v160, v200, v201
    v_cvt_pk_bf16_f32 v161, v202, v203
    v_mfma_f32_16x16x32_bf16 v[200:203], a[100:103], a[0:3], 0
    s_waitcnt lgkmcnt(6)
    ds_read_b64_tr_b16 v[222:223], v225 offset:6152
    v_rcp_f32 v250, v253
    v_mfma_f32_16x16x32_bf16 v[200:203], a[228:231], a[4:7], v[200:203]
    s_waitcnt lgkmcnt(6)
    ds_read_b64_tr_b16 v[208:209], v224 offset:36864
    v_accvgpr_read_b32 v232, a246
    v_mfma_f32_16x16x32_bf16 v[200:203], a[232:235], a[8:11], v[200:203]
    s_waitcnt lgkmcnt(6)
    v_exp_f32 v204, v204
    v_mfma_f32_16x16x32_bf16 v[200:203], a[236:239], a[12:15], v[200:203]
    s_waitcnt lgkmcnt(4)
    ds_read_b64_tr_b16 v[210:211], v224 offset:38912
    v_accvgpr_read_b32 v254, a247
    v_mfma_f32_16x16x32_bf16 v[8:11], v[216:219], v[180:183], v[8:11]
    v_exp_f32 v205, v205
    v_mul_f32 v64, v64, v250
    v_mul_f32 v65, v65, v250
    v_mul_f32 v66, v66, v250
    v_mul_f32 v67, v67, v250
    v_cvt_pk_bf16_f32 v64, v64, v65
    v_cvt_pk_bf16_f32 v65, v66, v67
    v_mul_f32 v68, v68, v250
    v_mul_f32 v69, v69, v250
    v_mul_f32 v70, v70, v250
    v_mul_f32 v71, v71, v250
    v_cvt_pk_bf16_f32 v66, v68, v69
    v_cvt_pk_bf16_f32 v67, v70, v71
    buffer_store_dwordx4 v[64:67], v230, s[20:23], s32 offen offset:0
    v_mfma_f32_16x16x32_bf16 v[40:43], v[216:219], v[184:187], v[40:43]
    s_waitcnt lgkmcnt(2)
    ds_write_b64 v228, a[120:121] offset:8192
    v_mfma_f32_16x16x32_bf16 v[12:15], v[220:223], v[180:183], v[12:15]
    ds_read_b64_tr_b16 v[212:213], v224 offset:36872
    v_exp_f32 v206, v206
    v_mfma_f32_16x16x32_bf16 v[44:47], v[220:223], v[184:187], v[44:47]
    ds_read_b64_tr_b16 v[214:215], v224 offset:38920
    v_add_f32 v232, v232, v254
    v_exp_f32 v207, v207
    v_cvt_pk_bf16_f32 v164, v204, v205
    v_cvt_pk_bf16_f32 v165, v206, v207
    v_mfma_f32_16x16x32_bf16 v[204:207], a[100:103], a[16:19], 0
    ds_read_b128 a[212:215], v229 offset:24576
    v_rcp_f32 v251, v232
    v_mfma_f32_16x16x32_bf16 v[204:207], a[228:231], a[20:23], v[204:207]
    ds_read_b128 a[216:219], v235 offset:24576
    v_mul_f32 v96, v96, v251
    v_mfma_f32_16x16x32_bf16 v[204:207], a[232:235], a[24:27], v[204:207]
    ds_read_b128 a[220:223], v231 offset:24576
    v_exp_f32 v200, v200
    v_mfma_f32_16x16x32_bf16 v[204:207], a[236:239], a[28:31], v[204:207]
    s_waitcnt lgkmcnt(6)
    ds_read_b64_tr_b16 v[216:217], v225 offset:36864
    v_mul_f32 v97, v97, v251
    v_mfma_f32_16x16x32_bf16 v[16:19], v[208:211], v[180:183], v[16:19]
    ds_read_b64_tr_b16 v[218:219], v225 offset:38912
    v_exp_f32 v201, v201
    v_mfma_f32_16x16x32_bf16 v[48:51], v[208:211], v[184:187], v[48:51]
    s_waitcnt lgkmcnt(5)
    ds_read_b64_tr_b16 v[220:221], v225 offset:36872
    v_mul_f32 v98, v98, v251
    v_mfma_f32_16x16x32_bf16 v[20:23], v[212:215], v[180:183], v[20:23]
    ds_read_b64_tr_b16 v[222:223], v225 offset:38920
    v_exp_f32 v202, v202
    v_mfma_f32_16x16x32_bf16 v[52:55], v[212:215], v[184:187], v[52:55]
    ds_write_b64 v228, a[122:123] offset:8200
    v_exp_f32 v203, v203
    v_cvt_pk_bf16_f32 v162, v200, v201
    v_cvt_pk_bf16_f32 v163, v202, v203
    v_mfma_f32_16x16x32_bf16 v[200:203], a[104:107], a[0:3], 0
    s_waitcnt lgkmcnt(7)
    v_exp_f32 v204, v204
    v_mfma_f32_16x16x32_bf16 v[200:203], a[212:215], a[4:7], v[200:203]
    s_waitcnt lgkmcnt(6)
    ds_read_b64_tr_b16 v[208:209], v224 offset:8192
    v_mul_f32 v99, v99, v251
    v_mfma_f32_16x16x32_bf16 v[200:203], a[216:219], a[8:11], v[200:203]
    s_waitcnt lgkmcnt(6)
    v_exp_f32 v205, v205
    v_mfma_f32_16x16x32_bf16 v[200:203], a[220:223], a[12:15], v[200:203]
    s_waitcnt lgkmcnt(4)
    ds_read_b64_tr_b16 v[210:211], v224 offset:10240
    v_cvt_pk_bf16_f32 v96, v96, v97
    v_mfma_f32_16x16x32_bf16 v[24:27], v[216:219], v[180:183], v[24:27]
    v_exp_f32 v206, v206
    v_cvt_pk_bf16_f32 v97, v98, v99
    v_mul_f32 v100, v100, v251
    v_mul_f32 v101, v101, v251
    v_mul_f32 v102, v102, v251
    v_mul_f32 v103, v103, v251
    v_cvt_pk_bf16_f32 v98, v100, v101
    v_cvt_pk_bf16_f32 v99, v102, v103
    buffer_store_dwordx4 v[96:99], v230, s[20:23], s33 offen offset:0
    v_mfma_f32_16x16x32_bf16 v[56:59], v[216:219], v[184:187], v[56:59]
    s_waitcnt lgkmcnt(3)
    ds_read_b64_tr_b16 v[212:213], v224 offset:8200
    v_mul_f32 v72, v72, v250
    v_mfma_f32_16x16x32_bf16 v[28:31], v[220:223], v[180:183], v[28:31]
    v_exp_f32 v207, v207
    v_mfma_f32_16x16x32_bf16 v[60:63], v[220:223], v[184:187], v[60:63]
    ds_write_b64 v228, a[124:125] offset:12288
    v_cvt_pk_bf16_f32 v166, v204, v205
    v_cvt_pk_bf16_f32 v167, v206, v207
    v_mfma_f32_16x16x32_bf16 v[204:207], a[104:107], a[16:19], 0
    v_exp_f32 v200, v200
    v_mfma_f32_16x16x32_bf16 v[204:207], a[212:215], a[20:23], v[204:207]
    ds_read_b64_tr_b16 v[214:215], v224 offset:10248
    v_mul_f32 v73, v73, v250
    v_mfma_f32_16x16x32_bf16 v[204:207], a[216:219], a[24:27], v[204:207]
    v_exp_f32 v201, v201
    v_mfma_f32_16x16x32_bf16 v[204:207], a[220:223], a[28:31], v[204:207]
    s_waitcnt lgkmcnt(3)
    v_exp_f32 v202, v202
    v_mfma_f32_16x16x32_bf16 v[0:3], v[208:211], v[160:163], v[0:3]
    ds_read_b128 a[228:231], v229 offset:28672
    v_mul_f32 v74, v74, v250
    v_mfma_f32_16x16x32_bf16 v[32:35], v[208:211], v[164:167], v[32:35]
    v_exp_f32 v203, v203
    v_smfmac_f32_16x16x64_bf16 a[240:243], a[252:255], v[160:167], v233
    s_waitcnt vmcnt(12)
    ds_read_b128 a[232:235], v235 offset:28672
    v_mul_f32 v75, v75, v250
    v_cvt_pk_bf16_f32 v180, v200, v201
    v_cvt_pk_bf16_f32 v181, v202, v203
    v_mfma_f32_16x16x32_bf16 v[200:203], a[104:107], a[32:35], 0
    s_waitcnt vmcnt(11)
    v_exp_f32 v204, v204
    v_mfma_f32_16x16x32_bf16 v[200:203], a[212:215], a[36:39], v[200:203]
    s_waitcnt vmcnt(10)
    ds_read_b128 a[236:239], v231 offset:28672
    v_cvt_pk_bf16_f32 v72, v72, v73
    v_mfma_f32_16x16x32_bf16 v[200:203], a[216:219], a[40:43], v[200:203]
    s_waitcnt vmcnt(9)
    ds_write_b64 v228, a[126:127] offset:12296
    v_mfma_f32_16x16x32_bf16 v[200:203], a[220:223], a[44:47], v[200:203]
    s_waitcnt lgkmcnt(4)
    ds_read_b64_tr_b16 v[216:217], v225 offset:8192
    v_exp_f32 v205, v205
    v_mfma_f32_16x16x32_bf16 v[4:7], v[212:215], v[160:163], v[4:7]
    buffer_store_dwordx4 v[192:195], v230, s[20:23], s31 offen offset:192
    v_mfma_f32_16x16x32_bf16 v[36:39], v[212:215], v[164:167], v[36:39]
    s_waitcnt vmcnt(9)
    ds_read_b64_tr_b16 v[218:219], v225 offset:10240
    v_exp_f32 v206, v206
    v_exp_f32 v207, v207
    v_cvt_pk_bf16_f32 v184, v204, v205
    v_cvt_pk_bf16_f32 v185, v206, v207
    v_mfma_f32_16x16x32_bf16 v[204:207], a[104:107], a[48:51], 0
    s_waitcnt vmcnt(8)
    v_exp_f32 v200, v200
    v_mfma_f32_16x16x32_bf16 v[204:207], a[212:215], a[52:55], v[204:207]
    s_waitcnt vmcnt(7)
    ds_read_b64_tr_b16 v[220:221], v225 offset:8200
    v_cvt_pk_bf16_f32 v73, v74, v75
    v_mfma_f32_16x16x32_bf16 v[204:207], a[216:219], a[56:59], v[204:207]
    s_waitcnt vmcnt(6)
    ds_read_b64_tr_b16 v[222:223], v225 offset:10248
    v_exp_f32 v201, v201
    v_mfma_f32_16x16x32_bf16 v[204:207], a[220:223], a[60:63], v[204:207]
    s_waitcnt lgkmcnt(2)
    s_barrier
    v_exp_f32 v202, v202
    v_mfma_f32_16x16x32_bf16 v[8:11], v[216:219], v[160:163], v[8:11]
    ds_read_b64_tr_b16 v[208:209], v224 offset:40960
    v_mul_f32 v76, v76, v250
    v_mfma_f32_16x16x32_bf16 v[40:43], v[216:219], v[164:167], v[40:43]
    v_exp_f32 v203, v203
    v_cvt_pk_bf16_f32 v188, v200, v201
    v_cvt_pk_bf16_f32 v189, v202, v203
    v_mfma_f32_16x16x32_bf16 v[200:203], a[108:111], a[0:3], 0
    v_exp_f32 v204, v204
    v_mfma_f32_16x16x32_bf16 v[200:203], a[228:231], a[4:7], v[200:203]
    ds_read_b64_tr_b16 v[210:211], v224 offset:43008
    v_mul_f32 v77, v77, v250
    v_mfma_f32_16x16x32_bf16 v[200:203], a[232:235], a[8:11], v[200:203]
    v_exp_f32 v205, v205
    v_mfma_f32_16x16x32_bf16 v[200:203], a[236:239], a[12:15], v[200:203]
    s_waitcnt lgkmcnt(2)
    v_exp_f32 v206, v206
    v_mfma_f32_16x16x32_bf16 v[12:15], v[220:223], v[160:163], v[12:15]
    ds_read_b64_tr_b16 v[212:213], v224 offset:40968
    v_mul_f32 v78, v78, v250
    v_mfma_f32_16x16x32_bf16 v[44:47], v[220:223], v[164:167], v[44:47]
    v_exp_f32 v207, v207
    v_cvt_pk_bf16_f32 v192, v204, v205
    v_cvt_pk_bf16_f32 v193, v206, v207
    v_mfma_f32_16x16x32_bf16 v[204:207], a[108:111], a[16:19], 0
    v_exp_f32 v200, v200
    v_mfma_f32_16x16x32_bf16 v[204:207], a[228:231], a[20:23], v[204:207]
    buffer_store_dwordx4 v[236:239], v230, s[20:23], s30 offen offset:0
    v_mfma_f32_16x16x32_bf16 v[204:207], a[232:235], a[24:27], v[204:207]
    ds_read_b64_tr_b16 v[214:215], v224 offset:43016
    v_exp_f32 v201, v201
    v_mfma_f32_16x16x32_bf16 v[204:207], a[236:239], a[28:31], v[204:207]
    s_waitcnt lgkmcnt(2)
    v_exp_f32 v202, v202
    v_mfma_f32_16x16x32_bf16 v[16:19], v[208:211], v[160:163], v[16:19]
    ds_write_b64 v228, a[128:129] offset:16384
    v_mfma_f32_16x16x32_bf16 v[48:51], v[208:211], v[164:167], v[48:51]
    v_exp_f32 v203, v203
    v_cvt_pk_bf16_f32 v182, v200, v201
    v_cvt_pk_bf16_f32 v183, v202, v203
    v_mfma_f32_16x16x32_bf16 v[200:203], a[108:111], a[32:35], 0
    v_exp_f32 v204, v204
    v_mfma_f32_16x16x32_bf16 v[200:203], a[228:231], a[36:39], v[200:203]
    v_exp_f32 v205, v205
    v_mfma_f32_16x16x32_bf16 v[200:203], a[232:235], a[40:43], v[200:203]
    ds_read_b128 a[212:215], v229 offset:0
    v_mul_f32 v79, v79, v250
    v_mfma_f32_16x16x32_bf16 v[200:203], a[236:239], a[44:47], v[200:203]
    s_waitcnt lgkmcnt(2)
    ds_read_b128 a[216:219], v235 offset:0
    v_exp_f32 v206, v206
    v_mfma_f32_16x16x32_bf16 v[20:23], v[212:215], v[160:163], v[20:23]
    ds_read_b128 a[220:223], v231 offset:0
    v_exp_f32 v207, v207
    v_cvt_pk_bf16_f32 v186, v204, v205
    v_cvt_pk_bf16_f32 v187, v206, v207
    v_mfma_f32_16x16x32_bf16 v[204:207], a[108:111], a[48:51], 0
    v_exp_f32 v200, v200
    v_mfma_f32_16x16x32_bf16 v[204:207], a[228:231], a[52:55], v[204:207]
    ds_read_b64_tr_b16 v[216:217], v225 offset:40960
    v_exp_f32 v201, v201
    v_mfma_f32_16x16x32_bf16 v[204:207], a[232:235], a[56:59], v[204:207]
    ds_read_b64_tr_b16 v[218:219], v225 offset:43008
    v_cvt_pk_bf16_f32 v74, v76, v77
    v_mfma_f32_16x16x32_bf16 v[204:207], a[236:239], a[60:63], v[204:207]
    ds_read_b64_tr_b16 v[220:221], v225 offset:40968
    v_exp_f32 v202, v202
    v_mfma_f32_16x16x32_bf16 v[52:55], v[212:215], v[164:167], v[52:55]
    ds_read_b64_tr_b16 v[222:223], v225 offset:43016
    v_exp_f32 v203, v203
    v_cvt_pk_bf16_f32 v190, v200, v201
    v_cvt_pk_bf16_f32 v191, v202, v203
    v_mfma_f32_16x16x32_bf16 v[200:203], a[112:115], a[0:3], 0
    s_waitcnt lgkmcnt(6)
    v_exp_f32 v204, v204
    v_mfma_f32_16x16x32_bf16 v[200:203], a[212:215], a[4:7], v[200:203]
    s_waitcnt lgkmcnt(5)
    buffer_store_dwordx4 v[240:243], v230, s[20:23], s31 offen offset:0
    v_mfma_f32_16x16x32_bf16 v[200:203], a[216:219], a[8:11], v[200:203]
    s_waitcnt lgkmcnt(4)
    ds_write_b64 v228, a[130:131] offset:16392
    v_mfma_f32_16x16x32_bf16 v[200:203], a[220:223], a[12:15], v[200:203]
    s_waitcnt lgkmcnt(3)
    ds_read_b64_tr_b16 v[208:209], v224 offset:12288
    v_cvt_pk_bf16_f32 v75, v78, v79
    buffer_store_dwordx4 v[72:75], v230, s[20:23], s32 offen offset:64
    v_mfma_f32_16x16x32_bf16 v[24:27], v[216:219], v[160:163], v[24:27]
    ds_read_b64_tr_b16 v[210:211], v224 offset:14336
    v_exp_f32 v205, v205
    v_mfma_f32_16x16x32_bf16 v[56:59], v[216:219], v[164:167], v[56:59]
    s_waitcnt lgkmcnt(3)
    ds_read_b64_tr_b16 v[212:213], v224 offset:12296
    v_mul_f32 v104, v104, v251
    v_mfma_f32_16x16x32_bf16 v[28:31], v[220:223], v[160:163], v[28:31]
    v_exp_f32 v206, v206
    v_mfma_f32_16x16x32_bf16 v[60:63], v[220:223], v[164:167], v[60:63]
    ds_read_b64_tr_b16 v[214:215], v224 offset:14344
    v_mul_f32 v105, v105, v251
    v_exp_f32 v207, v207
    v_cvt_pk_bf16_f32 v194, v204, v205
    v_cvt_pk_bf16_f32 v195, v206, v207
    v_mfma_f32_16x16x32_bf16 v[204:207], a[112:115], a[16:19], 0
L_pad6:
    s_cbranch_vccnz L_pad10
    v_exp_f32 v200, v200
    v_mfma_f32_16x16x32_bf16 v[204:207], a[212:215], a[20:23], v[204:207]
    ds_read_b64_tr_b16 v[216:217], v225 offset:12288
    v_mul_f32 v106, v106, v251
    v_mfma_f32_16x16x32_bf16 v[204:207], a[216:219], a[24:27], v[204:207]
    v_exp_f32 v201, v201
    v_mfma_f32_16x16x32_bf16 v[204:207], a[220:223], a[28:31], v[204:207]
    s_waitcnt lgkmcnt(3)
    ds_read_b64_tr_b16 v[218:219], v225 offset:14336
    v_mul_f32 v107, v107, v251
    v_mfma_f32_16x16x32_bf16 v[0:3], v[208:211], v[180:183], v[0:3]
    v_exp_f32 v202, v202
    v_mfma_f32_16x16x32_bf16 v[32:35], v[208:211], v[184:187], v[32:35]
    ds_read_b128 a[228:231], v229 offset:4096
    v_cvt_pk_bf16_f32 v104, v104, v105
    v_mfma_f32_16x16x32_bf16 v[64:67], v[208:211], v[188:191], 0
    v_exp_f32 v203, v203
    v_mfma_f32_16x16x32_bf16 v[96:99], v[208:211], v[192:195], 0
    ds_read_b128 a[232:235], v235 offset:4096
    v_cvt_pk_bf16_f32 v105, v106, v107
    v_smfmac_f32_16x16x64_bf16 a[240:243], a[252:255], v[180:187], v233
    ds_write_b64 v228, a[132:133] offset:20480
    v_cvt_pk_bf16_f32 v160, v200, v201
    v_cvt_pk_bf16_f32 v161, v202, v203
    v_mfma_f32_16x16x32_bf16 v[200:203], a[112:115], a[32:35], 0
    v_exp_f32 v204, v204
    v_mfma_f32_16x16x32_bf16 v[200:203], a[212:215], a[36:39], v[200:203]
    ds_read_b128 a[236:239], v231 offset:4096
    v_mul_f32 v108, v108, v251
    v_mfma_f32_16x16x32_bf16 v[200:203], a[216:219], a[40:43], v[200:203]
    v_exp_f32 v205, v205
    v_mul_f32 v109, v109, v251
    v_mul_f32 v110, v110, v251
    v_mul_f32 v111, v111, v251
    v_cvt_pk_bf16_f32 v106, v108, v109
    v_cvt_pk_bf16_f32 v107, v110, v111
    buffer_store_dwordx4 v[104:107], v230, s[20:23], s33 offen offset:64
    v_mfma_f32_16x16x32_bf16 v[200:203], a[220:223], a[44:47], v[200:203]
    s_waitcnt lgkmcnt(6)
    ds_read_b64_tr_b16 v[220:221], v225 offset:12296
    v_mul_f32 v80, v80, v250
    v_mfma_f32_16x16x32_bf16 v[4:7], v[212:215], v[180:183], v[4:7]
    v_exp_f32 v206, v206
    v_mfma_f32_16x16x32_bf16 v[36:39], v[212:215], v[184:187], v[36:39]
    ds_read_b64_tr_b16 v[222:223], v225 offset:14344
    v_mul_f32 v81, v81, v250
    v_mfma_f32_16x16x32_bf16 v[68:71], v[212:215], v[188:191], 0
    v_exp_f32 v207, v207
    v_mfma_f32_16x16x32_bf16 v[100:103], v[212:215], v[192:195], 0
    ds_read_b64_tr_b16 v[208:209], v224 offset:45056
    v_mul_f32 v82, v82, v250
    v_cvt_pk_bf16_f32 v164, v204, v205
    v_cvt_pk_bf16_f32 v165, v206, v207
    v_mfma_f32_16x16x32_bf16 v[204:207], a[112:115], a[48:51], 0
    v_exp_f32 v200, v200
    v_mfma_f32_16x16x32_bf16 v[204:207], a[212:215], a[52:55], v[204:207]
    ds_read_b64_tr_b16 v[210:211], v224 offset:47104
    v_mul_f32 v83, v83, v250
    v_mfma_f32_16x16x32_bf16 v[204:207], a[216:219], a[56:59], v[204:207]
    v_exp_f32 v201, v201
    v_mfma_f32_16x16x32_bf16 v[204:207], a[220:223], a[60:63], v[204:207]
    s_waitcnt lgkmcnt(8)
    ds_read_b128 a[212:215], v229 offset:8192
    v_cvt_pk_bf16_f32 v80, v80, v81
    v_mfma_f32_16x16x32_bf16 v[8:11], v[216:219], v[180:183], v[8:11]
    v_exp_f32 v202, v202
    v_mfma_f32_16x16x32_bf16 v[40:43], v[216:219], v[184:187], v[40:43]
    ds_write_b64 v228, a[134:135] offset:20488
    v_mfma_f32_16x16x32_bf16 v[72:75], v[216:219], v[188:191], 0
    v_exp_f32 v203, v203
    v_mfma_f32_16x16x32_bf16 v[104:107], v[216:219], v[192:195], 0
    ds_read_b64_tr_b16 v[212:213], v224 offset:45064
    v_cvt_pk_bf16_f32 v81, v82, v83
    v_cvt_pk_bf16_f32 v168, v200, v201
    v_cvt_pk_bf16_f32 v169, v202, v203
    v_mfma_f32_16x16x32_bf16 v[200:203], a[116:119], a[0:3], 0
    s_waitcnt lgkmcnt(10)
    v_exp_f32 v204, v204
    v_mfma_f32_16x16x32_bf16 v[200:203], a[228:231], a[4:7], v[200:203]
    s_waitcnt lgkmcnt(9)
    ds_read_b64_tr_b16 v[214:215], v224 offset:47112
    v_mul_f32 v84, v84, v250
    v_mfma_f32_16x16x32_bf16 v[200:203], a[232:235], a[8:11], v[200:203]
    s_waitcnt lgkmcnt(8)
    v_exp_f32 v205, v205
    v_mul_f32 v85, v85, v250
    v_mul_f32 v86, v86, v250
    v_mul_f32 v87, v87, v250
    v_cvt_pk_bf16_f32 v82, v84, v85
    v_cvt_pk_bf16_f32 v83, v86, v87
    buffer_store_dwordx4 v[80:83], v230, s[20:23], s32 offen offset:128
    v_mfma_f32_16x16x32_bf16 v[200:203], a[236:239], a[12:15], v[200:203]
    s_waitcnt lgkmcnt(6)
    ds_read_b128 a[216:219], v235 offset:8192
    v_mul_f32 v112, v112, v251
    v_mfma_f32_16x16x32_bf16 v[12:15], v[220:223], v[180:183], v[12:15]
    v_exp_f32 v206, v206
    v_mfma_f32_16x16x32_bf16 v[44:47], v[220:223], v[184:187], v[44:47]
    ds_read_b128 a[220:223], v231 offset:8192
    v_mul_f32 v113, v113, v251
    v_mfma_f32_16x16x32_bf16 v[76:79], v[220:223], v[188:191], 0
    v_exp_f32 v207, v207
    v_mfma_f32_16x16x32_bf16 v[108:111], v[220:223], v[192:195], 0
    ds_read_b64_tr_b16 v[216:217], v225 offset:45056
    v_mul_f32 v114, v114, v251
    v_cvt_pk_bf16_f32 v172, v204, v205
    v_cvt_pk_bf16_f32 v173, v206, v207
    v_mfma_f32_16x16x32_bf16 v[204:207], a[116:119], a[16:19], 0
    v_exp_f32 v200, v200
    v_mfma_f32_16x16x32_bf16 v[204:207], a[228:231], a[20:23], v[204:207]
    ds_read_b64_tr_b16 v[218:219], v225 offset:47104
    v_mul_f32 v115, v115, v251
    v_mfma_f32_16x16x32_bf16 v[204:207], a[232:235], a[24:27], v[204:207]
    v_exp_f32 v201, v201
    v_mfma_f32_16x16x32_bf16 v[204:207], a[236:239], a[28:31], v[204:207]
    s_waitcnt lgkmcnt(8)
    ds_write_b64 v228, a[136:137] offset:24576
    v_mfma_f32_16x16x32_bf16 v[16:19], v[208:211], v[180:183], v[16:19]
    v_exp_f32 v202, v202
    v_mfma_f32_16x16x32_bf16 v[48:51], v[208:211], v[184:187], v[48:51]
    v_cvt_pk_bf16_f32 v112, v112, v113
    v_cvt_pk_bf16_f32 v113, v114, v115
    v_mfma_f32_16x16x32_bf16 v[80:83], v[208:211], v[188:191], 0
    v_exp_f32 v203, v203
    v_mul_f32 v116, v116, v251
    v_mul_f32 v117, v117, v251
    v_mul_f32 v118, v118, v251
    v_mul_f32 v119, v119, v251
    v_cvt_pk_bf16_f32 v114, v116, v117
    v_cvt_pk_bf16_f32 v115, v118, v119
    buffer_store_dwordx4 v[112:115], v230, s[20:23], s33 offen offset:128
    v_accvgpr_write_b32 a244, 0
    v_accvgpr_write_b32 a245, 0
    v_accvgpr_write_b32 a246, 0
    v_accvgpr_write_b32 a247, 0
    v_mfma_f32_16x16x32_bf16 v[112:115], v[208:211], v[192:195], 0
    ds_read_b64_tr_b16 v[220:221], v225 offset:45064
    v_mul_f32 v88, v88, v250
    v_smfmac_f32_16x16x64_bf16 a[244:247], a[252:255], v[188:195], v233
    ds_read_b64_tr_b16 v[222:223], v225 offset:47112
    v_mul_f32 v89, v89, v250
    v_cvt_pk_bf16_f32 v162, v200, v201
    v_cvt_pk_bf16_f32 v163, v202, v203
    v_mfma_f32_16x16x32_bf16 v[200:203], a[116:119], a[32:35], 0
    v_exp_f32 v204, v204
    v_mfma_f32_16x16x32_bf16 v[200:203], a[228:231], a[36:39], v[200:203]
    v_mul_f32 v90, v90, v250
    v_mul_f32 v91, v91, v250
    v_mfma_f32_16x16x32_bf16 v[200:203], a[232:235], a[40:43], v[200:203]
    v_exp_f32 v205, v205
    v_mfma_f32_16x16x32_bf16 v[200:203], a[236:239], a[44:47], v[200:203]
    s_waitcnt lgkmcnt(7)
    v_cvt_pk_bf16_f32 v88, v88, v89
    v_cvt_pk_bf16_f32 v89, v90, v91
    v_mfma_f32_16x16x32_bf16 v[20:23], v[212:215], v[180:183], v[20:23]
    v_exp_f32 v206, v206
    v_mfma_f32_16x16x32_bf16 v[52:55], v[212:215], v[184:187], v[52:55]
    v_mul_f32 v92, v92, v250
    v_mul_f32 v93, v93, v250
    v_mfma_f32_16x16x32_bf16 v[84:87], v[212:215], v[188:191], 0
    v_exp_f32 v207, v207
    v_mfma_f32_16x16x32_bf16 v[116:119], v[212:215], v[192:195], 0
    ds_read_b64_tr_b16 v[208:209], v224 offset:16384
    v_mul_f32 v94, v94, v250
    v_cvt_pk_bf16_f32 v166, v204, v205
    v_cvt_pk_bf16_f32 v167, v206, v207
    v_mfma_f32_16x16x32_bf16 v[204:207], a[116:119], a[48:51], 0
    ds_write_b64 v228, a[138:139] offset:24584
    v_mfma_f32_16x16x32_bf16 v[204:207], a[228:231], a[52:55], v[204:207]
    ds_read_b64_tr_b16 v[210:211], v224 offset:18432
    v_mul_f32 v95, v95, v250
    v_mfma_f32_16x16x32_bf16 v[204:207], a[232:235], a[56:59], v[204:207]
    v_exp_f32 v200, v200
    v_mfma_f32_16x16x32_bf16 v[204:207], a[236:239], a[60:63], v[204:207]
    s_waitcnt lgkmcnt(6)
    buffer_store_dwordx4 v[244:247], v230, s[20:23], s30 offen offset:64
    v_mfma_f32_16x16x32_bf16 v[24:27], v[216:219], v[180:183], v[24:27]
    v_exp_f32 v201, v201
    v_mfma_f32_16x16x32_bf16 v[56:59], v[216:219], v[184:187], v[56:59]
    ds_read_b128 a[228:231], v229 offset:12288
    v_cvt_pk_bf16_f32 v90, v92, v93
    v_cvt_pk_bf16_f32 v91, v94, v95
    buffer_store_dwordx4 v[88:91], v230, s[20:23], s32 offen offset:192
    s_nop 1
    v_mfma_f32_16x16x32_bf16 v[88:91], v[216:219], v[188:191], 0
    v_exp_f32 v202, v202
    v_mul_f32 v120, v120, v251
    v_mul_f32 v121, v121, v251
    v_mul_f32 v122, v122, v251
    v_mul_f32 v123, v123, v251
    v_cvt_pk_bf16_f32 v120, v120, v121
    v_cvt_pk_bf16_f32 v121, v122, v123
    v_mul_f32 v124, v124, v251
    v_mul_f32 v125, v125, v251
    v_mul_f32 v126, v126, v251
    v_mul_f32 v127, v127, v251
    v_cvt_pk_bf16_f32 v122, v124, v125
    v_cvt_pk_bf16_f32 v123, v126, v127
    buffer_store_dwordx4 v[120:123], v230, s[20:23], s33 offen offset:192
    s_nop 1
    v_mfma_f32_16x16x32_bf16 v[120:123], v[216:219], v[192:195], 0
    ds_read_b64_tr_b16 v[212:213], v224 offset:16392
    v_cvt_pk_bf16_f32 v170, v200, v201
    v_exp_f32 v203, v203
    v_max3_u32 v226, v226, v253, v232
    v_cvt_pk_bf16_f32 v171, v202, v203
    v_mfma_f32_16x16x32_bf16 v[200:203], a[120:123], a[0:3], 0
    v_exp_f32 v204, v204
    v_mfma_f32_16x16x32_bf16 v[200:203], a[212:215], a[4:7], v[200:203]
    ds_read_b64_tr_b16 v[214:215], v224 offset:18440
    v_min3_u32 v227, v227, v253, v232
    v_mfma_f32_16x16x32_bf16 v[200:203], a[216:219], a[8:11], v[200:203]
    v_exp_f32 v205, v205
    v_mfma_f32_16x16x32_bf16 v[200:203], a[220:223], a[12:15], v[200:203]
    s_waitcnt lgkmcnt(6)
    ds_read_b128 a[232:235], v235 offset:12288
    v_accvgpr_read_b32 v253, a250
    v_mfma_f32_16x16x32_bf16 v[28:31], v[220:223], v[180:183], v[28:31]
    v_exp_f32 v206, v206
    v_mfma_f32_16x16x32_bf16 v[60:63], v[220:223], v[184:187], v[60:63]
    ds_read_b128 a[236:239], v231 offset:12288
    v_accvgpr_read_b32 v254, a251
    v_mfma_f32_16x16x32_bf16 v[92:95], v[220:223], v[188:191], 0
    ds_write_b64 v228, a[140:141] offset:28672
    v_mfma_f32_16x16x32_bf16 v[124:127], v[220:223], v[192:195], 0
    ds_read_b64_tr_b16 v[216:217], v225 offset:16384
    v_add_f32 v253, v253, v254
    v_exp_f32 v207, v207
    v_cvt_pk_bf16_f32 v174, v204, v205
    v_cvt_pk_bf16_f32 v175, v206, v207
    v_mfma_f32_16x16x32_bf16 v[204:207], a[120:123], a[16:19], 0
    v_rcp_f32 v252, v253
    v_mfma_f32_16x16x32_bf16 v[204:207], a[212:215], a[20:23], v[204:207]
    ds_read_b64_tr_b16 v[218:219], v225 offset:18432
    v_max_u32 v226, v226, v253
    v_mfma_f32_16x16x32_bf16 v[204:207], a[216:219], a[24:27], v[204:207]
    v_exp_f32 v200, v200
    v_mfma_f32_16x16x32_bf16 v[204:207], a[220:223], a[28:31], v[204:207]
    s_waitcnt lgkmcnt(8)
    v_exp_f32 v201, v201
    v_mfma_f32_16x16x32_bf16 v[0:3], v[208:211], v[160:163], v[0:3]
    v_exp_f32 v202, v202
    v_mfma_f32_16x16x32_bf16 v[32:35], v[208:211], v[164:167], v[32:35]
    v_exp_f32 v203, v203
    v_mfma_f32_16x16x32_bf16 v[64:67], v[208:211], v[168:171], v[64:67]
    v_cvt_pk_bf16_f32 v180, v200, v201
    v_cvt_pk_bf16_f32 v181, v202, v203
    v_mfma_f32_16x16x32_bf16 v[96:99], v[208:211], v[172:175], v[96:99]
    ds_read_b64_tr_b16 v[220:221], v225 offset:16392
    v_min_u32 v227, v227, v253
    v_smfmac_f32_16x16x64_bf16 a[240:243], a[252:255], v[160:167], v233
    ds_read_b64_tr_b16 v[222:223], v225 offset:18440
    v_mul_f32 v128, v128, v252
    v_mfma_f32_16x16x32_bf16 v[200:203], a[120:123], a[32:35], 0
    v_exp_f32 v204, v204
    v_mfma_f32_16x16x32_bf16 v[200:203], a[212:215], a[36:39], v[200:203]
    v_exp_f32 v205, v205
    v_mfma_f32_16x16x32_bf16 v[200:203], a[216:219], a[40:43], v[200:203]
    v_exp_f32 v206, v206
    v_mfma_f32_16x16x32_bf16 v[200:203], a[220:223], a[44:47], v[200:203]
    s_waitcnt lgkmcnt(7)
    ds_write_b64 v228, a[142:143] offset:28680
    v_mfma_f32_16x16x32_bf16 v[4:7], v[212:215], v[160:163], v[4:7]
    v_exp_f32 v207, v207
    v_mfma_f32_16x16x32_bf16 v[36:39], v[212:215], v[164:167], v[36:39]
    v_cvt_pk_bf16_f32 v184, v204, v205
    v_cvt_pk_bf16_f32 v185, v206, v207
    v_mfma_f32_16x16x32_bf16 v[68:71], v[212:215], v[168:171], v[68:71]
    v_mul_f32 v129, v129, v252
    v_mul_f32 v130, v130, v252
    v_mfma_f32_16x16x32_bf16 v[100:103], v[212:215], v[172:175], v[100:103]
    ds_read_b64_tr_b16 v[208:209], v224 offset:49152
    v_mul_f32 v131, v131, v252
    v_mfma_f32_16x16x32_bf16 v[204:207], a[120:123], a[48:51], 0
    v_exp_f32 v200, v200
    v_mfma_f32_16x16x32_bf16 v[204:207], a[212:215], a[52:55], v[204:207]
    ds_read_b64_tr_b16 v[210:211], v224 offset:51200
    v_cvt_pk_bf16_f32 v128, v128, v129
    v_mfma_f32_16x16x32_bf16 v[204:207], a[216:219], a[56:59], v[204:207]
    v_exp_f32 v201, v201
    v_mfma_f32_16x16x32_bf16 v[204:207], a[220:223], a[60:63], v[204:207]
    s_waitcnt lgkmcnt(2)
    s_barrier
    ds_read_b128 a[212:215], v229 offset:16384
    v_cvt_pk_bf16_f32 v188, v200, v201
    v_mfma_f32_16x16x32_bf16 v[8:11], v[216:219], v[160:163], v[8:11]
    v_exp_f32 v202, v202
    v_mfma_f32_16x16x32_bf16 v[40:43], v[216:219], v[164:167], v[40:43]
    ds_read_b128 a[216:219], v235 offset:16384
    v_cvt_pk_bf16_f32 v129, v130, v131
    v_mfma_f32_16x16x32_bf16 v[72:75], v[216:219], v[168:171], v[72:75]
    v_exp_f32 v203, v203
    v_mfma_f32_16x16x32_bf16 v[104:107], v[216:219], v[172:175], v[104:107]
    buffer_store_dwordx4 v[176:179], v230, s[20:23], s31 offen offset:64
    v_cvt_pk_bf16_f32 v189, v202, v203
    v_mfma_f32_16x16x32_bf16 v[200:203], a[124:127], a[0:3], 0
    v_exp_f32 v204, v204
    v_mfma_f32_16x16x32_bf16 v[200:203], a[228:231], a[4:7], v[200:203]
    ds_read_b64_tr_b16 v[212:213], v224 offset:49160
    v_mul_f32 v132, v132, v252
    v_mfma_f32_16x16x32_bf16 v[200:203], a[232:235], a[8:11], v[200:203]
    v_exp_f32 v205, v205
    v_mfma_f32_16x16x32_bf16 v[200:203], a[236:239], a[12:15], v[200:203]
    ds_read_b64_tr_b16 v[214:215], v224 offset:51208
    v_cvt_pk_bf16_f32 v192, v204, v205
    v_mfma_f32_16x16x32_bf16 v[12:15], v[220:223], v[160:163], v[12:15]
    v_exp_f32 v206, v206
    v_mfma_f32_16x16x32_bf16 v[44:47], v[220:223], v[164:167], v[44:47]
    ds_read_b128 a[220:223], v231 offset:16384
    v_mul_f32 v133, v133, v252
    v_mfma_f32_16x16x32_bf16 v[76:79], v[220:223], v[168:171], v[76:79]
    v_exp_f32 v207, v207
    v_mfma_f32_16x16x32_bf16 v[108:111], v[220:223], v[172:175], v[108:111]
    ds_read_b64_tr_b16 v[216:217], v225 offset:49152
    v_cvt_pk_bf16_f32 v193, v206, v207
    v_mfma_f32_16x16x32_bf16 v[204:207], a[124:127], a[16:19], 0
    v_exp_f32 v200, v200
    v_mfma_f32_16x16x32_bf16 v[204:207], a[228:231], a[20:23], v[204:207]
    ds_write_b64 v228, a[144:145] offset:0
    v_mfma_f32_16x16x32_bf16 v[204:207], a[232:235], a[24:27], v[204:207]
    v_exp_f32 v201, v201
    v_mfma_f32_16x16x32_bf16 v[204:207], a[236:239], a[28:31], v[204:207]
    s_waitcnt lgkmcnt(7)
    ds_read_b64_tr_b16 v[218:219], v225 offset:51200
    v_cvt_pk_bf16_f32 v182, v200, v201
    v_mfma_f32_16x16x32_bf16 v[16:19], v[208:211], v[160:163], v[16:19]
    v_exp_f32 v202, v202
    v_mfma_f32_16x16x32_bf16 v[48:51], v[208:211], v[164:167], v[48:51]
    v_exp_f32 v203, v203
    v_mfma_f32_16x16x32_bf16 v[80:83], v[208:211], v[168:171], v[80:83]
    v_cvt_pk_bf16_f32 v183, v202, v203
    v_mul_f32 v134, v134, v252
    v_mfma_f32_16x16x32_bf16 v[112:115], v[208:211], v[172:175], v[112:115]
    ds_read_b64_tr_b16 v[220:221], v225 offset:49160
    v_mul_f32 v135, v135, v252
    v_smfmac_f32_16x16x64_bf16 a[244:247], a[252:255], v[168:175], v233
    ds_read_b64_tr_b16 v[222:223], v225 offset:51208
    v_cvt_pk_bf16_f32 v130, v132, v133
    v_mfma_f32_16x16x32_bf16 v[200:203], a[124:127], a[32:35], 0
    v_exp_f32 v204, v204
    v_mfma_f32_16x16x32_bf16 v[200:203], a[228:231], a[36:39], v[200:203]
    v_exp_f32 v205, v205
    v_mfma_f32_16x16x32_bf16 v[200:203], a[232:235], a[40:43], v[200:203]
    v_exp_f32 v206, v206
    v_mfma_f32_16x16x32_bf16 v[200:203], a[236:239], a[44:47], v[200:203]
    s_waitcnt lgkmcnt(6)
    v_exp_f32 v207, v207
    v_mfma_f32_16x16x32_bf16 v[20:23], v[212:215], v[160:163], v[20:23]
    v_cvt_pk_bf16_f32 v186, v204, v205
    v_cvt_pk_bf16_f32 v187, v206, v207
    v_mfma_f32_16x16x32_bf16 v[52:55], v[212:215], v[164:167], v[52:55]
    v_cvt_pk_bf16_f32 v131, v134, v135
    v_mul_f32 v136, v136, v252
    v_mfma_f32_16x16x32_bf16 v[84:87], v[212:215], v[168:171], v[84:87]
    buffer_store_dwordx4 v[128:131], v230, s[20:23], s34 offen offset:0
    v_mfma_f32_16x16x32_bf16 v[116:119], v[212:215], v[172:175], v[116:119]
    ds_read_b64_tr_b16 v[208:209], v224 offset:20480
    v_mul_f32 v137, v137, v252
    v_mfma_f32_16x16x32_bf16 v[204:207], a[124:127], a[48:51], 0
    ds_write_b64 v228, a[146:147] offset:8
    v_mfma_f32_16x16x32_bf16 v[204:207], a[228:231], a[52:55], v[204:207]
    ds_read_b64_tr_b16 v[210:211], v224 offset:22528
    v_mul_f32 v138, v138, v252
    v_mfma_f32_16x16x32_bf16 v[204:207], a[232:235], a[56:59], v[204:207]
    v_exp_f32 v200, v200
    v_mfma_f32_16x16x32_bf16 v[204:207], a[236:239], a[60:63], v[204:207]
    s_waitcnt lgkmcnt(5)
    ds_read_b128 a[228:231], v229 offset:20480
    v_mul_f32 v139, v139, v252
    v_mfma_f32_16x16x32_bf16 v[24:27], v[216:219], v[160:163], v[24:27]
    v_exp_f32 v201, v201
    v_mfma_f32_16x16x32_bf16 v[56:59], v[216:219], v[164:167], v[56:59]
    ds_read_b128 a[232:235], v235 offset:20480
    v_cvt_pk_bf16_f32 v190, v200, v201
    v_mfma_f32_16x16x32_bf16 v[88:91], v[216:219], v[168:171], v[88:91]
    v_exp_f32 v202, v202
    v_mfma_f32_16x16x32_bf16 v[120:123], v[216:219], v[172:175], v[120:123]
    ds_read_b64_tr_b16 v[212:213], v224 offset:20488
    v_cvt_pk_bf16_f32 v136, v136, v137
    v_exp_f32 v203, v203
    v_cvt_pk_bf16_f32 v137, v138, v139
    v_cvt_pk_bf16_f32 v191, v202, v203
    v_mfma_f32_16x16x32_bf16 v[200:203], a[128:131], a[0:3], 0
    v_exp_f32 v204, v204
    v_mfma_f32_16x16x32_bf16 v[200:203], a[212:215], a[4:7], v[200:203]
    ds_read_b64_tr_b16 v[214:215], v224 offset:22536
    v_mul_f32 v140, v140, v252
    v_mfma_f32_16x16x32_bf16 v[200:203], a[216:219], a[8:11], v[200:203]
    v_exp_f32 v205, v205
    v_mfma_f32_16x16x32_bf16 v[200:203], a[220:223], a[12:15], v[200:203]
    s_waitcnt lgkmcnt(7)
    ds_read_b128 a[236:239], v231 offset:20480
    v_cvt_pk_bf16_f32 v194, v204, v205
    v_mfma_f32_16x16x32_bf16 v[28:31], v[220:223], v[160:163], v[28:31]
    v_exp_f32 v206, v206
    v_mfma_f32_16x16x32_bf16 v[60:63], v[220:223], v[164:167], v[60:63]
    v_exp_f32 v207, v207
    v_mfma_f32_16x16x32_bf16 v[92:95], v[220:223], v[168:171], v[92:95]
    v_cvt_pk_bf16_f32 v195, v206, v207
    v_mul_f32 v141, v141, v252
    v_mfma_f32_16x16x32_bf16 v[124:127], v[220:223], v[172:175], v[124:127]
    ds_write_b64 v228, a[148:149] offset:4096
    v_mfma_f32_16x16x32_bf16 v[204:207], a[128:131], a[16:19], 0
    v_exp_f32 v200, v200
    v_mfma_f32_16x16x32_bf16 v[204:207], a[212:215], a[20:23], v[204:207]
    ds_read_b64_tr_b16 v[216:217], v225 offset:20480
    v_mul_f32 v142, v142, v252
    v_mfma_f32_16x16x32_bf16 v[204:207], a[216:219], a[24:27], v[204:207]
    v_exp_f32 v201, v201
    v_mfma_f32_16x16x32_bf16 v[204:207], a[220:223], a[28:31], v[204:207]
    s_waitcnt lgkmcnt(7)
    ds_read_b64_tr_b16 v[218:219], v225 offset:22528
    v_cvt_pk_bf16_f32 v160, v200, v201
    v_mfma_f32_16x16x32_bf16 v[0:3], v[208:211], v[180:183], v[0:3]
    v_exp_f32 v202, v202
    v_mfma_f32_16x16x32_bf16 v[32:35], v[208:211], v[184:187], v[32:35]
    v_exp_f32 v203, v203
    v_mfma_f32_16x16x32_bf16 v[64:67], v[208:211], v[188:191], v[64:67]
    v_cvt_pk_bf16_f32 v161, v202, v203
    v_mul_f32 v143, v143, v252
    v_mfma_f32_16x16x32_bf16 v[96:99], v[208:211], v[192:195], v[96:99]
    ds_read_b64_tr_b16 v[220:221], v225 offset:20488
    v_cvt_pk_bf16_f32 v138, v140, v141
    v_smfmac_f32_16x16x64_bf16 a[240:243], a[252:255], v[180:187], v233
    ds_read_b64_tr_b16 v[222:223], v225 offset:22536
    v_cvt_pk_bf16_f32 v139, v142, v143
    v_mfma_f32_16x16x32_bf16 v[200:203], a[128:131], a[32:35], 0
    v_exp_f32 v204, v204
    v_mfma_f32_16x16x32_bf16 v[200:203], a[212:215], a[36:39], v[200:203]
    buffer_store_dwordx4 v[136:139], v230, s[20:23], s34 offen offset:64
    v_mfma_f32_16x16x32_bf16 v[200:203], a[216:219], a[40:43], v[200:203]
    v_exp_f32 v205, v205
    v_mfma_f32_16x16x32_bf16 v[200:203], a[220:223], a[44:47], v[200:203]
    s_waitcnt lgkmcnt(6)
    v_exp_f32 v206, v206
    v_mfma_f32_16x16x32_bf16 v[4:7], v[212:215], v[180:183], v[4:7]
    v_exp_f32 v207, v207
    v_mfma_f32_16x16x32_bf16 v[36:39], v[212:215], v[184:187], v[36:39]
    v_cvt_pk_bf16_f32 v164, v204, v205
    v_cvt_pk_bf16_f32 v165, v206, v207
    v_mfma_f32_16x16x32_bf16 v[68:71], v[212:215], v[188:191], v[68:71]
    ds_write_b64 v228, a[150:151] offset:4104
    v_mfma_f32_16x16x32_bf16 v[100:103], v[212:215], v[192:195], v[100:103]
    ds_read_b64_tr_b16 v[208:209], v224 offset:53248
    v_mul_f32 v144, v144, v252
    v_mfma_f32_16x16x32_bf16 v[204:207], a[128:131], a[48:51], 0
    v_exp_f32 v200, v200
    v_mfma_f32_16x16x32_bf16 v[204:207], a[212:215], a[52:55], v[204:207]
    ds_read_b64_tr_b16 v[210:211], v224 offset:55296
    v_mul_f32 v145, v145, v252
    v_mfma_f32_16x16x32_bf16 v[204:207], a[216:219], a[56:59], v[204:207]
    v_exp_f32 v201, v201
    v_mfma_f32_16x16x32_bf16 v[204:207], a[220:223], a[60:63], v[204:207]
    s_waitcnt lgkmcnt(5)
    ds_read_b128 a[212:215], v229 offset:24576
    v_cvt_pk_bf16_f32 v168, v200, v201
    v_mfma_f32_16x16x32_bf16 v[8:11], v[216:219], v[180:183], v[8:11]
    v_exp_f32 v202, v202
    v_mfma_f32_16x16x32_bf16 v[40:43], v[216:219], v[184:187], v[40:43]
    ds_read_b128 a[216:219], v235 offset:24576
    v_mul_f32 v146, v146, v252
    v_mfma_f32_16x16x32_bf16 v[72:75], v[216:219], v[188:191], v[72:75]
    v_exp_f32 v203, v203
    v_mfma_f32_16x16x32_bf16 v[104:107], v[216:219], v[192:195], v[104:107]
    ds_read_b64_tr_b16 v[212:213], v224 offset:53256
    v_cvt_pk_bf16_f32 v169, v202, v203
    v_mfma_f32_16x16x32_bf16 v[200:203], a[132:135], a[0:3], 0
    v_exp_f32 v204, v204
    v_mfma_f32_16x16x32_bf16 v[200:203], a[228:231], a[4:7], v[200:203]
    ds_read_b64_tr_b16 v[214:215], v224 offset:55304
    v_mul_f32 v147, v147, v252
    v_mfma_f32_16x16x32_bf16 v[200:203], a[232:235], a[8:11], v[200:203]
    v_exp_f32 v205, v205
    v_mfma_f32_16x16x32_bf16 v[200:203], a[236:239], a[12:15], v[200:203]
    s_waitcnt lgkmcnt(7)
    ds_read_b128 a[220:223], v231 offset:24576
    v_cvt_pk_bf16_f32 v172, v204, v205
    v_mfma_f32_16x16x32_bf16 v[12:15], v[220:223], v[180:183], v[12:15]
    v_exp_f32 v206, v206
    v_mfma_f32_16x16x32_bf16 v[44:47], v[220:223], v[184:187], v[44:47]
    v_exp_f32 v207, v207
    v_mfma_f32_16x16x32_bf16 v[76:79], v[220:223], v[188:191], v[76:79]
    ds_write_b64 v228, a[152:153] offset:8192
    v_mfma_f32_16x16x32_bf16 v[108:111], v[220:223], v[192:195], v[108:111]
    ds_read_b64_tr_b16 v[216:217], v225 offset:53248
    v_cvt_pk_bf16_f32 v173, v206, v207
    v_mfma_f32_16x16x32_bf16 v[204:207], a[132:135], a[16:19], 0
    v_exp_f32 v200, v200
    v_mfma_f32_16x16x32_bf16 v[204:207], a[228:231], a[20:23], v[204:207]
    ds_read_b64_tr_b16 v[218:219], v225 offset:55296
    v_cvt_pk_bf16_f32 v144, v144, v145
    v_mfma_f32_16x16x32_bf16 v[204:207], a[232:235], a[24:27], v[204:207]
    v_exp_f32 v201, v201
    v_mfma_f32_16x16x32_bf16 v[204:207], a[236:239], a[28:31], v[204:207]
    s_waitcnt lgkmcnt(8)
    v_exp_f32 v202, v202
    v_mfma_f32_16x16x32_bf16 v[16:19], v[208:211], v[180:183], v[16:19]
    v_exp_f32 v203, v203
    v_mfma_f32_16x16x32_bf16 v[48:51], v[208:211], v[184:187], v[48:51]
    v_cvt_pk_bf16_f32 v162, v200, v201
    v_cvt_pk_bf16_f32 v163, v202, v203
    v_mfma_f32_16x16x32_bf16 v[80:83], v[208:211], v[188:191], v[80:83]
    v_cvt_pk_bf16_f32 v145, v146, v147
    v_mul_f32 v148, v148, v252
    v_mfma_f32_16x16x32_bf16 v[112:115], v[208:211], v[192:195], v[112:115]
    ds_read_b64_tr_b16 v[220:221], v225 offset:53256
    v_mul_f32 v149, v149, v252
    v_smfmac_f32_16x16x64_bf16 a[244:247], a[252:255], v[188:195], v233
    ds_read_b64_tr_b16 v[222:223], v225 offset:55304
    v_mul_f32 v150, v150, v252
    v_mfma_f32_16x16x32_bf16 v[200:203], a[132:135], a[32:35], 0
    v_exp_f32 v204, v204
    v_mfma_f32_16x16x32_bf16 v[200:203], a[228:231], a[36:39], v[200:203]
    v_exp_f32 v205, v205
    v_mfma_f32_16x16x32_bf16 v[200:203], a[232:235], a[40:43], v[200:203]
    v_exp_f32 v206, v206
    v_mfma_f32_16x16x32_bf16 v[200:203], a[236:239], a[44:47], v[200:203]
    s_waitcnt lgkmcnt(6)
    v_exp_f32 v207, v207
    v_mfma_f32_16x16x32_bf16 v[20:23], v[212:215], v[180:183], v[20:23]
    ds_write_b64 v228, a[154:155] offset:8200
    v_mfma_f32_16x16x32_bf16 v[52:55], v[212:215], v[184:187], v[52:55]
    v_cvt_pk_bf16_f32 v166, v204, v205
    v_cvt_pk_bf16_f32 v167, v206, v207
    v_mfma_f32_16x16x32_bf16 v[84:87], v[212:215], v[188:191], v[84:87]
    v_mul_f32 v151, v151, v252
    v_cvt_pk_bf16_f32 v146, v148, v149
    v_mfma_f32_16x16x32_bf16 v[116:119], v[212:215], v[192:195], v[116:119]
    ds_read_b64_tr_b16 v[208:209], v224 offset:24576
    v_cvt_pk_bf16_f32 v147, v150, v151
    v_mfma_f32_16x16x32_bf16 v[204:207], a[132:135], a[48:51], 0
    v_exp_f32 v200, v200
    v_mfma_f32_16x16x32_bf16 v[204:207], a[228:231], a[52:55], v[204:207]
    buffer_store_dwordx4 v[144:147], v230, s[20:23], s34 offen offset:128
    v_mfma_f32_16x16x32_bf16 v[204:207], a[232:235], a[56:59], v[204:207]
    v_exp_f32 v201, v201
    v_mfma_f32_16x16x32_bf16 v[204:207], a[236:239], a[60:63], v[204:207]
    s_waitcnt lgkmcnt(4)
    ds_read_b64_tr_b16 v[210:211], v224 offset:26624
    v_cvt_pk_bf16_f32 v170, v200, v201
    v_mfma_f32_16x16x32_bf16 v[24:27], v[216:219], v[180:183], v[24:27]
    v_exp_f32 v202, v202
    v_mfma_f32_16x16x32_bf16 v[56:59], v[216:219], v[184:187], v[56:59]
    ds_read_b128 a[228:231], v229 offset:28672
    v_mul_f32 v152, v152, v252
    v_mfma_f32_16x16x32_bf16 v[88:91], v[216:219], v[188:191], v[88:91]
    v_exp_f32 v203, v203
    v_mfma_f32_16x16x32_bf16 v[120:123], v[216:219], v[192:195], v[120:123]
    ds_read_b64_tr_b16 v[212:213], v224 offset:24584
    v_cvt_pk_bf16_f32 v171, v202, v203
    v_mfma_f32_16x16x32_bf16 v[200:203], a[136:139], a[0:3], 0
    v_exp_f32 v204, v204
    v_mfma_f32_16x16x32_bf16 v[200:203], a[212:215], a[4:7], v[200:203]
    ds_read_b64_tr_b16 v[214:215], v224 offset:26632
    v_mul_f32 v153, v153, v252
    v_mfma_f32_16x16x32_bf16 v[200:203], a[216:219], a[8:11], v[200:203]
    v_exp_f32 v205, v205
    v_mfma_f32_16x16x32_bf16 v[200:203], a[220:223], a[12:15], v[200:203]
    s_waitcnt lgkmcnt(6)
    ds_read_b128 a[232:235], v235 offset:28672
    v_cvt_pk_bf16_f32 v174, v204, v205
    v_mfma_f32_16x16x32_bf16 v[28:31], v[220:223], v[180:183], v[28:31]
    ds_write_b64 v228, a[156:157] offset:12288
    v_mfma_f32_16x16x32_bf16 v[60:63], v[220:223], v[184:187], v[60:63]
    ds_read_b128 a[236:239], v231 offset:28672
    v_mul_f32 v154, v154, v252
    v_mfma_f32_16x16x32_bf16 v[92:95], v[220:223], v[188:191], v[92:95]
    v_exp_f32 v206, v206
    v_mfma_f32_16x16x32_bf16 v[124:127], v[220:223], v[192:195], v[124:127]
    ds_read_b64_tr_b16 v[216:217], v225 offset:24576
    v_mul_f32 v155, v155, v252
    v_exp_f32 v207, v207
    v_cvt_pk_bf16_f32 v152, v152, v153
    v_cvt_pk_bf16_f32 v175, v206, v207
    v_mfma_f32_16x16x32_bf16 v[204:207], a[136:139], a[16:19], 0
    v_exp_f32 v200, v200
    v_mfma_f32_16x16x32_bf16 v[204:207], a[212:215], a[20:23], v[204:207]
    ds_read_b64_tr_b16 v[218:219], v225 offset:26624
    v_cvt_pk_bf16_f32 v153, v154, v155
    v_mfma_f32_16x16x32_bf16 v[204:207], a[216:219], a[24:27], v[204:207]
    v_exp_f32 v201, v201
    v_mfma_f32_16x16x32_bf16 v[204:207], a[220:223], a[28:31], v[204:207]
    s_waitcnt lgkmcnt(8)
    v_exp_f32 v202, v202
    v_mfma_f32_16x16x32_bf16 v[0:3], v[208:211], v[160:163], v[0:3]
    v_exp_f32 v203, v203
    v_mfma_f32_16x16x32_bf16 v[32:35], v[208:211], v[164:167], v[32:35]
    v_cvt_pk_bf16_f32 v180, v200, v201
    v_cvt_pk_bf16_f32 v181, v202, v203
    v_mul_f32 v156, v156, v252
    v_mul_f32 v157, v157, v252
    v_mul_f32 v158, v158, v252
    v_mul_f32 v159, v159, v252
    v_cvt_pk_bf16_f32 v154, v156, v157
    v_cvt_pk_bf16_f32 v155, v158, v159
    buffer_store_dwordx4 v[152:155], v230, s[20:23], s34 offen offset:192
    v_mfma_f32_16x16x32_bf16 v[64:67], v[208:211], v[168:171], v[64:67]
    ds_write_b64 v228, a[158:159] offset:12296
    v_mfma_f32_16x16x32_bf16 v[96:99], v[208:211], v[172:175], v[96:99]
    ds_read_b64_tr_b16 v[220:221], v225 offset:24584
    v_smfmac_f32_16x16x64_bf16 a[240:243], a[252:255], v[160:167], v233
    ds_read_b64_tr_b16 v[222:223], v225 offset:26632
    v_mfma_f32_16x16x32_bf16 v[200:203], a[136:139], a[32:35], 0
    v_exp_f32 v204, v204
    v_mfma_f32_16x16x32_bf16 v[200:203], a[212:215], a[36:39], v[200:203]
    v_exp_f32 v205, v205
    v_mfma_f32_16x16x32_bf16 v[200:203], a[216:219], a[40:43], v[200:203]
    v_exp_f32 v206, v206
    v_mfma_f32_16x16x32_bf16 v[200:203], a[220:223], a[44:47], v[200:203]
    s_waitcnt lgkmcnt(8)
    v_exp_f32 v207, v207
    v_mfma_f32_16x16x32_bf16 v[4:7], v[212:215], v[160:163], v[4:7]
L_pad7:
    s_cbranch_vccnz L_pad11
    v_cvt_pk_bf16_f32 v184, v204, v205
    v_cvt_pk_bf16_f32 v185, v206, v207
    v_mfma_f32_16x16x32_bf16 v[36:39], v[212:215], v[164:167], v[36:39]
    v_mfma_f32_16x16x32_bf16 v[68:71], v[212:215], v[168:171], v[68:71]
    v_mfma_f32_16x16x32_bf16 v[100:103], v[212:215], v[172:175], v[100:103]
    ds_read_b64_tr_b16 v[208:209], v224 offset:57344
    v_mfma_f32_16x16x32_bf16 v[204:207], a[136:139], a[48:51], 0
    v_exp_f32 v200, v200
    v_mfma_f32_16x16x32_bf16 v[204:207], a[212:215], a[52:55], v[204:207]
    ds_read_b64_tr_b16 v[210:211], v224 offset:59392
    v_mfma_f32_16x16x32_bf16 v[204:207], a[216:219], a[56:59], v[204:207]
    v_exp_f32 v201, v201
    v_mfma_f32_16x16x32_bf16 v[204:207], a[220:223], a[60:63], v[204:207]
    s_waitcnt lgkmcnt(4)
    s_barrier
    ds_read_b128 a[212:215], v229 offset:0
    v_cvt_pk_bf16_f32 v188, v200, v201
    v_mfma_f32_16x16x32_bf16 v[8:11], v[216:219], v[160:163], v[8:11]
    v_exp_f32 v202, v202
    v_mfma_f32_16x16x32_bf16 v[40:43], v[216:219], v[164:167], v[40:43]
    ds_write_b64 v228, a[160:161] offset:16384
    v_mfma_f32_16x16x32_bf16 v[72:75], v[216:219], v[168:171], v[72:75]
    v_exp_f32 v203, v203
    v_mfma_f32_16x16x32_bf16 v[104:107], v[216:219], v[172:175], v[104:107]
    ds_read_b64_tr_b16 v[212:213], v224 offset:57352
    v_cvt_pk_bf16_f32 v189, v202, v203
    v_mfma_f32_16x16x32_bf16 v[200:203], a[140:143], a[0:3], 0
    v_exp_f32 v204, v204
    v_mfma_f32_16x16x32_bf16 v[200:203], a[228:231], a[4:7], v[200:203]
    ds_write_b64 v228, a[162:163] offset:16392
    v_mfma_f32_16x16x32_bf16 v[200:203], a[232:235], a[8:11], v[200:203]
    v_exp_f32 v205, v205
    v_mfma_f32_16x16x32_bf16 v[200:203], a[236:239], a[12:15], v[200:203]
    s_waitcnt lgkmcnt(6)
    ds_read_b64_tr_b16 v[214:215], v224 offset:59400
    v_cvt_pk_bf16_f32 v192, v204, v205
    v_mfma_f32_16x16x32_bf16 v[12:15], v[220:223], v[160:163], v[12:15]
    v_exp_f32 v206, v206
    v_mfma_f32_16x16x32_bf16 v[44:47], v[220:223], v[164:167], v[44:47]
    ds_write_b64 v228, a[164:165] offset:20480
    v_mfma_f32_16x16x32_bf16 v[76:79], v[220:223], v[168:171], v[76:79]
    v_exp_f32 v207, v207
    v_mfma_f32_16x16x32_bf16 v[108:111], v[220:223], v[172:175], v[108:111]
    ds_read_b64_tr_b16 v[216:217], v225 offset:57344
    v_cvt_pk_bf16_f32 v193, v206, v207
    v_mfma_f32_16x16x32_bf16 v[204:207], a[140:143], a[16:19], 0
    v_exp_f32 v200, v200
    v_mfma_f32_16x16x32_bf16 v[204:207], a[228:231], a[20:23], v[204:207]
    ds_write_b64 v228, a[166:167] offset:20488
    v_mfma_f32_16x16x32_bf16 v[204:207], a[232:235], a[24:27], v[204:207]
    v_exp_f32 v201, v201
    v_mfma_f32_16x16x32_bf16 v[204:207], a[236:239], a[28:31], v[204:207]
    s_waitcnt lgkmcnt(8)
    ds_read_b64_tr_b16 v[218:219], v225 offset:59392
    v_cvt_pk_bf16_f32 v182, v200, v201
    v_mfma_f32_16x16x32_bf16 v[16:19], v[208:211], v[160:163], v[16:19]
    v_exp_f32 v202, v202
    v_mfma_f32_16x16x32_bf16 v[48:51], v[208:211], v[164:167], v[48:51]
    ds_write_b64 v228, a[168:169] offset:24576
    v_mfma_f32_16x16x32_bf16 v[80:83], v[208:211], v[168:171], v[80:83]
    v_exp_f32 v203, v203
    v_mfma_f32_16x16x32_bf16 v[112:115], v[208:211], v[172:175], v[112:115]
    ds_read_b128 a[216:219], v235 offset:0
    v_cvt_pk_bf16_f32 v183, v202, v203
    v_smfmac_f32_16x16x64_bf16 a[244:247], a[252:255], v[168:175], v233
    ds_write_b64 v228, a[170:171] offset:24584
    v_mfma_f32_16x16x32_bf16 v[200:203], a[140:143], a[32:35], 0
    v_exp_f32 v204, v204
    v_mfma_f32_16x16x32_bf16 v[200:203], a[228:231], a[36:39], v[200:203]
    ds_write_b64 v228, a[172:173] offset:28672
    v_mfma_f32_16x16x32_bf16 v[200:203], a[232:235], a[40:43], v[200:203]
    v_exp_f32 v205, v205
    v_mfma_f32_16x16x32_bf16 v[200:203], a[236:239], a[44:47], v[200:203]
    s_waitcnt lgkmcnt(8)
    ds_read_b128 a[220:223], v231 offset:0
    v_cvt_pk_bf16_f32 v186, v204, v205
    v_mfma_f32_16x16x32_bf16 v[20:23], v[212:215], v[160:163], v[20:23]
    v_exp_f32 v206, v206
    v_mfma_f32_16x16x32_bf16 v[52:55], v[212:215], v[164:167], v[52:55]
    ds_write_b64 v228, a[174:175] offset:28680
    v_mfma_f32_16x16x32_bf16 v[84:87], v[212:215], v[168:171], v[84:87]
    v_exp_f32 v207, v207
    v_mfma_f32_16x16x32_bf16 v[116:119], v[212:215], v[172:175], v[116:119]
    ds_read_b64_tr_b16 v[220:221], v225 offset:57352
    v_cvt_pk_bf16_f32 v187, v206, v207
    v_mfma_f32_16x16x32_bf16 v[204:207], a[140:143], a[48:51], 0
    v_exp_f32 v200, v200
    v_mfma_f32_16x16x32_bf16 v[204:207], a[228:231], a[52:55], v[204:207]
    ds_read_b64_tr_b16 v[222:223], v225 offset:59400
    v_mfma_f32_16x16x32_bf16 v[204:207], a[232:235], a[56:59], v[204:207]
    v_exp_f32 v201, v201
    v_mfma_f32_16x16x32_bf16 v[204:207], a[236:239], a[60:63], v[204:207]
    s_waitcnt lgkmcnt(8)
    ds_read_b64_tr_b16 v[208:209], v224 offset:28672
    v_cvt_pk_bf16_f32 v190, v200, v201
    v_mfma_f32_16x16x32_bf16 v[24:27], v[216:219], v[160:163], v[24:27]
    v_exp_f32 v202, v202
    v_mfma_f32_16x16x32_bf16 v[56:59], v[216:219], v[164:167], v[56:59]
    ds_read_b64_tr_b16 v[210:211], v224 offset:30720
    v_mfma_f32_16x16x32_bf16 v[88:91], v[216:219], v[168:171], v[88:91]
    v_exp_f32 v203, v203
    v_mfma_f32_16x16x32_bf16 v[120:123], v[216:219], v[172:175], v[120:123]
    ds_read_b64_tr_b16 v[212:213], v224 offset:28680
    v_cvt_pk_bf16_f32 v191, v202, v203
    v_mfma_f32_16x16x32_bf16 v[200:203], a[144:147], a[0:3], 0
    v_exp_f32 v204, v204
    v_mfma_f32_16x16x32_bf16 v[200:203], a[212:215], a[4:7], v[200:203]
    s_waitcnt lgkmcnt(9)
    ds_read_b64_tr_b16 v[214:215], v224 offset:30728
    v_mfma_f32_16x16x32_bf16 v[200:203], a[216:219], a[8:11], v[200:203]
    s_waitcnt lgkmcnt(7)
    v_exp_f32 v205, v205
    v_mfma_f32_16x16x32_bf16 v[200:203], a[220:223], a[12:15], v[200:203]
    s_waitcnt lgkmcnt(4)
    ds_read_b128 a[228:231], v229 offset:4096
    v_cvt_pk_bf16_f32 v194, v204, v205
    v_mfma_f32_16x16x32_bf16 v[28:31], v[220:223], v[160:163], v[28:31]
    v_exp_f32 v206, v206
    v_mfma_f32_16x16x32_bf16 v[60:63], v[220:223], v[164:167], v[60:63]
    ds_read_b128 a[232:235], v235 offset:4096
    v_mfma_f32_16x16x32_bf16 v[92:95], v[220:223], v[168:171], v[92:95]
    v_exp_f32 v207, v207
    v_mfma_f32_16x16x32_bf16 v[124:127], v[220:223], v[172:175], v[124:127]
    ds_read_b64_tr_b16 v[216:217], v225 offset:28672
    v_cvt_pk_bf16_f32 v195, v206, v207
    v_mfma_f32_16x16x32_bf16 v[204:207], a[144:147], a[16:19], 0
    v_exp_f32 v200, v200
    v_mfma_f32_16x16x32_bf16 v[204:207], a[212:215], a[20:23], v[204:207]
    ds_read_b64_tr_b16 v[218:219], v225 offset:30720
    v_mfma_f32_16x16x32_bf16 v[204:207], a[216:219], a[24:27], v[204:207]
    v_exp_f32 v201, v201
    v_mfma_f32_16x16x32_bf16 v[204:207], a[220:223], a[28:31], v[204:207]
    s_waitcnt lgkmcnt(6)
    ds_read_b128 a[236:239], v231 offset:4096
    v_cvt_pk_bf16_f32 v160, v200, v201
    v_mfma_f32_16x16x32_bf16 v[0:3], v[208:211], v[180:183], v[0:3]
    v_exp_f32 v202, v202
    v_mfma_f32_16x16x32_bf16 v[32:35], v[208:211], v[184:187], v[32:35]
    v_exp_f32 v203, v203
    v_mfma_f32_16x16x32_bf16 v[64:67], v[208:211], v[188:191], v[64:67]
    v_cvt_pk_bf16_f32 v161, v202, v203
    v_mfma_f32_16x16x32_bf16 v[96:99], v[208:211], v[192:195], v[96:99]
    ds_read_b64_tr_b16 v[220:221], v225 offset:28680
    v_smfmac_f32_16x16x64_bf16 a[240:243], a[252:255], v[180:187], v233
    ds_read_b64_tr_b16 v[222:223], v225 offset:30728
    v_mfma_f32_16x16x32_bf16 v[200:203], a[144:147], a[32:35], 0
    v_exp_f32 v204, v204
    v_mfma_f32_16x16x32_bf16 v[200:203], a[212:215], a[36:39], v[200:203]
    v_exp_f32 v205, v205
    v_mfma_f32_16x16x32_bf16 v[200:203], a[216:219], a[40:43], v[200:203]
    v_exp_f32 v206, v206
    v_mfma_f32_16x16x32_bf16 v[200:203], a[220:223], a[44:47], v[200:203]
    s_waitcnt lgkmcnt(7)
    v_exp_f32 v207, v207
    v_mfma_f32_16x16x32_bf16 v[4:7], v[212:215], v[180:183], v[4:7]
    v_cvt_pk_bf16_f32 v164, v204, v205
    v_cvt_pk_bf16_f32 v165, v206, v207
    v_mfma_f32_16x16x32_bf16 v[36:39], v[212:215], v[184:187], v[36:39]
    v_mfma_f32_16x16x32_bf16 v[68:71], v[212:215], v[188:191], v[68:71]
    v_mfma_f32_16x16x32_bf16 v[100:103], v[212:215], v[192:195], v[100:103]
    ds_read_b64_tr_b16 v[208:209], v224 offset:61440
    v_mfma_f32_16x16x32_bf16 v[204:207], a[144:147], a[48:51], 0
    v_exp_f32 v200, v200
    v_mfma_f32_16x16x32_bf16 v[204:207], a[212:215], a[52:55], v[204:207]
    ds_read_b64_tr_b16 v[210:211], v224 offset:63488
    v_mfma_f32_16x16x32_bf16 v[204:207], a[216:219], a[56:59], v[204:207]
    v_exp_f32 v201, v201
    v_mfma_f32_16x16x32_bf16 v[204:207], a[220:223], a[60:63], v[204:207]
    s_waitcnt lgkmcnt(5)
    ds_read_b128 a[212:215], v229 offset:8192
    v_cvt_pk_bf16_f32 v168, v200, v201
    v_mfma_f32_16x16x32_bf16 v[8:11], v[216:219], v[180:183], v[8:11]
    v_exp_f32 v202, v202
    v_mfma_f32_16x16x32_bf16 v[40:43], v[216:219], v[184:187], v[40:43]
    ds_read_b128 a[216:219], v235 offset:8192
    v_mfma_f32_16x16x32_bf16 v[72:75], v[216:219], v[188:191], v[72:75]
    v_exp_f32 v203, v203
    v_mfma_f32_16x16x32_bf16 v[104:107], v[216:219], v[192:195], v[104:107]
    ds_read_b64_tr_b16 v[212:213], v224 offset:61448
    v_cvt_pk_bf16_f32 v169, v202, v203
    v_mfma_f32_16x16x32_bf16 v[200:203], a[148:151], a[0:3], 0
    v_exp_f32 v204, v204
    v_mfma_f32_16x16x32_bf16 v[200:203], a[228:231], a[4:7], v[200:203]
    ds_read_b64_tr_b16 v[214:215], v224 offset:63496
    v_xor_b32 v224, 0x10000, v224
    v_mfma_f32_16x16x32_bf16 v[200:203], a[232:235], a[8:11], v[200:203]
    s_waitcnt lgkmcnt(8)
    v_exp_f32 v205, v205
    v_mfma_f32_16x16x32_bf16 v[200:203], a[236:239], a[12:15], v[200:203]
    s_waitcnt lgkmcnt(6)
    ds_read_b128 a[220:223], v231 offset:8192
    v_cvt_pk_bf16_f32 v172, v204, v205
    v_mfma_f32_16x16x32_bf16 v[12:15], v[220:223], v[180:183], v[12:15]
    v_exp_f32 v206, v206
    v_mfma_f32_16x16x32_bf16 v[44:47], v[220:223], v[184:187], v[44:47]
    v_exp_f32 v207, v207
    v_mfma_f32_16x16x32_bf16 v[76:79], v[220:223], v[188:191], v[76:79]
    v_cvt_pk_bf16_f32 v173, v206, v207
    v_mfma_f32_16x16x32_bf16 v[108:111], v[220:223], v[192:195], v[108:111]
    ds_read_b64_tr_b16 v[216:217], v225 offset:61440
    v_mfma_f32_16x16x32_bf16 v[204:207], a[148:151], a[16:19], 0
    v_exp_f32 v200, v200
    v_mfma_f32_16x16x32_bf16 v[204:207], a[228:231], a[20:23], v[204:207]
    ds_read_b64_tr_b16 v[218:219], v225 offset:63488
    v_mfma_f32_16x16x32_bf16 v[204:207], a[232:235], a[24:27], v[204:207]
    v_exp_f32 v201, v201
    v_mfma_f32_16x16x32_bf16 v[204:207], a[236:239], a[28:31], v[204:207]
    s_waitcnt lgkmcnt(7)
    v_exp_f32 v202, v202
    v_mfma_f32_16x16x32_bf16 v[16:19], v[208:211], v[180:183], v[16:19]
    v_exp_f32 v203, v203
    v_mfma_f32_16x16x32_bf16 v[48:51], v[208:211], v[184:187], v[48:51]
    v_cvt_pk_bf16_f32 v162, v200, v201
    v_cvt_pk_bf16_f32 v163, v202, v203
    v_mfma_f32_16x16x32_bf16 v[80:83], v[208:211], v[188:191], v[80:83]
    v_mfma_f32_16x16x32_bf16 v[112:115], v[208:211], v[192:195], v[112:115]
    ds_read_b64_tr_b16 v[220:221], v225 offset:61448
    v_smfmac_f32_16x16x64_bf16 a[244:247], a[252:255], v[188:195], v233
    ds_read_b64_tr_b16 v[222:223], v225 offset:63496
    v_xor_b32 v225, 0x10000, v225
    v_mfma_f32_16x16x32_bf16 v[200:203], a[148:151], a[32:35], 0
    v_exp_f32 v204, v204
    v_mfma_f32_16x16x32_bf16 v[200:203], a[228:231], a[36:39], v[200:203]
    v_exp_f32 v205, v205
    v_mfma_f32_16x16x32_bf16 v[200:203], a[232:235], a[40:43], v[200:203]
    v_exp_f32 v206, v206
    v_mfma_f32_16x16x32_bf16 v[200:203], a[236:239], a[44:47], v[200:203]
    s_waitcnt lgkmcnt(5)
    v_exp_f32 v207, v207
    v_mfma_f32_16x16x32_bf16 v[20:23], v[212:215], v[180:183], v[20:23]
    v_cvt_pk_bf16_f32 v166, v204, v205
    v_cvt_pk_bf16_f32 v167, v206, v207
    v_mfma_f32_16x16x32_bf16 v[52:55], v[212:215], v[184:187], v[52:55]
    v_mfma_f32_16x16x32_bf16 v[84:87], v[212:215], v[188:191], v[84:87]
    v_mfma_f32_16x16x32_bf16 v[116:119], v[212:215], v[192:195], v[116:119]
    ds_read_b64_tr_b16 v[208:209], v224 offset:0
    v_mfma_f32_16x16x32_bf16 v[204:207], a[148:151], a[48:51], 0
    v_exp_f32 v200, v200
    v_mfma_f32_16x16x32_bf16 v[204:207], a[228:231], a[52:55], v[204:207]
    ds_read_b64_tr_b16 v[210:211], v224 offset:2048
    v_mfma_f32_16x16x32_bf16 v[204:207], a[232:235], a[56:59], v[204:207]
    v_exp_f32 v201, v201
    v_mfma_f32_16x16x32_bf16 v[204:207], a[236:239], a[60:63], v[204:207]
    s_waitcnt lgkmcnt(4)
    ds_read_b128 a[228:231], v229 offset:12288
    v_cvt_pk_bf16_f32 v170, v200, v201
    v_mfma_f32_16x16x32_bf16 v[24:27], v[216:219], v[180:183], v[24:27]
    v_exp_f32 v202, v202
    v_mfma_f32_16x16x32_bf16 v[56:59], v[216:219], v[184:187], v[56:59]
    ds_read_b128 a[232:235], v235 offset:12288
    v_mfma_f32_16x16x32_bf16 v[88:91], v[216:219], v[188:191], v[88:91]
    v_exp_f32 v203, v203
    v_mfma_f32_16x16x32_bf16 v[120:123], v[216:219], v[192:195], v[120:123]
    ds_read_b64_tr_b16 v[212:213], v224 offset:8
    v_cvt_pk_bf16_f32 v171, v202, v203
    v_mfma_f32_16x16x32_bf16 v[200:203], a[152:155], a[0:3], 0
    v_exp_f32 v204, v204
    v_mfma_f32_16x16x32_bf16 v[200:203], a[212:215], a[4:7], v[200:203]
    ds_read_b64_tr_b16 v[214:215], v224 offset:2056
    v_mfma_f32_16x16x32_bf16 v[200:203], a[216:219], a[8:11], v[200:203]
    v_exp_f32 v205, v205
    v_mfma_f32_16x16x32_bf16 v[200:203], a[220:223], a[12:15], v[200:203]
    s_waitcnt lgkmcnt(6)
    ds_read_b128 a[236:239], v231 offset:12288
    v_cvt_pk_bf16_f32 v174, v204, v205
    v_mfma_f32_16x16x32_bf16 v[28:31], v[220:223], v[180:183], v[28:31]
    v_exp_f32 v206, v206
    v_mfma_f32_16x16x32_bf16 v[60:63], v[220:223], v[184:187], v[60:63]
    v_exp_f32 v207, v207
    v_mfma_f32_16x16x32_bf16 v[92:95], v[220:223], v[188:191], v[92:95]
    v_cvt_pk_bf16_f32 v175, v206, v207
    v_mfma_f32_16x16x32_bf16 v[124:127], v[220:223], v[192:195], v[124:127]
    ds_read_b64_tr_b16 v[216:217], v225 offset:0
    v_mfma_f32_16x16x32_bf16 v[204:207], a[152:155], a[16:19], 0
    v_exp_f32 v200, v200
    v_mfma_f32_16x16x32_bf16 v[204:207], a[212:215], a[20:23], v[204:207]
    ds_read_b64_tr_b16 v[218:219], v225 offset:2048
    v_mfma_f32_16x16x32_bf16 v[204:207], a[216:219], a[24:27], v[204:207]
    v_exp_f32 v201, v201
    v_mfma_f32_16x16x32_bf16 v[204:207], a[220:223], a[28:31], v[204:207]
    s_waitcnt lgkmcnt(7)
    v_exp_f32 v202, v202
    v_mfma_f32_16x16x32_bf16 v[0:3], v[208:211], v[160:163], v[0:3]
    v_exp_f32 v203, v203
    v_mfma_f32_16x16x32_bf16 v[32:35], v[208:211], v[164:167], v[32:35]
    v_cvt_pk_bf16_f32 v180, v200, v201
    v_cvt_pk_bf16_f32 v181, v202, v203
    v_mfma_f32_16x16x32_bf16 v[64:67], v[208:211], v[168:171], v[64:67]
    v_mfma_f32_16x16x32_bf16 v[96:99], v[208:211], v[172:175], v[96:99]
    ds_read_b64_tr_b16 v[220:221], v225 offset:8
    v_smfmac_f32_16x16x64_bf16 a[240:243], a[252:255], v[160:167], v233
    ds_read_b64_tr_b16 v[222:223], v225 offset:2056
    v_mfma_f32_16x16x32_bf16 v[200:203], a[152:155], a[32:35], 0
    v_exp_f32 v204, v204
    v_mfma_f32_16x16x32_bf16 v[200:203], a[212:215], a[36:39], v[200:203]
    v_exp_f32 v205, v205
    v_mfma_f32_16x16x32_bf16 v[200:203], a[216:219], a[40:43], v[200:203]
    v_exp_f32 v206, v206
    v_mfma_f32_16x16x32_bf16 v[200:203], a[220:223], a[44:47], v[200:203]
    s_waitcnt lgkmcnt(5)
    v_exp_f32 v207, v207
    v_mfma_f32_16x16x32_bf16 v[4:7], v[212:215], v[160:163], v[4:7]
    v_cvt_pk_bf16_f32 v184, v204, v205
    v_cvt_pk_bf16_f32 v185, v206, v207
    v_mfma_f32_16x16x32_bf16 v[36:39], v[212:215], v[164:167], v[36:39]
    v_mfma_f32_16x16x32_bf16 v[68:71], v[212:215], v[168:171], v[68:71]
    v_mfma_f32_16x16x32_bf16 v[100:103], v[212:215], v[172:175], v[100:103]
    ds_read_b64_tr_b16 v[208:209], v224 offset:32768
    v_mfma_f32_16x16x32_bf16 v[204:207], a[152:155], a[48:51], 0
    v_exp_f32 v200, v200
    v_mfma_f32_16x16x32_bf16 v[204:207], a[212:215], a[52:55], v[204:207]
    ds_read_b64_tr_b16 v[210:211], v224 offset:34816
    v_mfma_f32_16x16x32_bf16 v[204:207], a[216:219], a[56:59], v[204:207]
    v_exp_f32 v201, v201
    v_mfma_f32_16x16x32_bf16 v[204:207], a[220:223], a[60:63], v[204:207]
    s_waitcnt lgkmcnt(4)
    s_barrier
    ds_read_b128 a[212:215], v229 offset:16384
    v_cvt_pk_bf16_f32 v188, v200, v201
    v_mfma_f32_16x16x32_bf16 v[8:11], v[216:219], v[160:163], v[8:11]
    v_exp_f32 v202, v202
    v_mfma_f32_16x16x32_bf16 v[40:43], v[216:219], v[164:167], v[40:43]
    ds_write_b64 v228, a[176:177] offset:0
    v_mfma_f32_16x16x32_bf16 v[72:75], v[216:219], v[168:171], v[72:75]
    v_exp_f32 v203, v203
    v_mfma_f32_16x16x32_bf16 v[104:107], v[216:219], v[172:175], v[104:107]
    ds_read_b64_tr_b16 v[212:213], v224 offset:32776
    v_cvt_pk_bf16_f32 v189, v202, v203
    v_mfma_f32_16x16x32_bf16 v[200:203], a[156:159], a[0:3], 0
    v_exp_f32 v204, v204
    v_mfma_f32_16x16x32_bf16 v[200:203], a[228:231], a[4:7], v[200:203]
    ds_write_b64 v228, a[178:179] offset:8
    v_mfma_f32_16x16x32_bf16 v[200:203], a[232:235], a[8:11], v[200:203]
    v_exp_f32 v205, v205
    v_mfma_f32_16x16x32_bf16 v[200:203], a[236:239], a[12:15], v[200:203]
    s_waitcnt lgkmcnt(6)
    ds_read_b64_tr_b16 v[214:215], v224 offset:34824
    v_cvt_pk_bf16_f32 v192, v204, v205
    v_mfma_f32_16x16x32_bf16 v[12:15], v[220:223], v[160:163], v[12:15]
    v_exp_f32 v206, v206
    v_mfma_f32_16x16x32_bf16 v[44:47], v[220:223], v[164:167], v[44:47]
    ds_write_b64 v228, a[180:181] offset:4096
    v_mfma_f32_16x16x32_bf16 v[76:79], v[220:223], v[168:171], v[76:79]
    v_exp_f32 v207, v207
    v_mfma_f32_16x16x32_bf16 v[108:111], v[220:223], v[172:175], v[108:111]
    ds_read_b64_tr_b16 v[216:217], v225 offset:32768
    v_cvt_pk_bf16_f32 v193, v206, v207
    v_mfma_f32_16x16x32_bf16 v[204:207], a[156:159], a[16:19], 0
    v_exp_f32 v200, v200
    v_mfma_f32_16x16x32_bf16 v[204:207], a[228:231], a[20:23], v[204:207]
    ds_write_b64 v228, a[182:183] offset:4104
    v_mfma_f32_16x16x32_bf16 v[204:207], a[232:235], a[24:27], v[204:207]
    v_exp_f32 v201, v201
    v_mfma_f32_16x16x32_bf16 v[204:207], a[236:239], a[28:31], v[204:207]
    s_waitcnt lgkmcnt(8)
    ds_read_b64_tr_b16 v[218:219], v225 offset:34816
    v_cvt_pk_bf16_f32 v182, v200, v201
    v_mfma_f32_16x16x32_bf16 v[16:19], v[208:211], v[160:163], v[16:19]
    v_exp_f32 v202, v202
    v_mfma_f32_16x16x32_bf16 v[48:51], v[208:211], v[164:167], v[48:51]
    ds_write_b64 v228, a[184:185] offset:8192
    v_mfma_f32_16x16x32_bf16 v[80:83], v[208:211], v[168:171], v[80:83]
    v_exp_f32 v203, v203
    v_mfma_f32_16x16x32_bf16 v[112:115], v[208:211], v[172:175], v[112:115]
    ds_read_b64_tr_b16 v[220:221], v225 offset:32776
    v_cvt_pk_bf16_f32 v183, v202, v203
    v_smfmac_f32_16x16x64_bf16 a[244:247], a[252:255], v[168:175], v233
    ds_write_b64 v228, a[186:187] offset:8200
    v_mfma_f32_16x16x32_bf16 v[200:203], a[156:159], a[32:35], 0
    v_exp_f32 v204, v204
    v_mfma_f32_16x16x32_bf16 v[200:203], a[228:231], a[36:39], v[200:203]
    ds_write_b64 v228, a[188:189] offset:12288
    v_mfma_f32_16x16x32_bf16 v[200:203], a[232:235], a[40:43], v[200:203]
    v_exp_f32 v205, v205
    v_mfma_f32_16x16x32_bf16 v[200:203], a[236:239], a[44:47], v[200:203]
    s_waitcnt lgkmcnt(8)
    ds_read_b64_tr_b16 v[222:223], v225 offset:34824
    v_cvt_pk_bf16_f32 v186, v204, v205
    v_mfma_f32_16x16x32_bf16 v[20:23], v[212:215], v[160:163], v[20:23]
    v_exp_f32 v206, v206
    v_mfma_f32_16x16x32_bf16 v[52:55], v[212:215], v[164:167], v[52:55]
    ds_write_b64 v228, a[190:191] offset:12296
    v_mfma_f32_16x16x32_bf16 v[84:87], v[212:215], v[168:171], v[84:87]
    v_exp_f32 v207, v207
    v_mfma_f32_16x16x32_bf16 v[116:119], v[212:215], v[172:175], v[116:119]
    ds_read_b64_tr_b16 v[208:209], v224 offset:4096
    v_cvt_pk_bf16_f32 v187, v206, v207
    v_mfma_f32_16x16x32_bf16 v[204:207], a[156:159], a[48:51], 0
    ds_read_b64_tr_b16 v[210:211], v224 offset:6144
    v_exp_f32 v200, v200
    v_mfma_f32_16x16x32_bf16 v[204:207], a[228:231], a[52:55], v[204:207]
    ds_read_b128 a[216:219], v235 offset:16384
    v_mfma_f32_16x16x32_bf16 v[204:207], a[232:235], a[56:59], v[204:207]
    ds_read_b128 a[220:223], v231 offset:16384
    v_exp_f32 v201, v201
    v_mfma_f32_16x16x32_bf16 v[204:207], a[236:239], a[60:63], v[204:207]
    s_waitcnt lgkmcnt(10)
    v_exp_f32 v202, v202
    v_mfma_f32_16x16x32_bf16 v[24:27], v[216:219], v[160:163], v[24:27]
    v_exp_f32 v203, v203
    v_mfma_f32_16x16x32_bf16 v[56:59], v[216:219], v[164:167], v[56:59]
    v_cvt_pk_bf16_f32 v190, v200, v201
    v_cvt_pk_bf16_f32 v191, v202, v203
    v_mfma_f32_16x16x32_bf16 v[88:91], v[216:219], v[168:171], v[88:91]
    v_mfma_f32_16x16x32_bf16 v[120:123], v[216:219], v[172:175], v[120:123]
    ds_read_b64_tr_b16 v[212:213], v224 offset:4104
    v_mfma_f32_16x16x32_bf16 v[200:203], a[160:163], a[0:3], 0
L_loop:
    v_exp_f32 v204, v204
    v_mfma_f32_16x16x32_bf16 v[200:203], a[212:215], a[4:7], v[200:203]
    s_waitcnt lgkmcnt(2)
    s_add_u32 s30, s30, 65536
    ds_read_b64_tr_b16 v[214:215], v224 offset:6152
    v_mfma_f32_16x16x32_bf16 v[200:203], a[216:219], a[8:11], v[200:203]
    s_waitcnt lgkmcnt(2)
    s_add_u32 s35, s30, 65536
    v_exp_f32 v205, v205
    v_mfma_f32_16x16x32_bf16 v[200:203], a[220:223], a[12:15], v[200:203]
    s_add_u32 s31, s31, 65536
    ds_read_b128 a[228:231], v229 offset:20480
    v_cvt_pk_bf16_f32 v194, v204, v205
    v_mfma_f32_16x16x32_bf16 v[28:31], v[220:223], v[160:163], v[28:31]
    s_add_u32 s36, s31, 65536
    v_exp_f32 v206, v206
    v_mfma_f32_16x16x32_bf16 v[60:63], v[220:223], v[164:167], v[60:63]
    s_add_u32 s32, s32, 65536
    ds_read_b128 a[232:235], v235 offset:20480
    v_mfma_f32_16x16x32_bf16 v[92:95], v[220:223], v[168:171], v[92:95]
    s_add_u32 s37, s32, 65536
    v_exp_f32 v207, v207
    v_mfma_f32_16x16x32_bf16 v[124:127], v[220:223], v[172:175], v[124:127]
    s_add_u32 s33, s33, 65536
    ds_read_b64_tr_b16 v[216:217], v225 offset:4096
    v_cvt_pk_bf16_f32 v195, v206, v207
    v_mfma_f32_16x16x32_bf16 v[204:207], a[160:163], a[16:19], 0
    s_add_u32 s38, s33, 65536
    v_exp_f32 v200, v200
    v_mfma_f32_16x16x32_bf16 v[204:207], a[212:215], a[20:23], v[204:207]
    s_add_u32 s43, s35, s28
    buffer_load_dwordx4 v[128:131], v230, s[8:11], s43 offen nt
    v_mfma_f32_16x16x32_bf16 v[204:207], a[216:219], a[24:27], v[204:207]
    s_add_u32 s44, s35, s46
    v_exp_f32 v201, v201
    v_mfma_f32_16x16x32_bf16 v[204:207], a[220:223], a[28:31], v[204:207]
    s_add_u32 s43, s35, s47
    ds_read_b64_tr_b16 v[218:219], v225 offset:6144
    v_cvt_pk_bf16_f32 v160, v200, v201
    v_mfma_f32_16x16x32_bf16 v[0:3], v[208:211], v[180:183], v[0:3]
    v_exp_f32 v202, v202
    v_mfma_f32_16x16x32_bf16 v[32:35], v[208:211], v[184:187], v[32:35]
    ds_read_b128 a[236:239], v231 offset:20480
    v_mfma_f32_16x16x32_bf16 v[64:67], v[208:211], v[188:191], v[64:67]
    v_exp_f32 v203, v203
    v_mfma_f32_16x16x32_bf16 v[96:99], v[208:211], v[192:195], v[96:99]
    ds_read_b64_tr_b16 v[220:221], v225 offset:4104
    v_cvt_pk_bf16_f32 v161, v202, v203
    v_smfmac_f32_16x16x64_bf16 a[240:243], a[252:255], v[180:187], v233
    ds_read_b64_tr_b16 v[222:223], v225 offset:6152
    v_mfma_f32_16x16x32_bf16 v[200:203], a[160:163], a[32:35], 0
    v_exp_f32 v204, v204
    v_mfma_f32_16x16x32_bf16 v[200:203], a[212:215], a[36:39], v[200:203]
    v_exp_f32 v205, v205
    v_mfma_f32_16x16x32_bf16 v[200:203], a[216:219], a[40:43], v[200:203]
    v_exp_f32 v206, v206
    v_mfma_f32_16x16x32_bf16 v[200:203], a[220:223], a[44:47], v[200:203]
    s_waitcnt lgkmcnt(7)
    v_exp_f32 v207, v207
    v_mfma_f32_16x16x32_bf16 v[4:7], v[212:215], v[180:183], v[4:7]
    v_cvt_pk_bf16_f32 v164, v204, v205
    v_cvt_pk_bf16_f32 v165, v206, v207
    v_mfma_f32_16x16x32_bf16 v[36:39], v[212:215], v[184:187], v[36:39]
    v_mfma_f32_16x16x32_bf16 v[68:71], v[212:215], v[188:191], v[68:71]
    v_mfma_f32_16x16x32_bf16 v[100:103], v[212:215], v[192:195], v[100:103]
    ds_read_b64_tr_b16 v[208:209], v224 offset:36864
    v_mfma_f32_16x16x32_bf16 v[204:207], a[160:163], a[48:51], 0
    v_exp_f32 v200, v200
    v_mfma_f32_16x16x32_bf16 v[204:207], a[212:215], a[52:55], v[204:207]
    buffer_load_dwordx4 v[132:135], v230, s[8:11], s44 offen nt
    v_mfma_f32_16x16x32_bf16 v[204:207], a[216:219], a[56:59], v[204:207]
    s_add_u32 s44, s35, s48
    v_exp_f32 v201, v201
    v_mfma_f32_16x16x32_bf16 v[204:207], a[220:223], a[60:63], v[204:207]
    s_waitcnt lgkmcnt(4)
    ds_read_b64_tr_b16 v[210:211], v224 offset:38912
    v_cvt_pk_bf16_f32 v168, v200, v201
    v_mfma_f32_16x16x32_bf16 v[8:11], v[216:219], v[180:183], v[8:11]
    v_exp_f32 v202, v202
    v_mfma_f32_16x16x32_bf16 v[40:43], v[216:219], v[184:187], v[40:43]
    ds_read_b128 a[212:215], v229 offset:24576
    v_mfma_f32_16x16x32_bf16 v[72:75], v[216:219], v[188:191], v[72:75]
    v_exp_f32 v203, v203
    v_mfma_f32_16x16x32_bf16 v[104:107], v[216:219], v[192:195], v[104:107]
    ds_read_b64_tr_b16 v[212:213], v224 offset:36872
    v_cvt_pk_bf16_f32 v169, v202, v203
    v_mfma_f32_16x16x32_bf16 v[200:203], a[164:167], a[0:3], 0
    v_exp_f32 v204, v204
    v_mfma_f32_16x16x32_bf16 v[200:203], a[228:231], a[4:7], v[200:203]
    ds_read_b64_tr_b16 v[214:215], v224 offset:38920
    v_mfma_f32_16x16x32_bf16 v[200:203], a[232:235], a[8:11], v[200:203]
    s_waitcnt lgkmcnt(7)
    v_exp_f32 v205, v205
    v_mfma_f32_16x16x32_bf16 v[200:203], a[236:239], a[12:15], v[200:203]
    s_waitcnt lgkmcnt(5)
    ds_read_b128 a[216:219], v235 offset:24576
    v_cvt_pk_bf16_f32 v172, v204, v205
    v_mfma_f32_16x16x32_bf16 v[12:15], v[220:223], v[180:183], v[12:15]
    v_exp_f32 v206, v206
    v_mfma_f32_16x16x32_bf16 v[44:47], v[220:223], v[184:187], v[44:47]
    ds_read_b128 a[220:223], v231 offset:24576
    v_mfma_f32_16x16x32_bf16 v[76:79], v[220:223], v[188:191], v[76:79]
    v_exp_f32 v207, v207
    v_mfma_f32_16x16x32_bf16 v[108:111], v[220:223], v[192:195], v[108:111]
    ds_read_b64_tr_b16 v[216:217], v225 offset:36864
    v_cvt_pk_bf16_f32 v173, v206, v207
    v_mfma_f32_16x16x32_bf16 v[204:207], a[164:167], a[16:19], 0
    v_exp_f32 v200, v200
    v_mfma_f32_16x16x32_bf16 v[204:207], a[228:231], a[20:23], v[204:207]
    buffer_load_dwordx4 v[136:139], v230, s[8:11], s43 offen nt
    v_mfma_f32_16x16x32_bf16 v[204:207], a[232:235], a[24:27], v[204:207]
    s_add_u32 s43, s36, s28
    v_exp_f32 v201, v201
    v_mfma_f32_16x16x32_bf16 v[204:207], a[236:239], a[28:31], v[204:207]
    s_waitcnt lgkmcnt(6)
    ds_read_b64_tr_b16 v[218:219], v225 offset:38912
    v_cvt_pk_bf16_f32 v162, v200, v201
    v_mfma_f32_16x16x32_bf16 v[16:19], v[208:211], v[180:183], v[16:19]
    v_exp_f32 v202, v202
    v_mfma_f32_16x16x32_bf16 v[48:51], v[208:211], v[184:187], v[48:51]
    v_exp_f32 v203, v203
    v_mfma_f32_16x16x32_bf16 v[80:83], v[208:211], v[188:191], v[80:83]
    v_cvt_pk_bf16_f32 v163, v202, v203
    v_mfma_f32_16x16x32_bf16 v[112:115], v[208:211], v[192:195], v[112:115]
    ds_read_b64_tr_b16 v[220:221], v225 offset:36872
    v_smfmac_f32_16x16x64_bf16 a[244:247], a[252:255], v[188:195], v233
    ds_read_b64_tr_b16 v[222:223], v225 offset:38920
    v_mfma_f32_16x16x32_bf16 v[200:203], a[164:167], a[32:35], 0
    v_exp_f32 v204, v204
    v_mfma_f32_16x16x32_bf16 v[200:203], a[228:231], a[36:39], v[200:203]
    v_exp_f32 v205, v205
    v_mfma_f32_16x16x32_bf16 v[200:203], a[232:235], a[40:43], v[200:203]
    v_exp_f32 v206, v206
    v_mfma_f32_16x16x32_bf16 v[200:203], a[236:239], a[44:47], v[200:203]
    s_waitcnt lgkmcnt(6)
    v_exp_f32 v207, v207
    v_mfma_f32_16x16x32_bf16 v[20:23], v[212:215], v[180:183], v[20:23]
    v_cvt_pk_bf16_f32 v166, v204, v205
    v_cvt_pk_bf16_f32 v167, v206, v207
    v_mfma_f32_16x16x32_bf16 v[52:55], v[212:215], v[184:187], v[52:55]
    v_mfma_f32_16x16x32_bf16 v[84:87], v[212:215], v[188:191], v[84:87]
    v_mfma_f32_16x16x32_bf16 v[116:119], v[212:215], v[192:195], v[116:119]
    ds_read_b64_tr_b16 v[208:209], v224 offset:8192
    v_mfma_f32_16x16x32_bf16 v[204:207], a[164:167], a[48:51], 0
    v_exp_f32 v200, v200
    v_mfma_f32_16x16x32_bf16 v[204:207], a[228:231], a[52:55], v[204:207]
    buffer_load_dwordx4 v[140:143], v230, s[8:11], s44 offen nt
    v_mfma_f32_16x16x32_bf16 v[204:207], a[232:235], a[56:59], v[204:207]
    s_add_u32 s44, s36, s46
    v_exp_f32 v201, v201
    v_mfma_f32_16x16x32_bf16 v[204:207], a[236:239], a[60:63], v[204:207]
    s_waitcnt lgkmcnt(3)
    ds_read_b64_tr_b16 v[210:211], v224 offset:10240
    v_cvt_pk_bf16_f32 v170, v200, v201
    v_mfma_f32_16x16x32_bf16 v[24:27], v[216:219], v[180:183], v[24:27]
    v_exp_f32 v202, v202
    v_mfma_f32_16x16x32_bf16 v[56:59], v[216:219], v[184:187], v[56:59]
    ds_read_b128 a[228:231], v229 offset:28672
    v_mfma_f32_16x16x32_bf16 v[88:91], v[216:219], v[188:191], v[88:91]
    v_exp_f32 v203, v203
    v_mfma_f32_16x16x32_bf16 v[120:123], v[216:219], v[192:195], v[120:123]
    ds_read_b64_tr_b16 v[212:213], v224 offset:8200
    v_cvt_pk_bf16_f32 v171, v202, v203
    v_mfma_f32_16x16x32_bf16 v[200:203], a[168:171], a[0:3], 0
    v_exp_f32 v204, v204
    v_mfma_f32_16x16x32_bf16 v[200:203], a[212:215], a[4:7], v[200:203]
    ds_read_b64_tr_b16 v[214:215], v224 offset:10248
    v_mfma_f32_16x16x32_bf16 v[200:203], a[216:219], a[8:11], v[200:203]
    v_exp_f32 v205, v205
    v_mfma_f32_16x16x32_bf16 v[200:203], a[220:223], a[12:15], v[200:203]
    s_waitcnt lgkmcnt(5)
    ds_read_b128 a[232:235], v235 offset:28672
    v_cvt_pk_bf16_f32 v174, v204, v205
    v_mfma_f32_16x16x32_bf16 v[28:31], v[220:223], v[180:183], v[28:31]
    v_exp_f32 v206, v206
    v_mfma_f32_16x16x32_bf16 v[60:63], v[220:223], v[184:187], v[60:63]
    ds_read_b128 a[236:239], v231 offset:28672
    v_mfma_f32_16x16x32_bf16 v[92:95], v[220:223], v[188:191], v[92:95]
    v_exp_f32 v207, v207
    v_mfma_f32_16x16x32_bf16 v[124:127], v[220:223], v[192:195], v[124:127]
    ds_read_b64_tr_b16 v[216:217], v225 offset:8192
    v_cvt_pk_bf16_f32 v175, v206, v207
    v_mfma_f32_16x16x32_bf16 v[204:207], a[168:171], a[16:19], 0
    v_exp_f32 v200, v200
    v_mfma_f32_16x16x32_bf16 v[204:207], a[212:215], a[20:23], v[204:207]
    buffer_load_dwordx4 v[144:147], v230, s[8:11], s43 offen nt
    v_mfma_f32_16x16x32_bf16 v[204:207], a[216:219], a[24:27], v[204:207]
    s_add_u32 s43, s36, s47
    v_exp_f32 v201, v201
    v_mfma_f32_16x16x32_bf16 v[204:207], a[220:223], a[28:31], v[204:207]
    s_waitcnt lgkmcnt(6)
    ds_read_b64_tr_b16 v[218:219], v225 offset:10240
    v_cvt_pk_bf16_f32 v180, v200, v201
L_pad8:
    s_cbranch_vccnz L_pad12
    v_mfma_f32_16x16x32_bf16 v[0:3], v[208:211], v[160:163], v[0:3]
    v_exp_f32 v202, v202
    v_mfma_f32_16x16x32_bf16 v[32:35], v[208:211], v[164:167], v[32:35]
    v_exp_f32 v203, v203
    v_mfma_f32_16x16x32_bf16 v[64:67], v[208:211], v[168:171], v[64:67]
    v_cvt_pk_bf16_f32 v181, v202, v203
    v_mfma_f32_16x16x32_bf16 v[96:99], v[208:211], v[172:175], v[96:99]
    ds_read_b64_tr_b16 v[220:221], v225 offset:8200
    v_smfmac_f32_16x16x64_bf16 a[240:243], a[252:255], v[160:167], v233
    ds_read_b64_tr_b16 v[222:223], v225 offset:10248
    v_mfma_f32_16x16x32_bf16 v[200:203], a[168:171], a[32:35], 0
    v_exp_f32 v204, v204
    v_mfma_f32_16x16x32_bf16 v[200:203], a[212:215], a[36:39], v[200:203]
    v_exp_f32 v205, v205
    v_mfma_f32_16x16x32_bf16 v[200:203], a[216:219], a[40:43], v[200:203]
    v_exp_f32 v206, v206
    v_mfma_f32_16x16x32_bf16 v[200:203], a[220:223], a[44:47], v[200:203]
    s_waitcnt lgkmcnt(6)
    v_exp_f32 v207, v207
    v_mfma_f32_16x16x32_bf16 v[4:7], v[212:215], v[160:163], v[4:7]
    v_cvt_pk_bf16_f32 v184, v204, v205
    v_cvt_pk_bf16_f32 v185, v206, v207
    v_mfma_f32_16x16x32_bf16 v[36:39], v[212:215], v[164:167], v[36:39]
    v_mfma_f32_16x16x32_bf16 v[68:71], v[212:215], v[168:171], v[68:71]
    v_mfma_f32_16x16x32_bf16 v[100:103], v[212:215], v[172:175], v[100:103]
    ds_read_b64_tr_b16 v[208:209], v224 offset:40960
    v_mfma_f32_16x16x32_bf16 v[204:207], a[168:171], a[48:51], 0
    v_exp_f32 v200, v200
    v_mfma_f32_16x16x32_bf16 v[204:207], a[212:215], a[52:55], v[204:207]
    buffer_load_dwordx4 v[148:151], v230, s[8:11], s44 offen nt
    v_mfma_f32_16x16x32_bf16 v[204:207], a[216:219], a[56:59], v[204:207]
    s_add_u32 s44, s36, s48
    v_exp_f32 v201, v201
    v_mfma_f32_16x16x32_bf16 v[204:207], a[220:223], a[60:63], v[204:207]
    s_waitcnt lgkmcnt(3)
    s_barrier
    ds_read_b64_tr_b16 v[210:211], v224 offset:43008
    v_cvt_pk_bf16_f32 v188, v200, v201
    v_mfma_f32_16x16x32_bf16 v[8:11], v[216:219], v[160:163], v[8:11]
    v_exp_f32 v202, v202
    v_mfma_f32_16x16x32_bf16 v[40:43], v[216:219], v[164:167], v[40:43]
    ds_write_b64 v228, a[192:193] offset:16384
    v_mfma_f32_16x16x32_bf16 v[72:75], v[216:219], v[168:171], v[72:75]
    v_exp_f32 v203, v203
    v_mfma_f32_16x16x32_bf16 v[104:107], v[216:219], v[172:175], v[104:107]
    ds_read_b64_tr_b16 v[212:213], v224 offset:40968
    v_cvt_pk_bf16_f32 v189, v202, v203
    v_mfma_f32_16x16x32_bf16 v[200:203], a[172:175], a[0:3], 0
    v_exp_f32 v204, v204
    v_mfma_f32_16x16x32_bf16 v[200:203], a[228:231], a[4:7], v[200:203]
    ds_write_b64 v228, a[194:195] offset:16392
    v_mfma_f32_16x16x32_bf16 v[200:203], a[232:235], a[8:11], v[200:203]
    v_exp_f32 v205, v205
    v_mfma_f32_16x16x32_bf16 v[200:203], a[236:239], a[12:15], v[200:203]
    s_waitcnt lgkmcnt(5)
    ds_read_b64_tr_b16 v[214:215], v224 offset:43016
    v_cvt_pk_bf16_f32 v192, v204, v205
    v_mfma_f32_16x16x32_bf16 v[12:15], v[220:223], v[160:163], v[12:15]
    v_exp_f32 v206, v206
    v_mfma_f32_16x16x32_bf16 v[44:47], v[220:223], v[164:167], v[44:47]
    ds_write_b64 v228, a[196:197] offset:20480
    v_mfma_f32_16x16x32_bf16 v[76:79], v[220:223], v[168:171], v[76:79]
    v_exp_f32 v207, v207
    v_mfma_f32_16x16x32_bf16 v[108:111], v[220:223], v[172:175], v[108:111]
    ds_read_b64_tr_b16 v[216:217], v225 offset:40960
    v_cvt_pk_bf16_f32 v193, v206, v207
    v_mfma_f32_16x16x32_bf16 v[204:207], a[172:175], a[16:19], 0
    v_exp_f32 v200, v200
    v_mfma_f32_16x16x32_bf16 v[204:207], a[228:231], a[20:23], v[204:207]
    buffer_load_dwordx4 v[152:155], v230, s[8:11], s43 offen nt
    v_mfma_f32_16x16x32_bf16 v[204:207], a[232:235], a[24:27], v[204:207]
    s_add_u32 s43, s37, s28
    v_exp_f32 v201, v201
    v_mfma_f32_16x16x32_bf16 v[204:207], a[236:239], a[28:31], v[204:207]
    s_waitcnt lgkmcnt(6)
    ds_read_b64_tr_b16 v[218:219], v225 offset:43008
    v_cvt_pk_bf16_f32 v182, v200, v201
    v_mfma_f32_16x16x32_bf16 v[16:19], v[208:211], v[160:163], v[16:19]
    v_exp_f32 v202, v202
    v_mfma_f32_16x16x32_bf16 v[48:51], v[208:211], v[164:167], v[48:51]
    ds_write_b64 v228, a[198:199] offset:20488
    v_mfma_f32_16x16x32_bf16 v[80:83], v[208:211], v[168:171], v[80:83]
    v_exp_f32 v203, v203
    v_mfma_f32_16x16x32_bf16 v[112:115], v[208:211], v[172:175], v[112:115]
    ds_read_b128 a[212:215], v229 offset:0
    v_cvt_pk_bf16_f32 v183, v202, v203
    v_smfmac_f32_16x16x64_bf16 a[244:247], a[252:255], v[168:175], v233
    ds_write_b64 v228, a[200:201] offset:24576
    v_mfma_f32_16x16x32_bf16 v[200:203], a[172:175], a[32:35], 0
    v_exp_f32 v204, v204
    v_mfma_f32_16x16x32_bf16 v[200:203], a[228:231], a[36:39], v[200:203]
    ds_write_b64 v228, a[202:203] offset:24584
    v_mfma_f32_16x16x32_bf16 v[200:203], a[232:235], a[40:43], v[200:203]
    v_exp_f32 v205, v205
    v_mfma_f32_16x16x32_bf16 v[200:203], a[236:239], a[44:47], v[200:203]
    s_waitcnt lgkmcnt(7)
    ds_read_b128 a[216:219], v235 offset:0
    v_cvt_pk_bf16_f32 v186, v204, v205
    v_mfma_f32_16x16x32_bf16 v[20:23], v[212:215], v[160:163], v[20:23]
    v_exp_f32 v206, v206
    v_mfma_f32_16x16x32_bf16 v[52:55], v[212:215], v[164:167], v[52:55]
    ds_write_b64 v228, a[204:205] offset:28672
    v_mfma_f32_16x16x32_bf16 v[84:87], v[212:215], v[168:171], v[84:87]
    v_exp_f32 v207, v207
    v_mfma_f32_16x16x32_bf16 v[116:119], v[212:215], v[172:175], v[116:119]
    buffer_load_dwordx4 v[156:159], v230, s[8:11], s44 offen nt
    v_cvt_pk_bf16_f32 v187, v206, v207
    v_mfma_f32_16x16x32_bf16 v[204:207], a[172:175], a[48:51], 0
    s_add_u32 s44, s37, s46
    ds_read_b128 a[220:223], v231 offset:0
    v_exp_f32 v200, v200
    v_mfma_f32_16x16x32_bf16 v[204:207], a[228:231], a[52:55], v[204:207]
    ds_write_b64 v228, a[206:207] offset:28680
    v_mfma_f32_16x16x32_bf16 v[204:207], a[232:235], a[56:59], v[204:207]
    v_exp_f32 v201, v201
    v_mfma_f32_16x16x32_bf16 v[204:207], a[236:239], a[60:63], v[204:207]
    s_waitcnt lgkmcnt(8)
    ds_read_b64_tr_b16 v[220:221], v225 offset:40968
    v_cvt_pk_bf16_f32 v190, v200, v201
    v_mfma_f32_16x16x32_bf16 v[24:27], v[216:219], v[160:163], v[24:27]
    ds_read_b64_tr_b16 v[222:223], v225 offset:43016
    v_exp_f32 v202, v202
    v_mfma_f32_16x16x32_bf16 v[56:59], v[216:219], v[164:167], v[56:59]
    ds_read_b64_tr_b16 v[208:209], v224 offset:12288
    v_mfma_f32_16x16x32_bf16 v[88:91], v[216:219], v[168:171], v[88:91]
    v_exp_f32 v203, v203
    v_mfma_f32_16x16x32_bf16 v[120:123], v[216:219], v[172:175], v[120:123]
    ds_read_b64_tr_b16 v[210:211], v224 offset:14336
    v_cvt_pk_bf16_f32 v191, v202, v203
    v_mfma_f32_16x16x32_bf16 v[200:203], a[176:179], a[0:3], 0
    s_waitcnt lgkmcnt(10)
    v_exp_f32 v204, v204
    v_mfma_f32_16x16x32_bf16 v[200:203], a[212:215], a[4:7], v[200:203]
    s_waitcnt lgkmcnt(7)
    ds_read_b64_tr_b16 v[212:213], v224 offset:12296
    v_mfma_f32_16x16x32_bf16 v[200:203], a[216:219], a[8:11], v[200:203]
    s_waitcnt lgkmcnt(6)
    v_exp_f32 v205, v205
    v_mfma_f32_16x16x32_bf16 v[200:203], a[220:223], a[12:15], v[200:203]
    s_waitcnt lgkmcnt(3)
    ds_read_b64_tr_b16 v[214:215], v224 offset:14344
    v_cvt_pk_bf16_f32 v194, v204, v205
    v_mfma_f32_16x16x32_bf16 v[28:31], v[220:223], v[160:163], v[28:31]
    v_exp_f32 v206, v206
    v_mfma_f32_16x16x32_bf16 v[60:63], v[220:223], v[164:167], v[60:63]
    ds_read_b128 a[228:231], v229 offset:4096
    v_mfma_f32_16x16x32_bf16 v[92:95], v[220:223], v[168:171], v[92:95]
    v_exp_f32 v207, v207
    v_mfma_f32_16x16x32_bf16 v[124:127], v[220:223], v[172:175], v[124:127]
    buffer_load_dwordx4 v[176:179], v230, s[8:11], s43 offen nt
    v_cvt_pk_bf16_f32 v195, v206, v207
    v_mfma_f32_16x16x32_bf16 v[204:207], a[176:179], a[16:19], 0
    s_add_u32 s43, s37, s47
    v_exp_f32 v200, v200
    v_mfma_f32_16x16x32_bf16 v[204:207], a[212:215], a[20:23], v[204:207]
    ds_read_b64_tr_b16 v[216:217], v225 offset:12288
    v_mfma_f32_16x16x32_bf16 v[204:207], a[216:219], a[24:27], v[204:207]
    v_exp_f32 v201, v201
    v_mfma_f32_16x16x32_bf16 v[204:207], a[220:223], a[28:31], v[204:207]
    s_waitcnt lgkmcnt(4)
    ds_read_b64_tr_b16 v[218:219], v225 offset:14336
    v_cvt_pk_bf16_f32 v160, v200, v201
    v_mfma_f32_16x16x32_bf16 v[0:3], v[208:211], v[180:183], v[0:3]
    v_exp_f32 v202, v202
    v_mfma_f32_16x16x32_bf16 v[32:35], v[208:211], v[184:187], v[32:35]
    ds_read_b128 a[232:235], v235 offset:4096
    v_mfma_f32_16x16x32_bf16 v[64:67], v[208:211], v[188:191], v[64:67]
    v_exp_f32 v203, v203
    v_mfma_f32_16x16x32_bf16 v[96:99], v[208:211], v[192:195], v[96:99]
    ds_read_b128 a[236:239], v231 offset:4096
    v_cvt_pk_bf16_f32 v161, v202, v203
    v_smfmac_f32_16x16x64_bf16 a[240:243], a[252:255], v[180:187], v233
    ds_read_b64_tr_b16 v[220:221], v225 offset:12296
    v_mfma_f32_16x16x32_bf16 v[200:203], a[176:179], a[32:35], 0
    v_exp_f32 v204, v204
    v_mfma_f32_16x16x32_bf16 v[200:203], a[212:215], a[36:39], v[200:203]
    ds_read_b64_tr_b16 v[222:223], v225 offset:14344
    v_mfma_f32_16x16x32_bf16 v[200:203], a[216:219], a[40:43], v[200:203]
    v_exp_f32 v205, v205
    v_mfma_f32_16x16x32_bf16 v[200:203], a[220:223], a[44:47], v[200:203]
    s_waitcnt lgkmcnt(7)
    v_exp_f32 v206, v206
    v_mfma_f32_16x16x32_bf16 v[4:7], v[212:215], v[180:183], v[4:7]
    v_exp_f32 v207, v207
    v_mfma_f32_16x16x32_bf16 v[36:39], v[212:215], v[184:187], v[36:39]
    v_cvt_pk_bf16_f32 v164, v204, v205
    v_cvt_pk_bf16_f32 v165, v206, v207
    v_mfma_f32_16x16x32_bf16 v[68:71], v[212:215], v[188:191], v[68:71]
    buffer_load_dwordx4 v[196:199], v230, s[8:11], s44 offen nt
    v_mfma_f32_16x16x32_bf16 v[100:103], v[212:215], v[192:195], v[100:103]
    s_add_u32 s44, s37, s48
    ds_read_b64_tr_b16 v[208:209], v224 offset:45056
    v_mfma_f32_16x16x32_bf16 v[204:207], a[176:179], a[48:51], 0
    v_exp_f32 v200, v200
    v_mfma_f32_16x16x32_bf16 v[204:207], a[212:215], a[52:55], v[204:207]
    ds_read_b64_tr_b16 v[210:211], v224 offset:47104
    v_mfma_f32_16x16x32_bf16 v[204:207], a[216:219], a[56:59], v[204:207]
    v_exp_f32 v201, v201
    v_mfma_f32_16x16x32_bf16 v[204:207], a[220:223], a[60:63], v[204:207]
    s_waitcnt lgkmcnt(6)
    ds_read_b128 a[212:215], v229 offset:8192
    v_cvt_pk_bf16_f32 v168, v200, v201
    v_mfma_f32_16x16x32_bf16 v[8:11], v[216:219], v[180:183], v[8:11]
    v_exp_f32 v202, v202
    v_mfma_f32_16x16x32_bf16 v[40:43], v[216:219], v[184:187], v[40:43]
    ds_read_b128 a[216:219], v235 offset:8192
    v_mfma_f32_16x16x32_bf16 v[72:75], v[216:219], v[188:191], v[72:75]
    v_exp_f32 v203, v203
    v_mfma_f32_16x16x32_bf16 v[104:107], v[216:219], v[192:195], v[104:107]
    ds_read_b64_tr_b16 v[212:213], v224 offset:45064
    v_cvt_pk_bf16_f32 v169, v202, v203
    v_mfma_f32_16x16x32_bf16 v[200:203], a[180:183], a[0:3], 0
    v_exp_f32 v204, v204
    v_mfma_f32_16x16x32_bf16 v[200:203], a[228:231], a[4:7], v[200:203]
    s_waitcnt lgkmcnt(8)
    ds_read_b64_tr_b16 v[214:215], v224 offset:47112
    v_mfma_f32_16x16x32_bf16 v[200:203], a[232:235], a[8:11], v[200:203]
    s_waitcnt lgkmcnt(8)
    v_exp_f32 v205, v205
    v_mfma_f32_16x16x32_bf16 v[200:203], a[236:239], a[12:15], v[200:203]
    s_waitcnt lgkmcnt(6)
    ds_read_b128 a[220:223], v231 offset:8192
    v_cvt_pk_bf16_f32 v172, v204, v205
    v_mfma_f32_16x16x32_bf16 v[12:15], v[220:223], v[180:183], v[12:15]
    v_exp_f32 v206, v206
    v_mfma_f32_16x16x32_bf16 v[44:47], v[220:223], v[184:187], v[44:47]
    v_exp_f32 v207, v207
    v_mfma_f32_16x16x32_bf16 v[76:79], v[220:223], v[188:191], v[76:79]
    buffer_load_dwordx4 v[236:239], v230, s[8:11], s43 offen nt
    v_mfma_f32_16x16x32_bf16 v[108:111], v[220:223], v[192:195], v[108:111]
    s_add_u32 s43, s38, s28
    ds_read_b64_tr_b16 v[216:217], v225 offset:45056
    v_cvt_pk_bf16_f32 v173, v206, v207
    v_mfma_f32_16x16x32_bf16 v[204:207], a[180:183], a[16:19], 0
    v_exp_f32 v200, v200
    v_mfma_f32_16x16x32_bf16 v[204:207], a[228:231], a[20:23], v[204:207]
    ds_read_b64_tr_b16 v[218:219], v225 offset:47104
    v_mfma_f32_16x16x32_bf16 v[204:207], a[232:235], a[24:27], v[204:207]
    v_exp_f32 v201, v201
    v_mfma_f32_16x16x32_bf16 v[204:207], a[236:239], a[28:31], v[204:207]
    s_waitcnt lgkmcnt(7)
    v_exp_f32 v202, v202
    v_mfma_f32_16x16x32_bf16 v[16:19], v[208:211], v[180:183], v[16:19]
    v_exp_f32 v203, v203
    v_mfma_f32_16x16x32_bf16 v[48:51], v[208:211], v[184:187], v[48:51]
    v_cvt_pk_bf16_f32 v162, v200, v201
    v_cvt_pk_bf16_f32 v163, v202, v203
    v_mfma_f32_16x16x32_bf16 v[80:83], v[208:211], v[188:191], v[80:83]
    v_mfma_f32_16x16x32_bf16 v[112:115], v[208:211], v[192:195], v[112:115]
    ds_read_b64_tr_b16 v[220:221], v225 offset:45064
    v_smfmac_f32_16x16x64_bf16 a[244:247], a[252:255], v[188:195], v233
    ds_read_b64_tr_b16 v[222:223], v225 offset:47112
    v_mfma_f32_16x16x32_bf16 v[200:203], a[180:183], a[32:35], 0
    v_exp_f32 v204, v204
    v_mfma_f32_16x16x32_bf16 v[200:203], a[228:231], a[36:39], v[200:203]
    v_exp_f32 v205, v205
    v_mfma_f32_16x16x32_bf16 v[200:203], a[232:235], a[40:43], v[200:203]
    v_exp_f32 v206, v206
    v_mfma_f32_16x16x32_bf16 v[200:203], a[236:239], a[44:47], v[200:203]
    s_waitcnt lgkmcnt(5)
    v_exp_f32 v207, v207
    v_mfma_f32_16x16x32_bf16 v[20:23], v[212:215], v[180:183], v[20:23]
    v_cvt_pk_bf16_f32 v166, v204, v205
    v_cvt_pk_bf16_f32 v167, v206, v207
    v_mfma_f32_16x16x32_bf16 v[52:55], v[212:215], v[184:187], v[52:55]
    buffer_load_dwordx4 v[240:243], v230, s[8:11], s44 offen nt
    v_mfma_f32_16x16x32_bf16 v[84:87], v[212:215], v[188:191], v[84:87]
    s_add_u32 s44, s38, s46
    v_mfma_f32_16x16x32_bf16 v[116:119], v[212:215], v[192:195], v[116:119]
    ds_read_b64_tr_b16 v[208:209], v224 offset:16384
    v_mfma_f32_16x16x32_bf16 v[204:207], a[180:183], a[48:51], 0
    v_exp_f32 v200, v200
    v_mfma_f32_16x16x32_bf16 v[204:207], a[228:231], a[52:55], v[204:207]
    ds_read_b64_tr_b16 v[210:211], v224 offset:18432
    v_mfma_f32_16x16x32_bf16 v[204:207], a[232:235], a[56:59], v[204:207]
    v_exp_f32 v201, v201
    v_mfma_f32_16x16x32_bf16 v[204:207], a[236:239], a[60:63], v[204:207]
    s_waitcnt lgkmcnt(4)
    ds_read_b128 a[228:231], v229 offset:12288
    v_cvt_pk_bf16_f32 v170, v200, v201
    v_mfma_f32_16x16x32_bf16 v[24:27], v[216:219], v[180:183], v[24:27]
    v_exp_f32 v202, v202
    v_mfma_f32_16x16x32_bf16 v[56:59], v[216:219], v[184:187], v[56:59]
    ds_read_b128 a[232:235], v235 offset:12288
    v_mfma_f32_16x16x32_bf16 v[88:91], v[216:219], v[188:191], v[88:91]
    v_exp_f32 v203, v203
    v_mfma_f32_16x16x32_bf16 v[120:123], v[216:219], v[192:195], v[120:123]
    ds_read_b64_tr_b16 v[212:213], v224 offset:16392
    v_cvt_pk_bf16_f32 v171, v202, v203
    v_mfma_f32_16x16x32_bf16 v[200:203], a[184:187], a[0:3], 0
    v_exp_f32 v204, v204
    v_mfma_f32_16x16x32_bf16 v[200:203], a[212:215], a[4:7], v[200:203]
    ds_read_b64_tr_b16 v[214:215], v224 offset:18440
    v_mfma_f32_16x16x32_bf16 v[200:203], a[216:219], a[8:11], v[200:203]
    v_exp_f32 v205, v205
    v_mfma_f32_16x16x32_bf16 v[200:203], a[220:223], a[12:15], v[200:203]
    s_waitcnt lgkmcnt(6)
    ds_read_b128 a[236:239], v231 offset:12288
    v_cvt_pk_bf16_f32 v174, v204, v205
    v_mfma_f32_16x16x32_bf16 v[28:31], v[220:223], v[180:183], v[28:31]
    v_exp_f32 v206, v206
    v_mfma_f32_16x16x32_bf16 v[60:63], v[220:223], v[184:187], v[60:63]
    buffer_load_dwordx4 a[64:67], v230, s[8:11], s43 offen nt
    v_mfma_f32_16x16x32_bf16 v[92:95], v[220:223], v[188:191], v[92:95]
    s_add_u32 s43, s38, s47
    v_exp_f32 v207, v207
    v_mfma_f32_16x16x32_bf16 v[124:127], v[220:223], v[192:195], v[124:127]
    ds_read_b64_tr_b16 v[216:217], v225 offset:16384
    v_cvt_pk_bf16_f32 v175, v206, v207
    v_mfma_f32_16x16x32_bf16 v[204:207], a[184:187], a[16:19], 0
    v_exp_f32 v200, v200
    v_mfma_f32_16x16x32_bf16 v[204:207], a[212:215], a[20:23], v[204:207]
    ds_read_b64_tr_b16 v[218:219], v225 offset:18432
    v_mfma_f32_16x16x32_bf16 v[204:207], a[216:219], a[24:27], v[204:207]
    v_exp_f32 v201, v201
    v_mfma_f32_16x16x32_bf16 v[204:207], a[220:223], a[28:31], v[204:207]
    s_waitcnt lgkmcnt(7)
    v_exp_f32 v202, v202
    v_mfma_f32_16x16x32_bf16 v[0:3], v[208:211], v[160:163], v[0:3]
    v_exp_f32 v203, v203
    v_mfma_f32_16x16x32_bf16 v[32:35], v[208:211], v[164:167], v[32:35]
    v_cvt_pk_bf16_f32 v180, v200, v201
    v_cvt_pk_bf16_f32 v181, v202, v203
    v_mfma_f32_16x16x32_bf16 v[64:67], v[208:211], v[168:171], v[64:67]
    v_mfma_f32_16x16x32_bf16 v[96:99], v[208:211], v[172:175], v[96:99]
    ds_read_b64_tr_b16 v[220:221], v225 offset:16392
    v_smfmac_f32_16x16x64_bf16 a[240:243], a[252:255], v[160:167], v233
    ds_read_b64_tr_b16 v[222:223], v225 offset:18440
    v_mfma_f32_16x16x32_bf16 v[200:203], a[184:187], a[32:35], 0
    v_exp_f32 v204, v204
    v_mfma_f32_16x16x32_bf16 v[200:203], a[212:215], a[36:39], v[200:203]
    v_exp_f32 v205, v205
    v_mfma_f32_16x16x32_bf16 v[200:203], a[216:219], a[40:43], v[200:203]
    v_exp_f32 v206, v206
    v_mfma_f32_16x16x32_bf16 v[200:203], a[220:223], a[44:47], v[200:203]
    s_waitcnt lgkmcnt(5)
    v_exp_f32 v207, v207
    v_mfma_f32_16x16x32_bf16 v[4:7], v[212:215], v[160:163], v[4:7]
    buffer_load_dwordx4 a[68:71], v230, s[8:11], s44 offen nt
    v_mfma_f32_16x16x32_bf16 v[36:39], v[212:215], v[164:167], v[36:39]
    s_add_u32 s44, s38, s48
    v_cvt_pk_bf16_f32 v184, v204, v205
    v_cvt_pk_bf16_f32 v185, v206, v207
    v_mfma_f32_16x16x32_bf16 v[68:71], v[212:215], v[168:171], v[68:71]
    v_mfma_f32_16x16x32_bf16 v[100:103], v[212:215], v[172:175], v[100:103]
    ds_read_b64_tr_b16 v[208:209], v224 offset:49152
    v_mfma_f32_16x16x32_bf16 v[204:207], a[184:187], a[48:51], 0
    v_exp_f32 v200, v200
    v_mfma_f32_16x16x32_bf16 v[204:207], a[212:215], a[52:55], v[204:207]
    ds_read_b64_tr_b16 v[210:211], v224 offset:51200
    v_mfma_f32_16x16x32_bf16 v[204:207], a[216:219], a[56:59], v[204:207]
    v_exp_f32 v201, v201
    v_mfma_f32_16x16x32_bf16 v[204:207], a[220:223], a[60:63], v[204:207]
    s_waitcnt lgkmcnt(4)
    s_barrier
    ds_read_b128 a[212:215], v229 offset:16384
    v_cvt_pk_bf16_f32 v188, v200, v201
    v_mfma_f32_16x16x32_bf16 v[8:11], v[216:219], v[160:163], v[8:11]
    v_exp_f32 v202, v202
    v_mfma_f32_16x16x32_bf16 v[40:43], v[216:219], v[164:167], v[40:43]
    ds_write_b64 v228, a[80:81] offset:0
    v_mfma_f32_16x16x32_bf16 v[72:75], v[216:219], v[168:171], v[72:75]
    v_exp_f32 v203, v203
    v_mfma_f32_16x16x32_bf16 v[104:107], v[216:219], v[172:175], v[104:107]
    ds_read_b64_tr_b16 v[212:213], v224 offset:49160
    v_cvt_pk_bf16_f32 v189, v202, v203
    v_mfma_f32_16x16x32_bf16 v[200:203], a[188:191], a[0:3], 0
    v_exp_f32 v204, v204
    v_mfma_f32_16x16x32_bf16 v[200:203], a[228:231], a[4:7], v[200:203]
    ds_write_b64 v228, a[82:83] offset:8
    v_mfma_f32_16x16x32_bf16 v[200:203], a[232:235], a[8:11], v[200:203]
    v_exp_f32 v205, v205
    v_mfma_f32_16x16x32_bf16 v[200:203], a[236:239], a[12:15], v[200:203]
    s_waitcnt lgkmcnt(6)
    ds_read_b64_tr_b16 v[214:215], v224 offset:51208
    v_cvt_pk_bf16_f32 v192, v204, v205
    v_mfma_f32_16x16x32_bf16 v[12:15], v[220:223], v[160:163], v[12:15]
    v_exp_f32 v206, v206
    v_mfma_f32_16x16x32_bf16 v[44:47], v[220:223], v[164:167], v[44:47]
    buffer_load_dwordx4 a[72:75], v230, s[8:11], s43 offen nt
    v_mfma_f32_16x16x32_bf16 v[76:79], v[220:223], v[168:171], v[76:79]
    v_exp_f32 v207, v207
    v_mfma_f32_16x16x32_bf16 v[108:111], v[220:223], v[172:175], v[108:111]
    ds_read_b64_tr_b16 v[216:217], v225 offset:49152
    v_cvt_pk_bf16_f32 v193, v206, v207
    v_mfma_f32_16x16x32_bf16 v[204:207], a[188:191], a[16:19], 0
    v_exp_f32 v200, v200
    v_mfma_f32_16x16x32_bf16 v[204:207], a[228:231], a[20:23], v[204:207]
    ds_write_b64 v228, a[84:85] offset:4096
    v_mfma_f32_16x16x32_bf16 v[204:207], a[232:235], a[24:27], v[204:207]
    v_exp_f32 v201, v201
    v_mfma_f32_16x16x32_bf16 v[204:207], a[236:239], a[28:31], v[204:207]
    s_waitcnt lgkmcnt(7)
    ds_read_b64_tr_b16 v[218:219], v225 offset:51200
    v_cvt_pk_bf16_f32 v182, v200, v201
    v_mfma_f32_16x16x32_bf16 v[16:19], v[208:211], v[160:163], v[16:19]
    v_exp_f32 v202, v202
    v_mfma_f32_16x16x32_bf16 v[48:51], v[208:211], v[164:167], v[48:51]
    ds_write_b64 v228, a[86:87] offset:4104
    v_mfma_f32_16x16x32_bf16 v[80:83], v[208:211], v[168:171], v[80:83]
    v_exp_f32 v203, v203
    v_mfma_f32_16x16x32_bf16 v[112:115], v[208:211], v[172:175], v[112:115]
    ds_read_b128 a[216:219], v235 offset:16384
    v_cvt_pk_bf16_f32 v183, v202, v203
    v_smfmac_f32_16x16x64_bf16 a[244:247], a[252:255], v[168:175], v233
    ds_write_b64 v228, a[88:89] offset:8192
    v_mfma_f32_16x16x32_bf16 v[200:203], a[188:191], a[32:35], 0
    v_exp_f32 v204, v204
    v_mfma_f32_16x16x32_bf16 v[200:203], a[228:231], a[36:39], v[200:203]
    ds_write_b64 v228, a[90:91] offset:8200
    v_mfma_f32_16x16x32_bf16 v[200:203], a[232:235], a[40:43], v[200:203]
    v_exp_f32 v205, v205
    v_mfma_f32_16x16x32_bf16 v[200:203], a[236:239], a[44:47], v[200:203]
    s_waitcnt lgkmcnt(7)
    buffer_load_dwordx4 a[76:79], v230, s[8:11], s44 offen nt
    v_mfma_f32_16x16x32_bf16 v[20:23], v[212:215], v[160:163], v[20:23]
    v_exp_f32 v206, v206
    v_mfma_f32_16x16x32_bf16 v[52:55], v[212:215], v[164:167], v[52:55]
    ds_read_b128 a[220:223], v231 offset:16384
    v_cvt_pk_bf16_f32 v186, v204, v205
    v_mfma_f32_16x16x32_bf16 v[84:87], v[212:215], v[168:171], v[84:87]
    v_exp_f32 v207, v207
    v_mfma_f32_16x16x32_bf16 v[116:119], v[212:215], v[172:175], v[116:119]
    ds_read_b64_tr_b16 v[220:221], v225 offset:49160
    v_cvt_pk_bf16_f32 v187, v206, v207
    v_mfma_f32_16x16x32_bf16 v[204:207], a[188:191], a[48:51], 0
    v_exp_f32 v200, v200
    v_mfma_f32_16x16x32_bf16 v[204:207], a[228:231], a[52:55], v[204:207]
    ds_write_b64 v228, a[92:93] offset:12288
    v_mfma_f32_16x16x32_bf16 v[204:207], a[232:235], a[56:59], v[204:207]
    v_exp_f32 v201, v201
    v_mfma_f32_16x16x32_bf16 v[204:207], a[236:239], a[60:63], v[204:207]
    s_waitcnt lgkmcnt(7)
    ds_read_b64_tr_b16 v[222:223], v225 offset:51208
    v_cvt_pk_bf16_f32 v190, v200, v201
    v_mfma_f32_16x16x32_bf16 v[24:27], v[216:219], v[160:163], v[24:27]
    v_exp_f32 v202, v202
    v_mfma_f32_16x16x32_bf16 v[56:59], v[216:219], v[164:167], v[56:59]
    ds_write_b64 v228, a[94:95] offset:12296
    v_mfma_f32_16x16x32_bf16 v[88:91], v[216:219], v[168:171], v[88:91]
    v_exp_f32 v203, v203
    v_mfma_f32_16x16x32_bf16 v[120:123], v[216:219], v[172:175], v[120:123]
    ds_read_b64_tr_b16 v[208:209], v224 offset:20480
    v_cvt_pk_bf16_f32 v191, v202, v203
    v_mfma_f32_16x16x32_bf16 v[200:203], a[192:195], a[0:3], 0
    v_exp_f32 v204, v204
    v_mfma_f32_16x16x32_bf16 v[200:203], a[212:215], a[4:7], v[200:203]
    s_waitcnt lgkmcnt(8)
    ds_read_b64_tr_b16 v[210:211], v224 offset:22528
    v_mfma_f32_16x16x32_bf16 v[200:203], a[216:219], a[8:11], v[200:203]
    s_waitcnt lgkmcnt(6)
    v_exp_f32 v205, v205
    v_mfma_f32_16x16x32_bf16 v[200:203], a[220:223], a[12:15], v[200:203]
    s_waitcnt lgkmcnt(3)
    ds_read_b64_tr_b16 v[212:213], v224 offset:20488
    v_cvt_pk_bf16_f32 v194, v204, v205
    v_mfma_f32_16x16x32_bf16 v[28:31], v[220:223], v[160:163], v[28:31]
    v_exp_f32 v206, v206
    v_mfma_f32_16x16x32_bf16 v[60:63], v[220:223], v[164:167], v[60:63]
    ds_read_b64_tr_b16 v[214:215], v224 offset:22536
    v_mfma_f32_16x16x32_bf16 v[92:95], v[220:223], v[168:171], v[92:95]
    v_exp_f32 v207, v207
    v_mfma_f32_16x16x32_bf16 v[124:127], v[220:223], v[172:175], v[124:127]
    ds_read_b64_tr_b16 v[216:217], v225 offset:20480
    v_cvt_pk_bf16_f32 v195, v206, v207
    v_mfma_f32_16x16x32_bf16 v[204:207], a[192:195], a[16:19], 0
    v_exp_f32 v200, v200
    v_mfma_f32_16x16x32_bf16 v[204:207], a[212:215], a[20:23], v[204:207]
    ds_read_b64_tr_b16 v[218:219], v225 offset:22528
    v_mfma_f32_16x16x32_bf16 v[204:207], a[216:219], a[24:27], v[204:207]
    v_exp_f32 v201, v201
    v_mfma_f32_16x16x32_bf16 v[204:207], a[220:223], a[28:31], v[204:207]
    s_waitcnt lgkmcnt(4)
    ds_read_b128 a[228:231], v229 offset:20480
    v_cvt_pk_bf16_f32 v160, v200, v201
    v_mfma_f32_16x16x32_bf16 v[0:3], v[208:211], v[180:183], v[0:3]
    v_exp_f32 v202, v202
    v_mfma_f32_16x16x32_bf16 v[32:35], v[208:211], v[184:187], v[32:35]
    ds_read_b128 a[232:235], v235 offset:20480
    v_mfma_f32_16x16x32_bf16 v[64:67], v[208:211], v[188:191], v[64:67]
    v_exp_f32 v203, v203
    v_mfma_f32_16x16x32_bf16 v[96:99], v[208:211], v[192:195], v[96:99]
    ds_read_b128 a[236:239], v231 offset:20480
    v_cvt_pk_bf16_f32 v161, v202, v203
    v_smfmac_f32_16x16x64_bf16 a[240:243], a[252:255], v[180:187], v233
    ds_read_b64_tr_b16 v[220:221], v225 offset:20488
    v_mfma_f32_16x16x32_bf16 v[200:203], a[192:195], a[32:35], 0
    v_exp_f32 v204, v204
    v_mfma_f32_16x16x32_bf16 v[200:203], a[212:215], a[36:39], v[200:203]
    ds_read_b64_tr_b16 v[222:223], v225 offset:22536
    v_mfma_f32_16x16x32_bf16 v[200:203], a[216:219], a[40:43], v[200:203]
    v_exp_f32 v205, v205
    v_mfma_f32_16x16x32_bf16 v[200:203], a[220:223], a[44:47], v[200:203]
    s_waitcnt lgkmcnt(7)
    v_exp_f32 v206, v206
    v_mfma_f32_16x16x32_bf16 v[4:7], v[212:215], v[180:183], v[4:7]
    v_exp_f32 v207, v207
    v_mfma_f32_16x16x32_bf16 v[36:39], v[212:215], v[184:187], v[36:39]
    v_cvt_pk_bf16_f32 v164, v204, v205
    v_cvt_pk_bf16_f32 v165, v206, v207
    v_mfma_f32_16x16x32_bf16 v[68:71], v[212:215], v[188:191], v[68:71]
    v_mfma_f32_16x16x32_bf16 v[100:103], v[212:215], v[192:195], v[100:103]
    ds_read_b64_tr_b16 v[208:209], v224 offset:53248
    v_mfma_f32_16x16x32_bf16 v[204:207], a[192:195], a[48:51], 0
    v_exp_f32 v200, v200
    v_mfma_f32_16x16x32_bf16 v[204:207], a[212:215], a[52:55], v[204:207]
    ds_read_b64_tr_b16 v[210:211], v224 offset:55296
    v_mfma_f32_16x16x32_bf16 v[204:207], a[216:219], a[56:59], v[204:207]
    v_exp_f32 v201, v201
    v_mfma_f32_16x16x32_bf16 v[204:207], a[220:223], a[60:63], v[204:207]
    s_waitcnt lgkmcnt(7)
    ds_read_b128 a[212:215], v229 offset:24576
    v_cvt_pk_bf16_f32 v168, v200, v201
    v_mfma_f32_16x16x32_bf16 v[8:11], v[216:219], v[180:183], v[8:11]
    v_exp_f32 v202, v202
    v_mfma_f32_16x16x32_bf16 v[40:43], v[216:219], v[184:187], v[40:43]
    ds_read_b128 a[216:219], v235 offset:24576
    v_mfma_f32_16x16x32_bf16 v[72:75], v[216:219], v[188:191], v[72:75]
    v_exp_f32 v203, v203
    v_mfma_f32_16x16x32_bf16 v[104:107], v[216:219], v[192:195], v[104:107]
    ds_read_b64_tr_b16 v[212:213], v224 offset:53256
    v_cvt_pk_bf16_f32 v169, v202, v203
    v_mfma_f32_16x16x32_bf16 v[200:203], a[196:199], a[0:3], 0
    s_waitcnt lgkmcnt(9)
    v_exp_f32 v204, v204
    v_mfma_f32_16x16x32_bf16 v[200:203], a[228:231], a[4:7], v[200:203]
    s_waitcnt lgkmcnt(8)
    ds_read_b64_tr_b16 v[214:215], v224 offset:55304
    v_mfma_f32_16x16x32_bf16 v[200:203], a[232:235], a[8:11], v[200:203]
    s_waitcnt lgkmcnt(8)
    v_exp_f32 v205, v205
    v_mfma_f32_16x16x32_bf16 v[200:203], a[236:239], a[12:15], v[200:203]
    s_waitcnt lgkmcnt(6)
    ds_read_b128 a[220:223], v231 offset:24576
    v_cvt_pk_bf16_f32 v172, v204, v205
    v_mfma_f32_16x16x32_bf16 v[12:15], v[220:223], v[180:183], v[12:15]
    v_exp_f32 v206, v206
    v_mfma_f32_16x16x32_bf16 v[44:47], v[220:223], v[184:187], v[44:47]
    v_exp_f32 v207, v207
    v_mfma_f32_16x16x32_bf16 v[76:79], v[220:223], v[188:191], v[76:79]
    v_cvt_pk_bf16_f32 v173, v206, v207
    v_mfma_f32_16x16x32_bf16 v[108:111], v[220:223], v[192:195], v[108:111]
    ds_read_b64_tr_b16 v[216:217], v225 offset:53248
    v_mfma_f32_16x16x32_bf16 v[204:207], a[196:199], a[16:19], 0
    v_exp_f32 v200, v200
    v_mfma_f32_16x16x32_bf16 v[204:207], a[228:231], a[20:23], v[204:207]
    ds_read_b64_tr_b16 v[218:219], v225 offset:55296
    v_mfma_f32_16x16x32_bf16 v[204:207], a[232:235], a[24:27], v[204:207]
    v_exp_f32 v201, v201
    v_mfma_f32_16x16x32_bf16 v[204:207], a[236:239], a[28:31], v[204:207]
    s_waitcnt lgkmcnt(7)
    v_exp_f32 v202, v202
    v_mfma_f32_16x16x32_bf16 v[16:19], v[208:211], v[180:183], v[16:19]
    v_exp_f32 v203, v203
    v_mfma_f32_16x16x32_bf16 v[48:51], v[208:211], v[184:187], v[48:51]
    v_cvt_pk_bf16_f32 v162, v200, v201
    v_cvt_pk_bf16_f32 v163, v202, v203
    v_mfma_f32_16x16x32_bf16 v[80:83], v[208:211], v[188:191], v[80:83]
    v_mfma_f32_16x16x32_bf16 v[112:115], v[208:211], v[192:195], v[112:115]
    ds_read_b64_tr_b16 v[220:221], v225 offset:53256
    v_smfmac_f32_16x16x64_bf16 a[244:247], a[252:255], v[188:195], v233
    ds_read_b64_tr_b16 v[222:223], v225 offset:55304
    v_mfma_f32_16x16x32_bf16 v[200:203], a[196:199], a[32:35], 0
    v_exp_f32 v204, v204
    v_mfma_f32_16x16x32_bf16 v[200:203], a[228:231], a[36:39], v[200:203]
    v_exp_f32 v205, v205
    v_mfma_f32_16x16x32_bf16 v[200:203], a[232:235], a[40:43], v[200:203]
    v_exp_f32 v206, v206
    v_mfma_f32_16x16x32_bf16 v[200:203], a[236:239], a[44:47], v[200:203]
    s_waitcnt lgkmcnt(5)
    v_exp_f32 v207, v207
    v_mfma_f32_16x16x32_bf16 v[20:23], v[212:215], v[180:183], v[20:23]
    v_cvt_pk_bf16_f32 v166, v204, v205
    v_cvt_pk_bf16_f32 v167, v206, v207
    v_mfma_f32_16x16x32_bf16 v[52:55], v[212:215], v[184:187], v[52:55]
    v_mfma_f32_16x16x32_bf16 v[84:87], v[212:215], v[188:191], v[84:87]
    v_mfma_f32_16x16x32_bf16 v[116:119], v[212:215], v[192:195], v[116:119]
    ds_read_b64_tr_b16 v[208:209], v224 offset:24576
    v_mfma_f32_16x16x32_bf16 v[204:207], a[196:199], a[48:51], 0
    v_exp_f32 v200, v200
    v_mfma_f32_16x16x32_bf16 v[204:207], a[228:231], a[52:55], v[204:207]
    ds_read_b64_tr_b16 v[210:211], v224 offset:26624
    v_mfma_f32_16x16x32_bf16 v[204:207], a[232:235], a[56:59], v[204:207]
    v_exp_f32 v201, v201
    v_mfma_f32_16x16x32_bf16 v[204:207], a[236:239], a[60:63], v[204:207]
    s_waitcnt lgkmcnt(4)
    ds_read_b128 a[228:231], v229 offset:28672
    v_cvt_pk_bf16_f32 v170, v200, v201
    v_mfma_f32_16x16x32_bf16 v[24:27], v[216:219], v[180:183], v[24:27]
    v_exp_f32 v202, v202
    v_mfma_f32_16x16x32_bf16 v[56:59], v[216:219], v[184:187], v[56:59]
    ds_read_b128 a[232:235], v235 offset:28672
    v_mfma_f32_16x16x32_bf16 v[88:91], v[216:219], v[188:191], v[88:91]
L_pad9:
    s_cbranch_vccnz L_pad13
    v_exp_f32 v203, v203
    v_mfma_f32_16x16x32_bf16 v[120:123], v[216:219], v[192:195], v[120:123]
    ds_read_b64_tr_b16 v[212:213], v224 offset:24584
    v_cvt_pk_bf16_f32 v171, v202, v203
    v_mfma_f32_16x16x32_bf16 v[200:203], a[200:203], a[0:3], 0
    v_exp_f32 v204, v204
    v_mfma_f32_16x16x32_bf16 v[200:203], a[212:215], a[4:7], v[200:203]
    ds_read_b64_tr_b16 v[214:215], v224 offset:26632
    v_mfma_f32_16x16x32_bf16 v[200:203], a[216:219], a[8:11], v[200:203]
    v_exp_f32 v205, v205
    v_mfma_f32_16x16x32_bf16 v[200:203], a[220:223], a[12:15], v[200:203]
    s_waitcnt lgkmcnt(6)
    ds_read_b128 a[236:239], v231 offset:28672
    v_cvt_pk_bf16_f32 v174, v204, v205
    v_mfma_f32_16x16x32_bf16 v[28:31], v[220:223], v[180:183], v[28:31]
    v_exp_f32 v206, v206
    v_mfma_f32_16x16x32_bf16 v[60:63], v[220:223], v[184:187], v[60:63]
    v_exp_f32 v207, v207
    v_mfma_f32_16x16x32_bf16 v[92:95], v[220:223], v[188:191], v[92:95]
    v_cvt_pk_bf16_f32 v175, v206, v207
    v_mfma_f32_16x16x32_bf16 v[124:127], v[220:223], v[192:195], v[124:127]
    ds_read_b64_tr_b16 v[216:217], v225 offset:24576
    v_mfma_f32_16x16x32_bf16 v[204:207], a[200:203], a[16:19], 0
    v_exp_f32 v200, v200
    v_mfma_f32_16x16x32_bf16 v[204:207], a[212:215], a[20:23], v[204:207]
    ds_read_b64_tr_b16 v[218:219], v225 offset:26624
    v_mfma_f32_16x16x32_bf16 v[204:207], a[216:219], a[24:27], v[204:207]
    v_exp_f32 v201, v201
    v_mfma_f32_16x16x32_bf16 v[204:207], a[220:223], a[28:31], v[204:207]
    s_waitcnt lgkmcnt(7)
    v_exp_f32 v202, v202
    v_mfma_f32_16x16x32_bf16 v[0:3], v[208:211], v[160:163], v[0:3]
    v_exp_f32 v203, v203
    v_mfma_f32_16x16x32_bf16 v[32:35], v[208:211], v[164:167], v[32:35]
    v_cvt_pk_bf16_f32 v180, v200, v201
    v_cvt_pk_bf16_f32 v181, v202, v203
    v_mfma_f32_16x16x32_bf16 v[64:67], v[208:211], v[168:171], v[64:67]
    v_mfma_f32_16x16x32_bf16 v[96:99], v[208:211], v[172:175], v[96:99]
    ds_read_b64_tr_b16 v[220:221], v225 offset:24584
    v_smfmac_f32_16x16x64_bf16 a[240:243], a[252:255], v[160:167], v233
    ds_read_b64_tr_b16 v[222:223], v225 offset:26632
    v_mfma_f32_16x16x32_bf16 v[200:203], a[200:203], a[32:35], 0
    v_exp_f32 v204, v204
    v_mfma_f32_16x16x32_bf16 v[200:203], a[212:215], a[36:39], v[200:203]
    v_exp_f32 v205, v205
    v_mfma_f32_16x16x32_bf16 v[200:203], a[216:219], a[40:43], v[200:203]
    v_exp_f32 v206, v206
    v_mfma_f32_16x16x32_bf16 v[200:203], a[220:223], a[44:47], v[200:203]
    s_waitcnt lgkmcnt(5)
    v_exp_f32 v207, v207
    v_mfma_f32_16x16x32_bf16 v[4:7], v[212:215], v[160:163], v[4:7]
    v_cvt_pk_bf16_f32 v184, v204, v205
    v_cvt_pk_bf16_f32 v185, v206, v207
    v_mfma_f32_16x16x32_bf16 v[36:39], v[212:215], v[164:167], v[36:39]
    v_mfma_f32_16x16x32_bf16 v[68:71], v[212:215], v[168:171], v[68:71]
    v_mfma_f32_16x16x32_bf16 v[100:103], v[212:215], v[172:175], v[100:103]
    ds_read_b64_tr_b16 v[208:209], v224 offset:57344
    v_mfma_f32_16x16x32_bf16 v[204:207], a[200:203], a[48:51], 0
    v_exp_f32 v200, v200
    v_mfma_f32_16x16x32_bf16 v[204:207], a[212:215], a[52:55], v[204:207]
    ds_read_b64_tr_b16 v[210:211], v224 offset:59392
    v_mfma_f32_16x16x32_bf16 v[204:207], a[216:219], a[56:59], v[204:207]
    v_exp_f32 v201, v201
    v_mfma_f32_16x16x32_bf16 v[204:207], a[220:223], a[60:63], v[204:207]
    s_waitcnt lgkmcnt(4)
    s_barrier
    ds_read_b128 a[212:215], v229 offset:0
    v_cvt_pk_bf16_f32 v188, v200, v201
    v_mfma_f32_16x16x32_bf16 v[8:11], v[216:219], v[160:163], v[8:11]
    v_exp_f32 v202, v202
    v_mfma_f32_16x16x32_bf16 v[40:43], v[216:219], v[164:167], v[40:43]
    ds_write_b64 v228, a[96:97] offset:16384
    v_mfma_f32_16x16x32_bf16 v[72:75], v[216:219], v[168:171], v[72:75]
    v_exp_f32 v203, v203
    v_mfma_f32_16x16x32_bf16 v[104:107], v[216:219], v[172:175], v[104:107]
    ds_read_b64_tr_b16 v[212:213], v224 offset:57352
    v_cvt_pk_bf16_f32 v189, v202, v203
    v_mfma_f32_16x16x32_bf16 v[200:203], a[204:207], a[0:3], 0
    v_exp_f32 v204, v204
    v_mfma_f32_16x16x32_bf16 v[200:203], a[228:231], a[4:7], v[200:203]
    s_waitcnt vmcnt(15)
    ds_read_b64_tr_b16 v[214:215], v224 offset:59400
    v_accvgpr_write_b32 a0, v128
    v_mfma_f32_16x16x32_bf16 v[200:203], a[232:235], a[8:11], v[200:203]
    v_exp_f32 v205, v205
    v_mfma_f32_16x16x32_bf16 v[200:203], a[236:239], a[12:15], v[200:203]
    s_waitcnt lgkmcnt(6)
    ds_read_b128 a[216:219], v235 offset:0
    v_cvt_pk_bf16_f32 v192, v204, v205
    v_mfma_f32_16x16x32_bf16 v[12:15], v[220:223], v[160:163], v[12:15]
    v_exp_f32 v206, v206
    v_mfma_f32_16x16x32_bf16 v[44:47], v[220:223], v[164:167], v[44:47]
    ds_read_b128 a[220:223], v231 offset:0
    v_accvgpr_write_b32 a1, v129
    v_mfma_f32_16x16x32_bf16 v[76:79], v[220:223], v[168:171], v[76:79]
    v_exp_f32 v207, v207
    v_mfma_f32_16x16x32_bf16 v[108:111], v[220:223], v[172:175], v[108:111]
    ds_read_b64_tr_b16 v[216:217], v225 offset:57344
    v_cvt_pk_bf16_f32 v193, v206, v207
    v_mfma_f32_16x16x32_bf16 v[204:207], a[204:207], a[16:19], 0
    v_exp_f32 v200, v200
    v_mfma_f32_16x16x32_bf16 v[204:207], a[228:231], a[20:23], v[204:207]
    ds_read_b64_tr_b16 v[218:219], v225 offset:59392
    v_accvgpr_write_b32 a2, v130
    v_mfma_f32_16x16x32_bf16 v[204:207], a[232:235], a[24:27], v[204:207]
    v_exp_f32 v201, v201
    v_mfma_f32_16x16x32_bf16 v[204:207], a[236:239], a[28:31], v[204:207]
    s_waitcnt lgkmcnt(8)
    v_exp_f32 v202, v202
    v_mfma_f32_16x16x32_bf16 v[16:19], v[208:211], v[160:163], v[16:19]
    v_exp_f32 v203, v203
    v_mfma_f32_16x16x32_bf16 v[48:51], v[208:211], v[164:167], v[48:51]
    v_cvt_pk_bf16_f32 v182, v200, v201
    v_cvt_pk_bf16_f32 v183, v202, v203
    v_mfma_f32_16x16x32_bf16 v[80:83], v[208:211], v[168:171], v[80:83]
    s_waitcnt vmcnt(14)
    v_accvgpr_write_b32 a3, v131
    v_accvgpr_write_b32 a4, v132
    v_mfma_f32_16x16x32_bf16 v[112:115], v[208:211], v[172:175], v[112:115]
    ds_read_b64_tr_b16 v[220:221], v225 offset:57352
    v_accvgpr_write_b32 a5, v133
    v_smfmac_f32_16x16x64_bf16 a[244:247], a[252:255], v[168:175], v233
    ds_read_b64_tr_b16 v[222:223], v225 offset:59400
    v_accvgpr_write_b32 a6, v134
    v_mfma_f32_16x16x32_bf16 v[200:203], a[204:207], a[32:35], 0
    v_exp_f32 v204, v204
    v_mfma_f32_16x16x32_bf16 v[200:203], a[228:231], a[36:39], v[200:203]
    v_exp_f32 v205, v205
    v_mfma_f32_16x16x32_bf16 v[200:203], a[232:235], a[40:43], v[200:203]
    v_exp_f32 v206, v206
    v_mfma_f32_16x16x32_bf16 v[200:203], a[236:239], a[44:47], v[200:203]
    s_waitcnt lgkmcnt(6)
    v_exp_f32 v207, v207
    v_mfma_f32_16x16x32_bf16 v[20:23], v[212:215], v[160:163], v[20:23]
    v_cvt_pk_bf16_f32 v186, v204, v205
    v_cvt_pk_bf16_f32 v187, v206, v207
    v_mfma_f32_16x16x32_bf16 v[52:55], v[212:215], v[164:167], v[52:55]
    s_waitcnt vmcnt(13)
    v_accvgpr_write_b32 a7, v135
    v_accvgpr_write_b32 a8, v136
    v_mfma_f32_16x16x32_bf16 v[84:87], v[212:215], v[168:171], v[84:87]
    v_accvgpr_write_b32 a9, v137
    v_accvgpr_write_b32 a10, v138
    v_mfma_f32_16x16x32_bf16 v[116:119], v[212:215], v[172:175], v[116:119]
    ds_read_b64_tr_b16 v[208:209], v224 offset:28672
    v_accvgpr_write_b32 a11, v139
    v_mfma_f32_16x16x32_bf16 v[204:207], a[204:207], a[48:51], 0
    ds_write_b64 v228, a[98:99] offset:16392
    v_mfma_f32_16x16x32_bf16 v[204:207], a[228:231], a[52:55], v[204:207]
    s_waitcnt vmcnt(12)
    ds_read_b64_tr_b16 v[210:211], v224 offset:30720
    v_accvgpr_write_b32 a12, v140
    v_mfma_f32_16x16x32_bf16 v[204:207], a[232:235], a[56:59], v[204:207]
    v_exp_f32 v200, v200
    v_mfma_f32_16x16x32_bf16 v[204:207], a[236:239], a[60:63], v[204:207]
    s_waitcnt lgkmcnt(5)
    ds_read_b128 a[228:231], v229 offset:4096
    v_accvgpr_write_b32 a13, v141
    v_mfma_f32_16x16x32_bf16 v[24:27], v[216:219], v[160:163], v[24:27]
    v_exp_f32 v201, v201
    v_mfma_f32_16x16x32_bf16 v[56:59], v[216:219], v[164:167], v[56:59]
    ds_read_b128 a[232:235], v235 offset:4096
    v_cvt_pk_bf16_f32 v190, v200, v201
    v_mfma_f32_16x16x32_bf16 v[88:91], v[216:219], v[168:171], v[88:91]
    v_exp_f32 v202, v202
    v_mfma_f32_16x16x32_bf16 v[120:123], v[216:219], v[172:175], v[120:123]
    ds_read_b64_tr_b16 v[212:213], v224 offset:28680
    v_accvgpr_write_b32 a14, v142
    v_exp_f32 v203, v203
    v_accvgpr_write_b32 a15, v143
    v_cvt_pk_bf16_f32 v191, v202, v203
    v_mfma_f32_16x16x32_bf16 v[200:203], a[80:83], a[32:35], 0
    s_sub_u32 s29, s29, 1
    s_cbranch_scc1 L_tail
    v_exp_f32 v204, v204
    v_mfma_f32_16x16x32_bf16 v[200:203], a[212:215], a[36:39], v[200:203]
    s_waitcnt vmcnt(11)
    ds_read_b64_tr_b16 v[214:215], v224 offset:30728
    v_accvgpr_write_b32 a16, v144
    v_mfma_f32_16x16x32_bf16 v[200:203], a[216:219], a[40:43], v[200:203]
    v_exp_f32 v205, v205
    v_mfma_f32_16x16x32_bf16 v[200:203], a[220:223], a[44:47], v[200:203]
    s_waitcnt lgkmcnt(7)
    ds_read_b128 a[236:239], v231 offset:4096
    v_cvt_pk_bf16_f32 v194, v204, v205
    v_mfma_f32_16x16x32_bf16 v[28:31], v[220:223], v[160:163], v[28:31]
    v_exp_f32 v206, v206
    v_mfma_f32_16x16x32_bf16 v[60:63], v[220:223], v[164:167], v[60:63]
    v_exp_f32 v207, v207
    v_mfma_f32_16x16x32_bf16 v[92:95], v[220:223], v[168:171], v[92:95]
    v_cvt_pk_bf16_f32 v195, v206, v207
    v_accvgpr_write_b32 a17, v145
    v_mfma_f32_16x16x32_bf16 v[124:127], v[220:223], v[172:175], v[124:127]
    ds_write_b64 v228, a[100:101] offset:20480
    v_smfmac_f32_16x16x64_bf16 a[240:243], a[252:255], v[180:187], v233
    ds_read_b64_tr_b16 v[216:217], v225 offset:28672
    v_accvgpr_write_b32 a18, v146
    v_mfma_f32_16x16x32_bf16 v[204:207], a[80:83], a[48:51], 0
    v_exp_f32 v200, v200
    v_mfma_f32_16x16x32_bf16 v[204:207], a[212:215], a[52:55], v[204:207]
    ds_read_b64_tr_b16 v[218:219], v225 offset:30720
    v_accvgpr_write_b32 a19, v147
    v_mfma_f32_16x16x32_bf16 v[204:207], a[216:219], a[56:59], v[204:207]
    v_exp_f32 v201, v201
    v_mfma_f32_16x16x32_bf16 v[204:207], a[220:223], a[60:63], v[204:207]
    s_waitcnt lgkmcnt(8)
    v_exp_f32 v202, v202
    v_mfma_f32_16x16x32_bf16 v[0:3], v[208:211], v[180:183], v[0:3]
    v_exp_f32 v203, v203
    v_mfma_f32_16x16x32_bf16 v[32:35], v[208:211], v[184:187], v[32:35]
    v_accvgpr_read_b32 v253, a240
    v_accvgpr_read_b32 v254, a241
    v_mfma_f32_16x16x32_bf16 v[64:67], v[208:211], v[188:191], v[64:67]
    v_add_f32 v253, v253, v254
    v_accvgpr_read_b32 v232, a242
    v_mfma_f32_16x16x32_bf16 v[96:99], v[208:211], v[192:195], v[96:99]
    ds_read_b64_tr_b16 v[220:221], v225 offset:28680
    v_accvgpr_read_b32 v254, a243
    v_cvt_pk_bf16_f32 v168, v200, v201
    v_cvt_pk_bf16_f32 v169, v202, v203
    v_mfma_f32_16x16x32_bf16 v[200:203], a[80:83], a[0:3], 0
    v_rcp_f32 v248, v253
    v_mfma_f32_16x16x32_bf16 v[200:203], a[212:215], a[4:7], v[200:203]
    ds_read_b64_tr_b16 v[222:223], v225 offset:30728
    v_add_f32 v232, v232, v254
    v_mfma_f32_16x16x32_bf16 v[200:203], a[216:219], a[8:11], v[200:203]
    v_rcp_f32 v249, v232
    v_mfma_f32_16x16x32_bf16 v[200:203], a[220:223], a[12:15], v[200:203]
    s_waitcnt vmcnt(10) lgkmcnt(6)
    v_accvgpr_write_b32 a20, v148
    v_accvgpr_write_b32 a21, v149
    v_mfma_f32_16x16x32_bf16 v[4:7], v[212:215], v[180:183], v[4:7]
    v_exp_f32 v204, v204
    v_mfma_f32_16x16x32_bf16 v[36:39], v[212:215], v[184:187], v[36:39]
    v_accvgpr_write_b32 a22, v150
    v_accvgpr_write_b32 a23, v151
    v_mfma_f32_16x16x32_bf16 v[68:71], v[212:215], v[188:191], v[68:71]
    ds_write_b64 v228, a[102:103] offset:20488
    v_mfma_f32_16x16x32_bf16 v[100:103], v[212:215], v[192:195], v[100:103]
    s_waitcnt vmcnt(9)
    ds_read_b64_tr_b16 v[208:209], v224 offset:61440
    v_accvgpr_write_b32 a24, v152
    v_exp_f32 v205, v205
    v_exp_f32 v206, v206
    v_exp_f32 v207, v207
    v_cvt_pk_bf16_f32 v172, v204, v205
    v_cvt_pk_bf16_f32 v173, v206, v207
    v_mfma_f32_16x16x32_bf16 v[204:207], a[80:83], a[16:19], 0
    v_exp_f32 v200, v200
    v_accvgpr_write_b32 a25, v153
    v_accvgpr_write_b32 a26, v154
    v_accvgpr_write_b32 a27, v155
    v_mfma_f32_16x16x32_bf16 v[204:207], a[212:215], a[20:23], v[204:207]
    s_waitcnt vmcnt(8)
    ds_read_b64_tr_b16 v[210:211], v224 offset:63488
    v_accvgpr_write_b32 a28, v156
    v_accvgpr_write_b32 a29, v157
    v_accvgpr_write_b32 a30, v158
    v_accvgpr_write_b32 a31, v159
    v_mfma_f32_16x16x32_bf16 v[204:207], a[216:219], a[24:27], v[204:207]
    v_exp_f32 v201, v201
    v_mfma_f32_16x16x32_bf16 v[204:207], a[220:223], a[28:31], v[204:207]
    s_waitcnt lgkmcnt(5)
    ds_read_b128 a[212:215], v229 offset:8192
    v_cvt_pk_bf16_f32 v160, v200, v201
    v_mfma_f32_16x16x32_bf16 v[8:11], v[216:219], v[180:183], v[8:11]
    v_exp_f32 v202, v202
    v_mfma_f32_16x16x32_bf16 v[40:43], v[216:219], v[184:187], v[40:43]
    ds_read_b128 a[216:219], v235 offset:8192
    v_mul_f32 v0, v0, v248
    v_mfma_f32_16x16x32_bf16 v[72:75], v[216:219], v[188:191], v[72:75]
    v_exp_f32 v203, v203
    v_mfma_f32_16x16x32_bf16 v[104:107], v[216:219], v[192:195], v[104:107]
    ds_read_b64_tr_b16 v[212:213], v224 offset:61448
    v_cvt_pk_bf16_f32 v161, v202, v203
    v_mfma_f32_16x16x32_bf16 v[200:203], a[84:87], a[32:35], 0
    v_exp_f32 v204, v204
    v_mfma_f32_16x16x32_bf16 v[200:203], a[228:231], a[36:39], v[200:203]
    ds_read_b64_tr_b16 v[214:215], v224 offset:63496
    v_xor_b32 v224, 0x10000, v224
    v_mfma_f32_16x16x32_bf16 v[200:203], a[232:235], a[40:43], v[200:203]
    v_exp_f32 v205, v205
    v_mfma_f32_16x16x32_bf16 v[200:203], a[236:239], a[44:47], v[200:203]
    s_waitcnt lgkmcnt(7)
    ds_read_b128 a[220:223], v231 offset:8192
    v_cvt_pk_bf16_f32 v164, v204, v205
    v_mfma_f32_16x16x32_bf16 v[12:15], v[220:223], v[180:183], v[12:15]
    v_exp_f32 v206, v206
    v_mfma_f32_16x16x32_bf16 v[44:47], v[220:223], v[184:187], v[44:47]
    v_exp_f32 v207, v207
    v_mfma_f32_16x16x32_bf16 v[76:79], v[220:223], v[188:191], v[76:79]
    ds_write_b64 v228, a[104:105] offset:24576
    v_mfma_f32_16x16x32_bf16 v[108:111], v[220:223], v[192:195], v[108:111]
    ds_read_b64_tr_b16 v[216:217], v225 offset:61440
    v_cvt_pk_bf16_f32 v165, v206, v207
    v_mfma_f32_16x16x32_bf16 v[204:207], a[84:87], a[48:51], 0
    v_exp_f32 v200, v200
    v_mfma_f32_16x16x32_bf16 v[204:207], a[228:231], a[52:55], v[204:207]
    ds_read_b64_tr_b16 v[218:219], v225 offset:63488
    v_mul_f32 v1, v1, v248
    v_mfma_f32_16x16x32_bf16 v[204:207], a[232:235], a[56:59], v[204:207]
    v_exp_f32 v201, v201
    v_mfma_f32_16x16x32_bf16 v[204:207], a[236:239], a[60:63], v[204:207]
    s_waitcnt lgkmcnt(8)
    v_exp_f32 v202, v202
    v_mfma_f32_16x16x32_bf16 v[16:19], v[208:211], v[180:183], v[16:19]
    v_exp_f32 v203, v203
    v_mfma_f32_16x16x32_bf16 v[48:51], v[208:211], v[184:187], v[48:51]
    v_cvt_pk_bf16_f32 v170, v200, v201
    v_cvt_pk_bf16_f32 v171, v202, v203
    v_mfma_f32_16x16x32_bf16 v[80:83], v[208:211], v[188:191], v[80:83]
    v_mul_f32 v2, v2, v248
    v_mul_f32 v3, v3, v248
    v_mfma_f32_16x16x32_bf16 v[112:115], v[208:211], v[192:195], v[112:115]
    ds_read_b64_tr_b16 v[220:221], v225 offset:61448
    v_cvt_pk_bf16_f32 v128, v0, v1
    v_smfmac_f32_16x16x64_bf16 a[244:247], a[252:255], v[188:195], v233
    ds_read_b64_tr_b16 v[222:223], v225 offset:63496
    v_xor_b32 v225, 0x10000, v225
    v_mfma_f32_16x16x32_bf16 v[200:203], a[84:87], a[0:3], 0
    v_exp_f32 v204, v204
    v_mfma_f32_16x16x32_bf16 v[200:203], a[228:231], a[4:7], v[200:203]
    v_exp_f32 v205, v205
    v_mfma_f32_16x16x32_bf16 v[200:203], a[232:235], a[8:11], v[200:203]
    v_exp_f32 v206, v206
    v_mfma_f32_16x16x32_bf16 v[200:203], a[236:239], a[12:15], v[200:203]
    s_waitcnt lgkmcnt(6)
    v_exp_f32 v207, v207
    v_mfma_f32_16x16x32_bf16 v[20:23], v[212:215], v[180:183], v[20:23]
    ds_write_b64 v228, a[106:107] offset:24584
    v_mfma_f32_16x16x32_bf16 v[52:55], v[212:215], v[184:187], v[52:55]
    v_cvt_pk_bf16_f32 v174, v204, v205
    v_cvt_pk_bf16_f32 v175, v206, v207
    v_mfma_f32_16x16x32_bf16 v[84:87], v[212:215], v[188:191], v[84:87]
    v_cvt_pk_bf16_f32 v129, v2, v3
    v_mul_f32 v32, v32, v249
    v_mfma_f32_16x16x32_bf16 v[116:119], v[212:215], v[192:195], v[116:119]
    ds_read_b64_tr_b16 v[208:209], v224 offset:0
    v_mul_f32 v33, v33, v249
    v_mfma_f32_16x16x32_bf16 v[204:207], a[84:87], a[16:19], 0
    v_exp_f32 v200, v200
    v_mfma_f32_16x16x32_bf16 v[204:207], a[228:231], a[20:23], v[204:207]
    ds_read_b64_tr_b16 v[210:211], v224 offset:2048
    v_mul_f32 v34, v34, v249
    v_mfma_f32_16x16x32_bf16 v[204:207], a[232:235], a[24:27], v[204:207]
    v_exp_f32 v201, v201
    v_mfma_f32_16x16x32_bf16 v[204:207], a[236:239], a[28:31], v[204:207]
    s_waitcnt lgkmcnt(5)
    ds_read_b128 a[228:231], v229 offset:12288
    v_cvt_pk_bf16_f32 v162, v200, v201
    v_mfma_f32_16x16x32_bf16 v[24:27], v[216:219], v[180:183], v[24:27]
    v_exp_f32 v202, v202
    v_mfma_f32_16x16x32_bf16 v[56:59], v[216:219], v[184:187], v[56:59]
    ds_read_b128 a[232:235], v235 offset:12288
    v_mul_f32 v35, v35, v249
    v_mfma_f32_16x16x32_bf16 v[88:91], v[216:219], v[188:191], v[88:91]
    v_exp_f32 v203, v203
    v_mfma_f32_16x16x32_bf16 v[120:123], v[216:219], v[192:195], v[120:123]
    ds_read_b64_tr_b16 v[212:213], v224 offset:8
    v_cvt_pk_bf16_f32 v163, v202, v203
    v_mfma_f32_16x16x32_bf16 v[200:203], a[88:91], a[0:3], 0
    v_exp_f32 v204, v204
    v_mfma_f32_16x16x32_bf16 v[200:203], a[212:215], a[4:7], v[200:203]
    ds_read_b64_tr_b16 v[214:215], v224 offset:2056
    v_cvt_pk_bf16_f32 v132, v32, v33
    v_mfma_f32_16x16x32_bf16 v[200:203], a[216:219], a[8:11], v[200:203]
    v_exp_f32 v205, v205
    v_mfma_f32_16x16x32_bf16 v[200:203], a[220:223], a[12:15], v[200:203]
    s_waitcnt lgkmcnt(7)
    ds_read_b128 a[236:239], v231 offset:12288
    v_cvt_pk_bf16_f32 v166, v204, v205
    v_mfma_f32_16x16x32_bf16 v[28:31], v[220:223], v[180:183], v[28:31]
    ds_write_b64 v228, a[108:109] offset:28672
    v_mfma_f32_16x16x32_bf16 v[60:63], v[220:223], v[184:187], v[60:63]
    v_exp_f32 v206, v206
    v_mfma_f32_16x16x32_bf16 v[92:95], v[220:223], v[188:191], v[92:95]
    v_exp_f32 v207, v207
    v_mfma_f32_16x16x32_bf16 v[124:127], v[220:223], v[192:195], v[124:127]
    ds_read_b64_tr_b16 v[216:217], v225 offset:0
    v_cvt_pk_bf16_f32 v167, v206, v207
    v_mfma_f32_16x16x32_bf16 v[204:207], a[88:91], a[16:19], 0
    v_exp_f32 v200, v200
    v_mfma_f32_16x16x32_bf16 v[204:207], a[212:215], a[20:23], v[204:207]
    ds_read_b64_tr_b16 v[218:219], v225 offset:2048
    v_cvt_pk_bf16_f32 v133, v34, v35
    v_mfma_f32_16x16x32_bf16 v[204:207], a[216:219], a[24:27], v[204:207]
    v_exp_f32 v201, v201
    v_mfma_f32_16x16x32_bf16 v[204:207], a[220:223], a[28:31], v[204:207]
    s_waitcnt lgkmcnt(8)
    v_exp_f32 v202, v202
    v_mfma_f32_16x16x32_bf16 v[64:67], v[208:211], v[168:171], v[64:67]
    v_exp_f32 v203, v203
    v_mfma_f32_16x16x32_bf16 v[96:99], v[208:211], v[172:175], v[96:99]
    v_cvt_pk_bf16_f32 v180, v200, v201
    v_cvt_pk_bf16_f32 v181, v202, v203
    v_mfma_f32_16x16x32_bf16 v[0:3], v[208:211], v[160:163], 0
    v_mul_f32 v4, v4, v248
    v_mul_f32 v5, v5, v248
    v_mfma_f32_16x16x32_bf16 v[32:35], v[208:211], v[164:167], 0
    ds_read_b64_tr_b16 v[220:221], v225 offset:8
    v_mul_f32 v6, v6, v248
    v_smfmac_f32_16x16x64_bf16 a[244:247], a[252:255], v[168:175], v233
    ds_read_b64_tr_b16 v[222:223], v225 offset:2056
    v_mul_f32 v7, v7, v248
    v_mfma_f32_16x16x32_bf16 v[200:203], a[88:91], a[32:35], 0
    v_exp_f32 v204, v204
    v_cvt_pk_bf16_f32 v130, v4, v5
    v_cvt_pk_bf16_f32 v131, v6, v7
    buffer_store_dwordx4 v[128:131], v230, s[20:23], s30 offen offset:0
    v_mfma_f32_16x16x32_bf16 v[200:203], a[212:215], a[36:39], v[200:203]
    v_mul_f32 v36, v36, v249
    v_mul_f32 v37, v37, v249
    v_mfma_f32_16x16x32_bf16 v[200:203], a[216:219], a[40:43], v[200:203]
    v_exp_f32 v205, v205
    v_mfma_f32_16x16x32_bf16 v[200:203], a[220:223], a[44:47], v[200:203]
    s_waitcnt lgkmcnt(6)
    ds_write_b64 v228, a[110:111] offset:28680
    v_mfma_f32_16x16x32_bf16 v[68:71], v[212:215], v[168:171], v[68:71]
    v_exp_f32 v206, v206
    v_mfma_f32_16x16x32_bf16 v[100:103], v[212:215], v[172:175], v[100:103]
    v_mul_f32 v38, v38, v249
    v_mul_f32 v39, v39, v249
    v_mfma_f32_16x16x32_bf16 v[4:7], v[212:215], v[160:163], 0
    v_exp_f32 v207, v207
    v_cvt_pk_bf16_f32 v134, v36, v37
    v_cvt_pk_bf16_f32 v135, v38, v39
    v_mfma_f32_16x16x32_bf16 v[36:39], v[212:215], v[164:167], 0
    ds_read_b64_tr_b16 v[208:209], v224 offset:32768
    v_cvt_pk_bf16_f32 v184, v204, v205
    v_cvt_pk_bf16_f32 v185, v206, v207
    v_mfma_f32_16x16x32_bf16 v[204:207], a[88:91], a[48:51], 0
    v_exp_f32 v200, v200
    v_mfma_f32_16x16x32_bf16 v[204:207], a[212:215], a[52:55], v[204:207]
    ds_read_b64_tr_b16 v[210:211], v224 offset:34816
    v_mul_f32 v8, v8, v248
    v_mfma_f32_16x16x32_bf16 v[204:207], a[216:219], a[56:59], v[204:207]
    v_exp_f32 v201, v201
    v_mfma_f32_16x16x32_bf16 v[204:207], a[220:223], a[60:63], v[204:207]
    s_waitcnt lgkmcnt(2)
    s_barrier
    ds_read_b128 a[212:215], v229 offset:16384
    v_mul_f32 v9, v9, v248
    v_mfma_f32_16x16x32_bf16 v[72:75], v[216:219], v[168:171], v[72:75]
    v_exp_f32 v202, v202
    v_mfma_f32_16x16x32_bf16 v[104:107], v[216:219], v[172:175], v[104:107]
    ds_read_b128 a[216:219], v235 offset:16384
    v_mul_f32 v10, v10, v248
    v_mul_f32 v11, v11, v248
    v_cvt_pk_bf16_f32 v136, v8, v9
    v_cvt_pk_bf16_f32 v137, v10, v11
    v_mfma_f32_16x16x32_bf16 v[8:11], v[216:219], v[160:163], 0
    v_exp_f32 v203, v203
    v_mul_f32 v40, v40, v249
    v_mul_f32 v41, v41, v249
    v_mul_f32 v42, v42, v249
    v_mul_f32 v43, v43, v249
    v_cvt_pk_bf16_f32 v140, v40, v41
    v_cvt_pk_bf16_f32 v141, v42, v43
    v_mfma_f32_16x16x32_bf16 v[40:43], v[216:219], v[164:167], 0
    buffer_store_dwordx4 v[132:135], v230, s[20:23], s31 offen offset:0
    v_cvt_pk_bf16_f32 v188, v200, v201
    v_cvt_pk_bf16_f32 v189, v202, v203
    v_mfma_f32_16x16x32_bf16 v[200:203], a[92:95], a[0:3], 0
    v_exp_f32 v204, v204
    v_mfma_f32_16x16x32_bf16 v[200:203], a[228:231], a[4:7], v[200:203]
    ds_read_b64_tr_b16 v[212:213], v224 offset:32776
    v_mul_f32 v12, v12, v248
    v_mfma_f32_16x16x32_bf16 v[200:203], a[232:235], a[8:11], v[200:203]
    v_exp_f32 v205, v205
    v_mfma_f32_16x16x32_bf16 v[200:203], a[236:239], a[12:15], v[200:203]
    ds_read_b64_tr_b16 v[214:215], v224 offset:34824
    v_mul_f32 v13, v13, v248
    v_mfma_f32_16x16x32_bf16 v[76:79], v[220:223], v[168:171], v[76:79]
    v_exp_f32 v206, v206
    v_mfma_f32_16x16x32_bf16 v[108:111], v[220:223], v[172:175], v[108:111]
    ds_read_b128 a[220:223], v231 offset:16384
    v_mul_f32 v14, v14, v248
    v_mul_f32 v15, v15, v248
    v_cvt_pk_bf16_f32 v138, v12, v13
    v_cvt_pk_bf16_f32 v139, v14, v15
    v_mfma_f32_16x16x32_bf16 v[12:15], v[220:223], v[160:163], 0
    v_exp_f32 v207, v207
    v_mul_f32 v44, v44, v249
    v_mul_f32 v45, v45, v249
    v_mul_f32 v46, v46, v249
    v_mul_f32 v47, v47, v249
    v_cvt_pk_bf16_f32 v142, v44, v45
    v_cvt_pk_bf16_f32 v143, v46, v47
    v_mfma_f32_16x16x32_bf16 v[44:47], v[220:223], v[164:167], 0
    ds_read_b64_tr_b16 v[216:217], v225 offset:32768
    v_cvt_pk_bf16_f32 v192, v204, v205
    v_cvt_pk_bf16_f32 v193, v206, v207
    v_mfma_f32_16x16x32_bf16 v[204:207], a[92:95], a[16:19], 0
    v_exp_f32 v200, v200
    v_mfma_f32_16x16x32_bf16 v[204:207], a[228:231], a[20:23], v[204:207]
    ds_write_b64 v228, a[112:113] offset:0
    v_mfma_f32_16x16x32_bf16 v[204:207], a[232:235], a[24:27], v[204:207]
    v_exp_f32 v201, v201
    v_mfma_f32_16x16x32_bf16 v[204:207], a[236:239], a[28:31], v[204:207]
    s_waitcnt lgkmcnt(7)
    buffer_store_dwordx4 v[136:139], v230, s[20:23], s30 offen offset:64
    v_mfma_f32_16x16x32_bf16 v[80:83], v[208:211], v[168:171], v[80:83]
    v_exp_f32 v202, v202
    v_mfma_f32_16x16x32_bf16 v[112:115], v[208:211], v[172:175], v[112:115]
    ds_read_b64_tr_b16 v[218:219], v225 offset:34816
    v_mul_f32 v16, v16, v248
    v_mul_f32 v17, v17, v248
    v_mul_f32 v18, v18, v248
    v_mul_f32 v19, v19, v248
    v_cvt_pk_bf16_f32 v144, v16, v17
    v_cvt_pk_bf16_f32 v145, v18, v19
    v_mfma_f32_16x16x32_bf16 v[16:19], v[208:211], v[160:163], 0
    v_exp_f32 v203, v203
    v_accvgpr_write_b32 a240, 0
    v_accvgpr_write_b32 a241, 0
    v_accvgpr_write_b32 a242, 0
    v_accvgpr_write_b32 a243, 0
    v_mul_f32 v48, v48, v249
    v_mul_f32 v49, v49, v249
    v_mul_f32 v50, v50, v249
    v_mul_f32 v51, v51, v249
    v_cvt_pk_bf16_f32 v148, v48, v49
    v_cvt_pk_bf16_f32 v149, v50, v51
    v_mfma_f32_16x16x32_bf16 v[48:51], v[208:211], v[164:167], 0
    ds_read_b64_tr_b16 v[220:221], v225 offset:32776
    v_cvt_pk_bf16_f32 v182, v200, v201
    v_smfmac_f32_16x16x64_bf16 a[240:243], a[252:255], v[160:167], v233
    ds_read_b64_tr_b16 v[222:223], v225 offset:34824
    v_cvt_pk_bf16_f32 v183, v202, v203
    v_mfma_f32_16x16x32_bf16 v[200:203], a[92:95], a[32:35], 0
    v_exp_f32 v204, v204
    v_mfma_f32_16x16x32_bf16 v[200:203], a[228:231], a[36:39], v[200:203]
    v_mul_f32 v20, v20, v248
    v_mul_f32 v21, v21, v248
    v_mfma_f32_16x16x32_bf16 v[200:203], a[232:235], a[40:43], v[200:203]
    v_exp_f32 v205, v205
    v_mfma_f32_16x16x32_bf16 v[200:203], a[236:239], a[44:47], v[200:203]
    s_waitcnt lgkmcnt(6)
    v_mul_f32 v22, v22, v248
    v_mul_f32 v23, v23, v248
    v_mfma_f32_16x16x32_bf16 v[84:87], v[212:215], v[168:171], v[84:87]
    v_exp_f32 v206, v206
    v_mfma_f32_16x16x32_bf16 v[116:119], v[212:215], v[172:175], v[116:119]
    v_cvt_pk_bf16_f32 v146, v20, v21
    v_cvt_pk_bf16_f32 v147, v22, v23
    v_mfma_f32_16x16x32_bf16 v[20:23], v[212:215], v[160:163], 0
    v_exp_f32 v207, v207
    v_mul_f32 v52, v52, v249
    v_mul_f32 v53, v53, v249
    v_mul_f32 v54, v54, v249
    v_mul_f32 v55, v55, v249
    v_cvt_pk_bf16_f32 v150, v52, v53
    v_cvt_pk_bf16_f32 v151, v54, v55
    v_mfma_f32_16x16x32_bf16 v[52:55], v[212:215], v[164:167], 0
    buffer_store_dwordx4 v[140:143], v230, s[20:23], s31 offen offset:64
    v_cvt_pk_bf16_f32 v186, v204, v205
    v_cvt_pk_bf16_f32 v187, v206, v207
    v_mfma_f32_16x16x32_bf16 v[204:207], a[92:95], a[48:51], 0
    ds_write_b64 v228, a[114:115] offset:8
    v_mfma_f32_16x16x32_bf16 v[204:207], a[228:231], a[52:55], v[204:207]
    ds_read_b64_tr_b16 v[208:209], v224 offset:4096
    v_mul_f32 v24, v24, v248
    v_mfma_f32_16x16x32_bf16 v[204:207], a[232:235], a[56:59], v[204:207]
    v_exp_f32 v200, v200
    v_mfma_f32_16x16x32_bf16 v[204:207], a[236:239], a[60:63], v[204:207]
    s_waitcnt lgkmcnt(4)
    ds_read_b64_tr_b16 v[210:211], v224 offset:6144
    v_mul_f32 v25, v25, v248
    v_mfma_f32_16x16x32_bf16 v[88:91], v[216:219], v[168:171], v[88:91]
    v_exp_f32 v201, v201
    v_mfma_f32_16x16x32_bf16 v[120:123], v[216:219], v[172:175], v[120:123]
    ds_read_b128 a[228:231], v229 offset:20480
    v_mul_f32 v26, v26, v248
    v_mul_f32 v27, v27, v248
    v_cvt_pk_bf16_f32 v152, v24, v25
    v_cvt_pk_bf16_f32 v153, v26, v27
    v_mfma_f32_16x16x32_bf16 v[24:27], v[216:219], v[160:163], 0
    v_exp_f32 v202, v202
    v_mul_f32 v56, v56, v249
    v_mul_f32 v57, v57, v249
    v_mul_f32 v58, v58, v249
    v_mul_f32 v59, v59, v249
    v_cvt_pk_bf16_f32 v156, v56, v57
    v_cvt_pk_bf16_f32 v157, v58, v59
    v_mfma_f32_16x16x32_bf16 v[56:59], v[216:219], v[164:167], 0
    ds_read_b64_tr_b16 v[212:213], v224 offset:4104
    v_cvt_pk_bf16_f32 v190, v200, v201
    v_exp_f32 v203, v203
    v_mul_f32 v28, v28, v248
    v_cvt_pk_bf16_f32 v191, v202, v203
    v_mfma_f32_16x16x32_bf16 v[200:203], a[96:99], a[32:35], 0
    v_exp_f32 v204, v204
    v_mfma_f32_16x16x32_bf16 v[200:203], a[212:215], a[36:39], v[200:203]
    ds_read_b64_tr_b16 v[214:215], v224 offset:6152
    v_mul_f32 v29, v29, v248
    v_mfma_f32_16x16x32_bf16 v[200:203], a[216:219], a[40:43], v[200:203]
    v_exp_f32 v205, v205
    v_mfma_f32_16x16x32_bf16 v[200:203], a[220:223], a[44:47], v[200:203]
    s_waitcnt lgkmcnt(6)
    ds_read_b128 a[232:235], v235 offset:20480
    v_mul_f32 v30, v30, v248
    v_mfma_f32_16x16x32_bf16 v[92:95], v[220:223], v[168:171], v[92:95]
    v_exp_f32 v206, v206
    v_mfma_f32_16x16x32_bf16 v[124:127], v[220:223], v[172:175], v[124:127]
    ds_read_b128 a[236:239], v231 offset:20480
    v_mul_f32 v31, v31, v248
    v_cvt_pk_bf16_f32 v154, v28, v29
    v_cvt_pk_bf16_f32 v155, v30, v31
    v_mfma_f32_16x16x32_bf16 v[28:31], v[220:223], v[160:163], 0
    v_exp_f32 v207, v207
    v_mul_f32 v60, v60, v249
    v_mul_f32 v61, v61, v249
    v_mul_f32 v62, v62, v249
    v_mul_f32 v63, v63, v249
    v_cvt_pk_bf16_f32 v158, v60, v61
    v_cvt_pk_bf16_f32 v159, v62, v63
    v_mfma_f32_16x16x32_bf16 v[60:63], v[220:223], v[164:167], 0
L_pad10:
    s_cbranch_vccnz L_back
    buffer_store_dwordx4 v[144:147], v230, s[20:23], s30 offen offset:128
    v_cvt_pk_bf16_f32 v194, v204, v205
    v_cvt_pk_bf16_f32 v195, v206, v207
    v_mfma_f32_16x16x32_bf16 v[204:207], a[96:99], a[48:51], 0
    ds_write_b64 v228, a[116:117] offset:4096
    v_mfma_f32_16x16x32_bf16 v[204:207], a[212:215], a[52:55], v[204:207]
    ds_read_b64_tr_b16 v[216:217], v225 offset:4096
    v_max3_u32 v226, v226, v253, v232
    v_mfma_f32_16x16x32_bf16 v[204:207], a[216:219], a[56:59], v[204:207]
    v_exp_f32 v200, v200
    v_mfma_f32_16x16x32_bf16 v[204:207], a[220:223], a[60:63], v[204:207]
    s_waitcnt lgkmcnt(7)
    ds_read_b64_tr_b16 v[218:219], v225 offset:6144
    v_min3_u32 v227, v227, v253, v232
    v_mfma_f32_16x16x32_bf16 v[0:3], v[208:211], v[180:183], v[0:3]
    v_exp_f32 v201, v201
    v_mfma_f32_16x16x32_bf16 v[32:35], v[208:211], v[184:187], v[32:35]
    v_exp_f32 v202, v202
    v_mfma_f32_16x16x32_bf16 v[64:67], v[208:211], v[188:191], v[64:67]
    v_exp_f32 v203, v203
    v_mfma_f32_16x16x32_bf16 v[96:99], v[208:211], v[192:195], v[96:99]
    ds_read_b64_tr_b16 v[220:221], v225 offset:4104
    v_cvt_pk_bf16_f32 v168, v200, v201
    v_smfmac_f32_16x16x64_bf16 a[240:243], a[252:255], v[180:187], v233
    ds_read_b64_tr_b16 v[222:223], v225 offset:6152
    v_cvt_pk_bf16_f32 v169, v202, v203
    v_mfma_f32_16x16x32_bf16 v[200:203], a[96:99], a[0:3], 0
    v_exp_f32 v204, v204
    v_mfma_f32_16x16x32_bf16 v[200:203], a[212:215], a[4:7], v[200:203]
    ds_write_b64 v228, a[118:119] offset:4104
    v_mfma_f32_16x16x32_bf16 v[200:203], a[216:219], a[8:11], v[200:203]
    v_exp_f32 v205, v205
    v_mfma_f32_16x16x32_bf16 v[200:203], a[220:223], a[12:15], v[200:203]
    s_waitcnt lgkmcnt(8)
    v_exp_f32 v206, v206
    v_mfma_f32_16x16x32_bf16 v[4:7], v[212:215], v[180:183], v[4:7]
    v_exp_f32 v207, v207
    v_mfma_f32_16x16x32_bf16 v[36:39], v[212:215], v[184:187], v[36:39]
    buffer_store_dwordx4 v[148:151], v230, s[20:23], s31 offen offset:128
    v_mfma_f32_16x16x32_bf16 v[68:71], v[212:215], v[188:191], v[68:71]
    v_cvt_pk_bf16_f32 v172, v204, v205
    v_cvt_pk_bf16_f32 v173, v206, v207
    v_mfma_f32_16x16x32_bf16 v[100:103], v[212:215], v[192:195], v[100:103]
    ds_write_b64 v228, a[120:121] offset:8192
    v_mfma_f32_16x16x32_bf16 v[204:207], a[96:99], a[16:19], 0
    v_exp_f32 v200, v200
    v_mfma_f32_16x16x32_bf16 v[204:207], a[212:215], a[20:23], v[204:207]
    ds_write_b64 v228, a[122:123] offset:8200
    v_mfma_f32_16x16x32_bf16 v[204:207], a[216:219], a[24:27], v[204:207]
    v_exp_f32 v201, v201
    v_mfma_f32_16x16x32_bf16 v[204:207], a[220:223], a[28:31], v[204:207]
    s_waitcnt lgkmcnt(5)
    ds_read_b64_tr_b16 v[208:209], v224 offset:36864
    v_cvt_pk_bf16_f32 v160, v200, v201
    v_mfma_f32_16x16x32_bf16 v[8:11], v[216:219], v[180:183], v[8:11]
    v_exp_f32 v202, v202
    v_mfma_f32_16x16x32_bf16 v[40:43], v[216:219], v[184:187], v[40:43]
    ds_write_b64 v228, a[124:125] offset:12288
    v_mfma_f32_16x16x32_bf16 v[72:75], v[216:219], v[188:191], v[72:75]
    v_exp_f32 v203, v203
    v_mfma_f32_16x16x32_bf16 v[104:107], v[216:219], v[192:195], v[104:107]
    ds_read_b64_tr_b16 v[210:211], v224 offset:38912
    v_cvt_pk_bf16_f32 v161, v202, v203
    v_mfma_f32_16x16x32_bf16 v[200:203], a[100:103], a[32:35], 0
    v_exp_f32 v204, v204
    v_mfma_f32_16x16x32_bf16 v[200:203], a[228:231], a[36:39], v[200:203]
    s_waitcnt vmcnt(13)
    ds_read_b64_tr_b16 v[212:213], v224 offset:36872
    v_accvgpr_write_b32 a32, v176
    v_mfma_f32_16x16x32_bf16 v[200:203], a[232:235], a[40:43], v[200:203]
    v_exp_f32 v205, v205
    v_mfma_f32_16x16x32_bf16 v[200:203], a[236:239], a[44:47], v[200:203]
    s_waitcnt lgkmcnt(7)
    ds_read_b64_tr_b16 v[214:215], v224 offset:38920
    v_cvt_pk_bf16_f32 v164, v204, v205
    v_mfma_f32_16x16x32_bf16 v[12:15], v[220:223], v[180:183], v[12:15]
    v_exp_f32 v206, v206
    v_mfma_f32_16x16x32_bf16 v[44:47], v[220:223], v[184:187], v[44:47]
    buffer_store_dwordx4 v[152:155], v230, s[20:23], s30 offen offset:192
    v_mfma_f32_16x16x32_bf16 v[76:79], v[220:223], v[188:191], v[76:79]
    v_exp_f32 v207, v207
    v_mfma_f32_16x16x32_bf16 v[108:111], v[220:223], v[192:195], v[108:111]
    ds_read_b64_tr_b16 v[216:217], v225 offset:36864
    v_cvt_pk_bf16_f32 v165, v206, v207
    v_mfma_f32_16x16x32_bf16 v[204:207], a[100:103], a[48:51], 0
    v_exp_f32 v200, v200
    v_mfma_f32_16x16x32_bf16 v[204:207], a[228:231], a[52:55], v[204:207]
    ds_read_b64_tr_b16 v[218:219], v225 offset:38912
    v_accvgpr_write_b32 a33, v177
    v_mfma_f32_16x16x32_bf16 v[204:207], a[232:235], a[56:59], v[204:207]
    v_exp_f32 v201, v201
    v_mfma_f32_16x16x32_bf16 v[204:207], a[236:239], a[60:63], v[204:207]
    s_waitcnt lgkmcnt(4)
    ds_read_b128 a[212:215], v229 offset:24576
    v_cvt_pk_bf16_f32 v170, v200, v201
    v_mfma_f32_16x16x32_bf16 v[16:19], v[208:211], v[180:183], v[16:19]
    v_exp_f32 v202, v202
    v_mfma_f32_16x16x32_bf16 v[48:51], v[208:211], v[184:187], v[48:51]
    ds_read_b128 a[216:219], v235 offset:24576
    v_accvgpr_write_b32 a34, v178
    v_mfma_f32_16x16x32_bf16 v[80:83], v[208:211], v[188:191], v[80:83]
    v_exp_f32 v203, v203
    v_mfma_f32_16x16x32_bf16 v[112:115], v[208:211], v[192:195], v[112:115]
    ds_read_b128 a[220:223], v231 offset:24576
    v_cvt_pk_bf16_f32 v171, v202, v203
    v_smfmac_f32_16x16x64_bf16 a[244:247], a[252:255], v[188:195], v233
    ds_read_b64_tr_b16 v[220:221], v225 offset:36872
    v_accvgpr_write_b32 a35, v179
    v_mfma_f32_16x16x32_bf16 v[200:203], a[100:103], a[0:3], 0
    v_exp_f32 v204, v204
    v_mfma_f32_16x16x32_bf16 v[200:203], a[228:231], a[4:7], v[200:203]
    s_waitcnt vmcnt(13)
    ds_read_b64_tr_b16 v[222:223], v225 offset:38920
    v_accvgpr_write_b32 a36, v196
    v_mfma_f32_16x16x32_bf16 v[200:203], a[232:235], a[8:11], v[200:203]
    v_exp_f32 v205, v205
    v_mfma_f32_16x16x32_bf16 v[200:203], a[236:239], a[12:15], v[200:203]
    s_waitcnt lgkmcnt(7)
    v_exp_f32 v206, v206
    v_mfma_f32_16x16x32_bf16 v[20:23], v[212:215], v[180:183], v[20:23]
    v_exp_f32 v207, v207
    v_mfma_f32_16x16x32_bf16 v[52:55], v[212:215], v[184:187], v[52:55]
    buffer_store_dwordx4 v[156:159], v230, s[20:23], s31 offen offset:192
    v_mfma_f32_16x16x32_bf16 v[84:87], v[212:215], v[188:191], v[84:87]
    v_cvt_pk_bf16_f32 v174, v204, v205
    v_cvt_pk_bf16_f32 v175, v206, v207
    v_mfma_f32_16x16x32_bf16 v[116:119], v[212:215], v[192:195], v[116:119]
    ds_read_b64_tr_b16 v[208:209], v224 offset:8192
    v_accvgpr_write_b32 a37, v197
    v_mfma_f32_16x16x32_bf16 v[204:207], a[100:103], a[16:19], 0
    v_exp_f32 v200, v200
    v_mfma_f32_16x16x32_bf16 v[204:207], a[228:231], a[20:23], v[204:207]
    ds_read_b64_tr_b16 v[210:211], v224 offset:10240
    v_accvgpr_write_b32 a38, v198
    v_mfma_f32_16x16x32_bf16 v[204:207], a[232:235], a[24:27], v[204:207]
    v_exp_f32 v201, v201
    v_mfma_f32_16x16x32_bf16 v[204:207], a[236:239], a[28:31], v[204:207]
    s_waitcnt lgkmcnt(7)
    ds_read_b128 a[228:231], v229 offset:28672
    v_cvt_pk_bf16_f32 v162, v200, v201
    v_mfma_f32_16x16x32_bf16 v[24:27], v[216:219], v[180:183], v[24:27]
    v_exp_f32 v202, v202
    v_mfma_f32_16x16x32_bf16 v[56:59], v[216:219], v[184:187], v[56:59]
    ds_read_b128 a[232:235], v235 offset:28672
    v_accvgpr_write_b32 a39, v199
    v_mfma_f32_16x16x32_bf16 v[88:91], v[216:219], v[188:191], v[88:91]
    v_exp_f32 v203, v203
    v_mfma_f32_16x16x32_bf16 v[120:123], v[216:219], v[192:195], v[120:123]
    ds_read_b64_tr_b16 v[212:213], v224 offset:8200
    v_cvt_pk_bf16_f32 v163, v202, v203
    v_mfma_f32_16x16x32_bf16 v[200:203], a[104:107], a[0:3], 0
    s_waitcnt lgkmcnt(9)
    v_exp_f32 v204, v204
    v_mfma_f32_16x16x32_bf16 v[200:203], a[212:215], a[4:7], v[200:203]
    s_waitcnt vmcnt(13) lgkmcnt(8)
    ds_read_b64_tr_b16 v[214:215], v224 offset:10248
    v_accvgpr_write_b32 a40, v236
    v_mfma_f32_16x16x32_bf16 v[200:203], a[216:219], a[8:11], v[200:203]
    s_waitcnt lgkmcnt(8)
    v_exp_f32 v205, v205
    v_mfma_f32_16x16x32_bf16 v[200:203], a[220:223], a[12:15], v[200:203]
    s_waitcnt lgkmcnt(6)
    ds_read_b128 a[236:239], v231 offset:28672
    v_cvt_pk_bf16_f32 v166, v204, v205
    v_mfma_f32_16x16x32_bf16 v[28:31], v[220:223], v[180:183], v[28:31]
    v_exp_f32 v206, v206
    v_mfma_f32_16x16x32_bf16 v[60:63], v[220:223], v[184:187], v[60:63]
    v_exp_f32 v207, v207
    v_mfma_f32_16x16x32_bf16 v[92:95], v[220:223], v[188:191], v[92:95]
    v_cvt_pk_bf16_f32 v167, v206, v207
    v_accvgpr_write_b32 a41, v237
    v_mfma_f32_16x16x32_bf16 v[124:127], v[220:223], v[192:195], v[124:127]
    ds_read_b64_tr_b16 v[216:217], v225 offset:8192
    v_accvgpr_write_b32 a42, v238
    v_smfmac_f32_16x16x64_bf16 a[244:247], a[252:255], v[168:175], v233
    ds_read_b64_tr_b16 v[218:219], v225 offset:10240
    v_accvgpr_write_b32 a43, v239
    v_mfma_f32_16x16x32_bf16 v[204:207], a[104:107], a[16:19], 0
    v_exp_f32 v200, v200
    v_mfma_f32_16x16x32_bf16 v[204:207], a[212:215], a[20:23], v[204:207]
    s_waitcnt vmcnt(12)
    v_accvgpr_write_b32 a44, v240
    v_accvgpr_write_b32 a45, v241
    v_mfma_f32_16x16x32_bf16 v[204:207], a[216:219], a[24:27], v[204:207]
    v_exp_f32 v201, v201
    v_mfma_f32_16x16x32_bf16 v[204:207], a[220:223], a[28:31], v[204:207]
    s_waitcnt lgkmcnt(7)
    v_accvgpr_write_b32 a46, v242
    v_accvgpr_write_b32 a47, v243
    v_mfma_f32_16x16x32_bf16 v[64:67], v[208:211], v[168:171], v[64:67]
    v_exp_f32 v202, v202
    v_mfma_f32_16x16x32_bf16 v[96:99], v[208:211], v[172:175], v[96:99]
    v_accvgpr_read_b32 v253, a244
    v_accvgpr_read_b32 v254, a245
    v_mfma_f32_16x16x32_bf16 v[0:3], v[208:211], v[160:163], v[0:3]
    v_exp_f32 v203, v203
    v_mfma_f32_16x16x32_bf16 v[32:35], v[208:211], v[164:167], v[32:35]
    ds_read_b64_tr_b16 v[220:221], v225 offset:8200
    v_add_f32 v253, v253, v254
    v_cvt_pk_bf16_f32 v180, v200, v201
    v_cvt_pk_bf16_f32 v181, v202, v203
    v_mfma_f32_16x16x32_bf16 v[200:203], a[104:107], a[32:35], 0
    v_rcp_f32 v250, v253
    v_mfma_f32_16x16x32_bf16 v[200:203], a[212:215], a[36:39], v[200:203]
    ds_read_b64_tr_b16 v[222:223], v225 offset:10248
    v_accvgpr_read_b32 v232, a246
    v_mfma_f32_16x16x32_bf16 v[200:203], a[216:219], a[40:43], v[200:203]
    v_exp_f32 v204, v204
    v_mfma_f32_16x16x32_bf16 v[200:203], a[220:223], a[44:47], v[200:203]
    s_waitcnt lgkmcnt(5)
    ds_write_b64 v228, a[126:127] offset:12296
    v_mfma_f32_16x16x32_bf16 v[68:71], v[212:215], v[168:171], v[68:71]
    v_exp_f32 v205, v205
    v_mfma_f32_16x16x32_bf16 v[100:103], v[212:215], v[172:175], v[100:103]
    v_accvgpr_read_b32 v254, a247
    v_add_f32 v232, v232, v254
    v_mfma_f32_16x16x32_bf16 v[4:7], v[212:215], v[160:163], v[4:7]
    s_waitcnt vmcnt(11)
    v_rcp_f32 v251, v232
    v_accvgpr_mov_b32 a48, a64
    v_accvgpr_mov_b32 a49, a65
    v_accvgpr_mov_b32 a50, a66
    v_accvgpr_mov_b32 a51, a67
    v_mfma_f32_16x16x32_bf16 v[36:39], v[212:215], v[164:167], v[36:39]
    s_waitcnt vmcnt(10)
    ds_read_b64_tr_b16 v[208:209], v224 offset:40960
    v_accvgpr_mov_b32 a52, a68
    v_accvgpr_mov_b32 a53, a69
    v_accvgpr_mov_b32 a54, a70
    v_accvgpr_mov_b32 a55, a71
    v_exp_f32 v206, v206
    v_exp_f32 v207, v207
    v_cvt_pk_bf16_f32 v184, v204, v205
    v_cvt_pk_bf16_f32 v185, v206, v207
    v_mfma_f32_16x16x32_bf16 v[204:207], a[104:107], a[48:51], 0
    s_waitcnt vmcnt(9)
    v_exp_f32 v200, v200
    v_accvgpr_mov_b32 a56, a72
    v_accvgpr_mov_b32 a57, a73
    v_accvgpr_mov_b32 a58, a74
    v_accvgpr_mov_b32 a59, a75
    v_mfma_f32_16x16x32_bf16 v[204:207], a[212:215], a[52:55], v[204:207]
    s_waitcnt vmcnt(8)
    ds_read_b64_tr_b16 v[210:211], v224 offset:43008
    v_accvgpr_mov_b32 a60, a76
    v_accvgpr_mov_b32 a61, a77
    v_accvgpr_mov_b32 a62, a78
    v_accvgpr_mov_b32 a63, a79
    v_mfma_f32_16x16x32_bf16 v[204:207], a[216:219], a[56:59], v[204:207]
    v_exp_f32 v201, v201
    v_mfma_f32_16x16x32_bf16 v[204:207], a[220:223], a[60:63], v[204:207]
    s_waitcnt lgkmcnt(2)
    s_barrier
    ds_read_b128 a[212:215], v229 offset:0
    v_cvt_pk_bf16_f32 v188, v200, v201
    v_mfma_f32_16x16x32_bf16 v[72:75], v[216:219], v[168:171], v[72:75]
    v_exp_f32 v202, v202
    v_mfma_f32_16x16x32_bf16 v[104:107], v[216:219], v[172:175], v[104:107]
    ds_read_b128 a[216:219], v235 offset:0
    v_mul_f32 v64, v64, v250
    v_mfma_f32_16x16x32_bf16 v[8:11], v[216:219], v[160:163], v[8:11]
    v_exp_f32 v203, v203
    v_mfma_f32_16x16x32_bf16 v[40:43], v[216:219], v[164:167], v[40:43]
    ds_read_b64_tr_b16 v[212:213], v224 offset:40968
    v_cvt_pk_bf16_f32 v189, v202, v203
    v_mfma_f32_16x16x32_bf16 v[200:203], a[108:111], a[0:3], 0
    v_exp_f32 v204, v204
    v_mfma_f32_16x16x32_bf16 v[200:203], a[228:231], a[4:7], v[200:203]
    ds_read_b64_tr_b16 v[214:215], v224 offset:43016
    v_mul_f32 v65, v65, v250
    v_mfma_f32_16x16x32_bf16 v[200:203], a[232:235], a[8:11], v[200:203]
    v_exp_f32 v205, v205
    v_mfma_f32_16x16x32_bf16 v[200:203], a[236:239], a[12:15], v[200:203]
    ds_read_b128 a[220:223], v231 offset:0
    v_cvt_pk_bf16_f32 v192, v204, v205
    v_mfma_f32_16x16x32_bf16 v[76:79], v[220:223], v[168:171], v[76:79]
    v_exp_f32 v206, v206
    v_mfma_f32_16x16x32_bf16 v[108:111], v[220:223], v[172:175], v[108:111]
    v_exp_f32 v207, v207
    v_mfma_f32_16x16x32_bf16 v[12:15], v[220:223], v[160:163], v[12:15]
    v_cvt_pk_bf16_f32 v193, v206, v207
    v_mul_f32 v66, v66, v250
    v_mfma_f32_16x16x32_bf16 v[44:47], v[220:223], v[164:167], v[44:47]
    ds_read_b64_tr_b16 v[216:217], v225 offset:40960
    v_mul_f32 v67, v67, v250
    v_mfma_f32_16x16x32_bf16 v[204:207], a[108:111], a[16:19], 0
    v_exp_f32 v200, v200
    v_mfma_f32_16x16x32_bf16 v[204:207], a[228:231], a[20:23], v[204:207]
    ds_write_b64 v228, a[128:129] offset:16384
    v_mfma_f32_16x16x32_bf16 v[204:207], a[232:235], a[24:27], v[204:207]
    v_exp_f32 v201, v201
    v_mfma_f32_16x16x32_bf16 v[204:207], a[236:239], a[28:31], v[204:207]
    s_waitcnt lgkmcnt(7)
    ds_read_b64_tr_b16 v[218:219], v225 offset:43008
    v_cvt_pk_bf16_f32 v182, v200, v201
    v_mfma_f32_16x16x32_bf16 v[80:83], v[208:211], v[168:171], v[80:83]
    v_exp_f32 v202, v202
    v_mfma_f32_16x16x32_bf16 v[112:115], v[208:211], v[172:175], v[112:115]
    v_exp_f32 v203, v203
    v_mfma_f32_16x16x32_bf16 v[16:19], v[208:211], v[160:163], v[16:19]
    v_cvt_pk_bf16_f32 v183, v202, v203
    v_cvt_pk_bf16_f32 v244, v64, v65
    v_mfma_f32_16x16x32_bf16 v[48:51], v[208:211], v[164:167], v[48:51]
    ds_read_b64_tr_b16 v[220:221], v225 offset:40968
    v_cvt_pk_bf16_f32 v245, v66, v67
    v_smfmac_f32_16x16x64_bf16 a[240:243], a[252:255], v[160:167], v233
    ds_read_b64_tr_b16 v[222:223], v225 offset:43016
    v_mul_f32 v96, v96, v251
    v_mfma_f32_16x16x32_bf16 v[200:203], a[108:111], a[32:35], 0
    v_exp_f32 v204, v204
    v_mfma_f32_16x16x32_bf16 v[200:203], a[228:231], a[36:39], v[200:203]
    v_exp_f32 v205, v205
    v_mfma_f32_16x16x32_bf16 v[200:203], a[232:235], a[40:43], v[200:203]
    v_exp_f32 v206, v206
    v_mfma_f32_16x16x32_bf16 v[200:203], a[236:239], a[44:47], v[200:203]
    s_waitcnt lgkmcnt(6)
    v_exp_f32 v207, v207
    v_mfma_f32_16x16x32_bf16 v[84:87], v[212:215], v[168:171], v[84:87]
    v_cvt_pk_bf16_f32 v186, v204, v205
    v_cvt_pk_bf16_f32 v187, v206, v207
    v_mfma_f32_16x16x32_bf16 v[116:119], v[212:215], v[172:175], v[116:119]
    v_mul_f32 v97, v97, v251
    v_mul_f32 v98, v98, v251
    v_mfma_f32_16x16x32_bf16 v[20:23], v[212:215], v[160:163], v[20:23]
    v_mul_f32 v99, v99, v251
    v_cvt_pk_bf16_f32 v176, v96, v97
    v_mfma_f32_16x16x32_bf16 v[52:55], v[212:215], v[164:167], v[52:55]
    ds_read_b64_tr_b16 v[208:209], v224 offset:12288
    v_cvt_pk_bf16_f32 v177, v98, v99
    v_mfma_f32_16x16x32_bf16 v[204:207], a[108:111], a[48:51], 0
    ds_write_b64 v228, a[130:131] offset:16392
    v_mfma_f32_16x16x32_bf16 v[204:207], a[228:231], a[52:55], v[204:207]
    ds_read_b64_tr_b16 v[210:211], v224 offset:14336
    v_mul_f32 v68, v68, v250
    v_mfma_f32_16x16x32_bf16 v[204:207], a[232:235], a[56:59], v[204:207]
    v_exp_f32 v200, v200
    v_mfma_f32_16x16x32_bf16 v[204:207], a[236:239], a[60:63], v[204:207]
    s_waitcnt lgkmcnt(5)
    ds_read_b128 a[228:231], v229 offset:4096
    v_mul_f32 v69, v69, v250
    v_mfma_f32_16x16x32_bf16 v[88:91], v[216:219], v[168:171], v[88:91]
    v_exp_f32 v201, v201
    v_mfma_f32_16x16x32_bf16 v[120:123], v[216:219], v[172:175], v[120:123]
    ds_read_b128 a[232:235], v235 offset:4096
    v_cvt_pk_bf16_f32 v190, v200, v201
    v_mfma_f32_16x16x32_bf16 v[24:27], v[216:219], v[160:163], v[24:27]
    v_exp_f32 v202, v202
    v_mfma_f32_16x16x32_bf16 v[56:59], v[216:219], v[164:167], v[56:59]
    ds_read_b64_tr_b16 v[212:213], v224 offset:12296
    v_mul_f32 v70, v70, v250
    v_exp_f32 v203, v203
    v_mul_f32 v71, v71, v250
    v_cvt_pk_bf16_f32 v191, v202, v203
    v_mfma_f32_16x16x32_bf16 v[200:203], a[112:115], a[0:3], 0
    v_exp_f32 v204, v204
    v_mfma_f32_16x16x32_bf16 v[200:203], a[212:215], a[4:7], v[200:203]
    ds_read_b64_tr_b16 v[214:215], v224 offset:14344
    v_cvt_pk_bf16_f32 v246, v68, v69
    v_mfma_f32_16x16x32_bf16 v[200:203], a[216:219], a[8:11], v[200:203]
    v_exp_f32 v205, v205
    v_mfma_f32_16x16x32_bf16 v[200:203], a[220:223], a[12:15], v[200:203]
    s_waitcnt lgkmcnt(7)
    ds_read_b128 a[236:239], v231 offset:4096
    v_cvt_pk_bf16_f32 v194, v204, v205
    v_mfma_f32_16x16x32_bf16 v[92:95], v[220:223], v[168:171], v[92:95]
    v_exp_f32 v206, v206
    v_mfma_f32_16x16x32_bf16 v[124:127], v[220:223], v[172:175], v[124:127]
    v_exp_f32 v207, v207
    v_mfma_f32_16x16x32_bf16 v[28:31], v[220:223], v[160:163], v[28:31]
    v_cvt_pk_bf16_f32 v195, v206, v207
    v_cvt_pk_bf16_f32 v247, v70, v71
    v_mfma_f32_16x16x32_bf16 v[60:63], v[220:223], v[164:167], v[60:63]
    ds_write_b64 v228, a[132:133] offset:20480
    v_mfma_f32_16x16x32_bf16 v[204:207], a[112:115], a[16:19], 0
    v_exp_f32 v200, v200
    v_mfma_f32_16x16x32_bf16 v[204:207], a[212:215], a[20:23], v[204:207]
    buffer_store_dwordx4 v[244:247], v230, s[20:23], s32 offen offset:0
    v_mfma_f32_16x16x32_bf16 v[204:207], a[216:219], a[24:27], v[204:207]
    v_exp_f32 v201, v201
    v_mfma_f32_16x16x32_bf16 v[204:207], a[220:223], a[28:31], v[204:207]
    s_waitcnt lgkmcnt(6)
    ds_read_b64_tr_b16 v[216:217], v225 offset:12288
    v_cvt_pk_bf16_f32 v160, v200, v201
    v_mfma_f32_16x16x32_bf16 v[0:3], v[208:211], v[180:183], v[0:3]
    v_exp_f32 v202, v202
    v_mfma_f32_16x16x32_bf16 v[32:35], v[208:211], v[184:187], v[32:35]
    ds_read_b64_tr_b16 v[218:219], v225 offset:14336
    v_mul_f32 v100, v100, v251
    v_mfma_f32_16x16x32_bf16 v[64:67], v[208:211], v[188:191], 0
    v_exp_f32 v203, v203
    v_mfma_f32_16x16x32_bf16 v[96:99], v[208:211], v[192:195], 0
    ds_read_b64_tr_b16 v[220:221], v225 offset:12296
    v_cvt_pk_bf16_f32 v161, v202, v203
    v_smfmac_f32_16x16x64_bf16 a[240:243], a[252:255], v[180:187], v233
    ds_read_b64_tr_b16 v[222:223], v225 offset:14344
    v_mul_f32 v101, v101, v251
    v_mfma_f32_16x16x32_bf16 v[200:203], a[112:115], a[32:35], 0
    v_exp_f32 v204, v204
    v_mfma_f32_16x16x32_bf16 v[200:203], a[212:215], a[36:39], v[200:203]
    v_mul_f32 v102, v102, v251
    v_mul_f32 v103, v103, v251
    v_mfma_f32_16x16x32_bf16 v[200:203], a[216:219], a[40:43], v[200:203]
    v_exp_f32 v205, v205
    v_mfma_f32_16x16x32_bf16 v[200:203], a[220:223], a[44:47], v[200:203]
    s_waitcnt lgkmcnt(6)
    v_cvt_pk_bf16_f32 v178, v100, v101
    v_cvt_pk_bf16_f32 v179, v102, v103
    v_mfma_f32_16x16x32_bf16 v[4:7], v[212:215], v[180:183], v[4:7]
    v_exp_f32 v206, v206
    v_mfma_f32_16x16x32_bf16 v[36:39], v[212:215], v[184:187], v[36:39]
    v_exp_f32 v207, v207
    v_mfma_f32_16x16x32_bf16 v[68:71], v[212:215], v[188:191], 0
    ds_write_b64 v228, a[134:135] offset:20488
    v_mfma_f32_16x16x32_bf16 v[100:103], v[212:215], v[192:195], 0
    buffer_store_dwordx4 v[176:179], v230, s[20:23], s33 offen offset:0
    v_cvt_pk_bf16_f32 v164, v204, v205
    v_cvt_pk_bf16_f32 v165, v206, v207
    v_mfma_f32_16x16x32_bf16 v[204:207], a[112:115], a[48:51], 0
    v_exp_f32 v200, v200
    v_mfma_f32_16x16x32_bf16 v[204:207], a[212:215], a[52:55], v[204:207]
    ds_read_b64_tr_b16 v[208:209], v224 offset:45056
    v_mul_f32 v72, v72, v250
    v_mfma_f32_16x16x32_bf16 v[204:207], a[216:219], a[56:59], v[204:207]
    v_exp_f32 v201, v201
    v_mfma_f32_16x16x32_bf16 v[204:207], a[220:223], a[60:63], v[204:207]
    s_waitcnt lgkmcnt(4)
    ds_read_b64_tr_b16 v[210:211], v224 offset:47104
    v_mul_f32 v73, v73, v250
    v_mfma_f32_16x16x32_bf16 v[8:11], v[216:219], v[180:183], v[8:11]
    v_exp_f32 v202, v202
    v_mfma_f32_16x16x32_bf16 v[40:43], v[216:219], v[184:187], v[40:43]
    ds_read_b128 a[212:215], v229 offset:8192
    v_mul_f32 v74, v74, v250
    v_mul_f32 v75, v75, v250
    v_cvt_pk_bf16_f32 v196, v72, v73
    v_cvt_pk_bf16_f32 v197, v74, v75
    v_mfma_f32_16x16x32_bf16 v[72:75], v[216:219], v[188:191], 0
    v_exp_f32 v203, v203
    v_mul_f32 v104, v104, v251
    v_mul_f32 v105, v105, v251
    v_mul_f32 v106, v106, v251
    v_mul_f32 v107, v107, v251
    v_cvt_pk_bf16_f32 v236, v104, v105
    v_cvt_pk_bf16_f32 v237, v106, v107
    v_mfma_f32_16x16x32_bf16 v[104:107], v[216:219], v[192:195], 0
    ds_read_b64_tr_b16 v[212:213], v224 offset:45064
    v_cvt_pk_bf16_f32 v168, v200, v201
    v_cvt_pk_bf16_f32 v169, v202, v203
    v_mfma_f32_16x16x32_bf16 v[200:203], a[116:119], a[0:3], 0
    v_exp_f32 v204, v204
    v_mfma_f32_16x16x32_bf16 v[200:203], a[228:231], a[4:7], v[200:203]
    ds_read_b64_tr_b16 v[214:215], v224 offset:47112
    v_mul_f32 v76, v76, v250
    v_mfma_f32_16x16x32_bf16 v[200:203], a[232:235], a[8:11], v[200:203]
    v_exp_f32 v205, v205
    v_mfma_f32_16x16x32_bf16 v[200:203], a[236:239], a[12:15], v[200:203]
    s_waitcnt lgkmcnt(6)
    ds_read_b128 a[216:219], v235 offset:8192
    v_mul_f32 v77, v77, v250
    v_mfma_f32_16x16x32_bf16 v[12:15], v[220:223], v[180:183], v[12:15]
    v_exp_f32 v206, v206
    v_mfma_f32_16x16x32_bf16 v[44:47], v[220:223], v[184:187], v[44:47]
    ds_read_b128 a[220:223], v231 offset:8192
    v_mul_f32 v78, v78, v250
    v_mul_f32 v79, v79, v250
    v_cvt_pk_bf16_f32 v198, v76, v77
    v_cvt_pk_bf16_f32 v199, v78, v79
    v_mfma_f32_16x16x32_bf16 v[76:79], v[220:223], v[188:191], 0
    ds_write_b64 v228, a[136:137] offset:24576
    v_mul_f32 v108, v108, v251
    v_mul_f32 v109, v109, v251
    v_mul_f32 v110, v110, v251
    v_mul_f32 v111, v111, v251
    v_cvt_pk_bf16_f32 v238, v108, v109
    v_cvt_pk_bf16_f32 v239, v110, v111
    v_mfma_f32_16x16x32_bf16 v[108:111], v[220:223], v[192:195], 0
    buffer_store_dwordx4 v[196:199], v230, s[20:23], s32 offen offset:64
    v_exp_f32 v207, v207
    v_cvt_pk_bf16_f32 v172, v204, v205
    v_cvt_pk_bf16_f32 v173, v206, v207
    v_mfma_f32_16x16x32_bf16 v[204:207], a[116:119], a[16:19], 0
    v_exp_f32 v200, v200
    v_mfma_f32_16x16x32_bf16 v[204:207], a[228:231], a[20:23], v[204:207]
    ds_read_b64_tr_b16 v[216:217], v225 offset:45056
    v_mul_f32 v80, v80, v250
    v_mfma_f32_16x16x32_bf16 v[204:207], a[232:235], a[24:27], v[204:207]
    v_exp_f32 v201, v201
    v_mfma_f32_16x16x32_bf16 v[204:207], a[236:239], a[28:31], v[204:207]
    s_waitcnt lgkmcnt(7)
    ds_read_b64_tr_b16 v[218:219], v225 offset:47104
    v_mul_f32 v81, v81, v250
    v_mfma_f32_16x16x32_bf16 v[16:19], v[208:211], v[180:183], v[16:19]
    v_exp_f32 v202, v202
    v_mfma_f32_16x16x32_bf16 v[48:51], v[208:211], v[184:187], v[48:51]
    v_mul_f32 v82, v82, v250
    v_mul_f32 v83, v83, v250
    v_cvt_pk_bf16_f32 v240, v80, v81
    v_cvt_pk_bf16_f32 v241, v82, v83
    v_mfma_f32_16x16x32_bf16 v[80:83], v[208:211], v[188:191], 0
    v_exp_f32 v203, v203
    v_accvgpr_write_b32 a244, 0
    v_accvgpr_write_b32 a245, 0
    v_accvgpr_write_b32 a246, 0
    v_accvgpr_write_b32 a247, 0
    v_mul_f32 v112, v112, v251
    v_mul_f32 v113, v113, v251
    v_mul_f32 v114, v114, v251
    v_mul_f32 v115, v115, v251
    v_cvt_pk_bf16_f32 v128, v112, v113
    v_cvt_pk_bf16_f32 v129, v114, v115
    v_mfma_f32_16x16x32_bf16 v[112:115], v[208:211], v[192:195], 0
    ds_read_b64_tr_b16 v[220:221], v225 offset:45064
    v_cvt_pk_bf16_f32 v162, v200, v201
    v_smfmac_f32_16x16x64_bf16 a[244:247], a[252:255], v[188:195], v233
    ds_read_b64_tr_b16 v[222:223], v225 offset:47112
    v_cvt_pk_bf16_f32 v163, v202, v203
    v_mfma_f32_16x16x32_bf16 v[200:203], a[116:119], a[32:35], 0
    v_exp_f32 v204, v204
    v_mfma_f32_16x16x32_bf16 v[200:203], a[228:231], a[36:39], v[200:203]
    v_mul_f32 v84, v84, v250
    v_mul_f32 v85, v85, v250
    v_mfma_f32_16x16x32_bf16 v[200:203], a[232:235], a[40:43], v[200:203]
    v_exp_f32 v205, v205
    v_mfma_f32_16x16x32_bf16 v[200:203], a[236:239], a[44:47], v[200:203]
    s_waitcnt lgkmcnt(7)
    v_mul_f32 v86, v86, v250
    v_mul_f32 v87, v87, v250
    v_mfma_f32_16x16x32_bf16 v[20:23], v[212:215], v[180:183], v[20:23]
    ds_write_b64 v228, a[138:139] offset:24584
    v_mfma_f32_16x16x32_bf16 v[52:55], v[212:215], v[184:187], v[52:55]
    v_cvt_pk_bf16_f32 v242, v84, v85
    v_cvt_pk_bf16_f32 v243, v86, v87
    v_mfma_f32_16x16x32_bf16 v[84:87], v[212:215], v[188:191], 0
    v_exp_f32 v206, v206
    v_mul_f32 v116, v116, v251
    v_mul_f32 v117, v117, v251
    v_mul_f32 v118, v118, v251
    v_mul_f32 v119, v119, v251
    v_cvt_pk_bf16_f32 v130, v116, v117
    v_cvt_pk_bf16_f32 v131, v118, v119
    v_mfma_f32_16x16x32_bf16 v[116:119], v[212:215], v[192:195], 0
    buffer_store_dwordx4 v[236:239], v230, s[20:23], s33 offen offset:64
    v_exp_f32 v207, v207
    v_cvt_pk_bf16_f32 v166, v204, v205
    v_cvt_pk_bf16_f32 v167, v206, v207
    v_mfma_f32_16x16x32_bf16 v[204:207], a[116:119], a[48:51], 0
    v_exp_f32 v200, v200
    v_mfma_f32_16x16x32_bf16 v[204:207], a[228:231], a[52:55], v[204:207]
    ds_read_b64_tr_b16 v[208:209], v224 offset:16384
    v_mul_f32 v88, v88, v250
    v_mfma_f32_16x16x32_bf16 v[204:207], a[232:235], a[56:59], v[204:207]
    v_exp_f32 v201, v201
    v_mfma_f32_16x16x32_bf16 v[204:207], a[236:239], a[60:63], v[204:207]
    s_waitcnt lgkmcnt(4)
    ds_read_b64_tr_b16 v[210:211], v224 offset:18432
    v_mul_f32 v89, v89, v250
    v_mfma_f32_16x16x32_bf16 v[24:27], v[216:219], v[180:183], v[24:27]
    v_exp_f32 v202, v202
    v_mfma_f32_16x16x32_bf16 v[56:59], v[216:219], v[184:187], v[56:59]
    ds_read_b128 a[228:231], v229 offset:12288
    v_mul_f32 v90, v90, v250
    v_mul_f32 v91, v91, v250
    v_cvt_pk_bf16_f32 v132, v88, v89
    v_cvt_pk_bf16_f32 v133, v90, v91
    v_mfma_f32_16x16x32_bf16 v[88:91], v[216:219], v[188:191], 0
    v_exp_f32 v203, v203
    v_mul_f32 v120, v120, v251
    v_mul_f32 v121, v121, v251
    v_mul_f32 v122, v122, v251
    v_mul_f32 v123, v123, v251
    v_cvt_pk_bf16_f32 v136, v120, v121
    v_cvt_pk_bf16_f32 v137, v122, v123
    v_mfma_f32_16x16x32_bf16 v[120:123], v[216:219], v[192:195], 0
    ds_read_b64_tr_b16 v[212:213], v224 offset:16392
    v_cvt_pk_bf16_f32 v170, v200, v201
    v_cvt_pk_bf16_f32 v171, v202, v203
    v_mfma_f32_16x16x32_bf16 v[200:203], a[120:123], a[0:3], 0
    v_exp_f32 v204, v204
    v_mfma_f32_16x16x32_bf16 v[200:203], a[212:215], a[4:7], v[200:203]
    ds_read_b64_tr_b16 v[214:215], v224 offset:18440
    v_mul_f32 v92, v92, v250
    v_mfma_f32_16x16x32_bf16 v[200:203], a[216:219], a[8:11], v[200:203]
    v_exp_f32 v205, v205
    v_mfma_f32_16x16x32_bf16 v[200:203], a[220:223], a[12:15], v[200:203]
    s_waitcnt lgkmcnt(6)
    ds_read_b128 a[232:235], v235 offset:12288
    v_mul_f32 v93, v93, v250
    v_mfma_f32_16x16x32_bf16 v[28:31], v[220:223], v[180:183], v[28:31]
    ds_write_b64 v228, a[140:141] offset:28672
    v_mfma_f32_16x16x32_bf16 v[60:63], v[220:223], v[184:187], v[60:63]
    ds_read_b128 a[236:239], v231 offset:12288
    v_mul_f32 v94, v94, v250
    v_mul_f32 v95, v95, v250
    v_cvt_pk_bf16_f32 v134, v92, v93
    v_cvt_pk_bf16_f32 v135, v94, v95
    v_mfma_f32_16x16x32_bf16 v[92:95], v[220:223], v[188:191], 0
    v_exp_f32 v206, v206
    v_mul_f32 v124, v124, v251
    v_mul_f32 v125, v125, v251
    v_mul_f32 v126, v126, v251
    v_mul_f32 v127, v127, v251
    v_cvt_pk_bf16_f32 v138, v124, v125
    v_cvt_pk_bf16_f32 v139, v126, v127
    v_mfma_f32_16x16x32_bf16 v[124:127], v[220:223], v[192:195], 0
    buffer_store_dwordx4 v[240:243], v230, s[20:23], s32 offen offset:128
    v_exp_f32 v207, v207
    v_cvt_pk_bf16_f32 v174, v204, v205
    v_cvt_pk_bf16_f32 v175, v206, v207
    v_mfma_f32_16x16x32_bf16 v[204:207], a[120:123], a[16:19], 0
    v_exp_f32 v200, v200
    v_mfma_f32_16x16x32_bf16 v[204:207], a[212:215], a[20:23], v[204:207]
    ds_read_b64_tr_b16 v[216:217], v225 offset:16384
    v_max3_u32 v226, v226, v253, v232
    v_mfma_f32_16x16x32_bf16 v[204:207], a[216:219], a[24:27], v[204:207]
L_pad11:
    s_cbranch_vccnz L_back
    v_exp_f32 v201, v201
    v_mfma_f32_16x16x32_bf16 v[204:207], a[220:223], a[28:31], v[204:207]
    s_waitcnt lgkmcnt(7)
    ds_read_b64_tr_b16 v[218:219], v225 offset:18432
    v_cvt_pk_bf16_f32 v180, v200, v201
    v_mfma_f32_16x16x32_bf16 v[0:3], v[208:211], v[160:163], v[0:3]
    v_exp_f32 v202, v202
    v_mfma_f32_16x16x32_bf16 v[32:35], v[208:211], v[164:167], v[32:35]
    v_exp_f32 v203, v203
    v_mfma_f32_16x16x32_bf16 v[64:67], v[208:211], v[168:171], v[64:67]
    v_cvt_pk_bf16_f32 v181, v202, v203
    v_min3_u32 v227, v227, v253, v232
    v_mfma_f32_16x16x32_bf16 v[96:99], v[208:211], v[172:175], v[96:99]
    ds_write_b64 v228, a[142:143] offset:28680
    v_smfmac_f32_16x16x64_bf16 a[240:243], a[252:255], v[160:167], v233
    ds_read_b64_tr_b16 v[220:221], v225 offset:16392
    v_mfma_f32_16x16x32_bf16 v[200:203], a[120:123], a[32:35], 0
    v_exp_f32 v204, v204
    v_mfma_f32_16x16x32_bf16 v[200:203], a[212:215], a[36:39], v[200:203]
    ds_read_b64_tr_b16 v[222:223], v225 offset:18440
    v_mfma_f32_16x16x32_bf16 v[200:203], a[216:219], a[40:43], v[200:203]
    v_exp_f32 v205, v205
    v_mfma_f32_16x16x32_bf16 v[200:203], a[220:223], a[44:47], v[200:203]
    s_waitcnt lgkmcnt(8)
    v_exp_f32 v206, v206
    v_mfma_f32_16x16x32_bf16 v[4:7], v[212:215], v[160:163], v[4:7]
    v_exp_f32 v207, v207
    v_mfma_f32_16x16x32_bf16 v[36:39], v[212:215], v[164:167], v[36:39]
    buffer_store_dwordx4 v[128:131], v230, s[20:23], s33 offen offset:128
    v_mfma_f32_16x16x32_bf16 v[68:71], v[212:215], v[168:171], v[68:71]
    v_cvt_pk_bf16_f32 v184, v204, v205
    v_cvt_pk_bf16_f32 v185, v206, v207
    v_mfma_f32_16x16x32_bf16 v[100:103], v[212:215], v[172:175], v[100:103]
    ds_read_b64_tr_b16 v[208:209], v224 offset:49152
    v_mfma_f32_16x16x32_bf16 v[204:207], a[120:123], a[48:51], 0
    v_exp_f32 v200, v200
    v_mfma_f32_16x16x32_bf16 v[204:207], a[212:215], a[52:55], v[204:207]
    ds_read_b64_tr_b16 v[210:211], v224 offset:51200
    v_mfma_f32_16x16x32_bf16 v[204:207], a[216:219], a[56:59], v[204:207]
    v_exp_f32 v201, v201
    v_mfma_f32_16x16x32_bf16 v[204:207], a[220:223], a[60:63], v[204:207]
    s_waitcnt lgkmcnt(4)
    s_barrier
    ds_read_b128 a[212:215], v229 offset:16384
    v_cvt_pk_bf16_f32 v188, v200, v201
    v_mfma_f32_16x16x32_bf16 v[8:11], v[216:219], v[160:163], v[8:11]
    v_exp_f32 v202, v202
    v_mfma_f32_16x16x32_bf16 v[40:43], v[216:219], v[164:167], v[40:43]
    ds_write_b64 v228, a[144:145] offset:0
    v_mfma_f32_16x16x32_bf16 v[72:75], v[216:219], v[168:171], v[72:75]
    v_exp_f32 v203, v203
    v_mfma_f32_16x16x32_bf16 v[104:107], v[216:219], v[172:175], v[104:107]
    ds_read_b64_tr_b16 v[212:213], v224 offset:49160
    v_cvt_pk_bf16_f32 v189, v202, v203
    v_mfma_f32_16x16x32_bf16 v[200:203], a[124:127], a[0:3], 0
    v_exp_f32 v204, v204
    v_mfma_f32_16x16x32_bf16 v[200:203], a[228:231], a[4:7], v[200:203]
    ds_write_b64 v228, a[146:147] offset:8
    v_mfma_f32_16x16x32_bf16 v[200:203], a[232:235], a[8:11], v[200:203]
    v_exp_f32 v205, v205
    v_mfma_f32_16x16x32_bf16 v[200:203], a[236:239], a[12:15], v[200:203]
    s_waitcnt lgkmcnt(6)
    ds_read_b64_tr_b16 v[214:215], v224 offset:51208
    v_cvt_pk_bf16_f32 v192, v204, v205
    v_mfma_f32_16x16x32_bf16 v[12:15], v[220:223], v[160:163], v[12:15]
    v_exp_f32 v206, v206
    v_mfma_f32_16x16x32_bf16 v[44:47], v[220:223], v[164:167], v[44:47]
    buffer_store_dwordx4 v[132:135], v230, s[20:23], s32 offen offset:192
    v_mfma_f32_16x16x32_bf16 v[76:79], v[220:223], v[168:171], v[76:79]
    v_exp_f32 v207, v207
    v_mfma_f32_16x16x32_bf16 v[108:111], v[220:223], v[172:175], v[108:111]
    ds_read_b64_tr_b16 v[216:217], v225 offset:49152
    v_cvt_pk_bf16_f32 v193, v206, v207
    v_mfma_f32_16x16x32_bf16 v[204:207], a[124:127], a[16:19], 0
    v_exp_f32 v200, v200
    v_mfma_f32_16x16x32_bf16 v[204:207], a[228:231], a[20:23], v[204:207]
    ds_write_b64 v228, a[148:149] offset:4096
    v_mfma_f32_16x16x32_bf16 v[204:207], a[232:235], a[24:27], v[204:207]
    v_exp_f32 v201, v201
    v_mfma_f32_16x16x32_bf16 v[204:207], a[236:239], a[28:31], v[204:207]
    s_waitcnt lgkmcnt(7)
    ds_read_b64_tr_b16 v[218:219], v225 offset:51200
    v_cvt_pk_bf16_f32 v182, v200, v201
    v_mfma_f32_16x16x32_bf16 v[16:19], v[208:211], v[160:163], v[16:19]
    v_exp_f32 v202, v202
    v_mfma_f32_16x16x32_bf16 v[48:51], v[208:211], v[164:167], v[48:51]
    ds_write_b64 v228, a[150:151] offset:4104
    v_mfma_f32_16x16x32_bf16 v[80:83], v[208:211], v[168:171], v[80:83]
    v_exp_f32 v203, v203
    v_mfma_f32_16x16x32_bf16 v[112:115], v[208:211], v[172:175], v[112:115]
    ds_read_b128 a[216:219], v235 offset:16384
    v_cvt_pk_bf16_f32 v183, v202, v203
    v_smfmac_f32_16x16x64_bf16 a[244:247], a[252:255], v[168:175], v233
    ds_write_b64 v228, a[152:153] offset:8192
    v_mfma_f32_16x16x32_bf16 v[200:203], a[124:127], a[32:35], 0
    v_exp_f32 v204, v204
    v_mfma_f32_16x16x32_bf16 v[200:203], a[228:231], a[36:39], v[200:203]
    ds_write_b64 v228, a[154:155] offset:8200
    v_mfma_f32_16x16x32_bf16 v[200:203], a[232:235], a[40:43], v[200:203]
    v_exp_f32 v205, v205
    v_mfma_f32_16x16x32_bf16 v[200:203], a[236:239], a[44:47], v[200:203]
    s_waitcnt lgkmcnt(7)
    ds_read_b128 a[220:223], v231 offset:16384
    v_cvt_pk_bf16_f32 v186, v204, v205
    v_mfma_f32_16x16x32_bf16 v[20:23], v[212:215], v[160:163], v[20:23]
    v_exp_f32 v206, v206
    v_mfma_f32_16x16x32_bf16 v[52:55], v[212:215], v[164:167], v[52:55]
    buffer_store_dwordx4 v[136:139], v230, s[20:23], s33 offen offset:192
    v_mfma_f32_16x16x32_bf16 v[84:87], v[212:215], v[168:171], v[84:87]
    v_exp_f32 v207, v207
    v_mfma_f32_16x16x32_bf16 v[116:119], v[212:215], v[172:175], v[116:119]
    ds_read_b64_tr_b16 v[220:221], v225 offset:49160
    v_cvt_pk_bf16_f32 v187, v206, v207
    v_mfma_f32_16x16x32_bf16 v[204:207], a[124:127], a[48:51], 0
    v_exp_f32 v200, v200
    v_mfma_f32_16x16x32_bf16 v[204:207], a[228:231], a[52:55], v[204:207]
    ds_write_b64 v228, a[156:157] offset:12288
    v_mfma_f32_16x16x32_bf16 v[204:207], a[232:235], a[56:59], v[204:207]
    v_exp_f32 v201, v201
    v_mfma_f32_16x16x32_bf16 v[204:207], a[236:239], a[60:63], v[204:207]
    s_waitcnt lgkmcnt(7)
    ds_read_b64_tr_b16 v[222:223], v225 offset:51208
    v_cvt_pk_bf16_f32 v190, v200, v201
    v_mfma_f32_16x16x32_bf16 v[24:27], v[216:219], v[160:163], v[24:27]
    v_exp_f32 v202, v202
    v_mfma_f32_16x16x32_bf16 v[56:59], v[216:219], v[164:167], v[56:59]
    ds_write_b64 v228, a[158:159] offset:12296
    v_mfma_f32_16x16x32_bf16 v[88:91], v[216:219], v[168:171], v[88:91]
    v_exp_f32 v203, v203
    v_mfma_f32_16x16x32_bf16 v[120:123], v[216:219], v[172:175], v[120:123]
    ds_read_b64_tr_b16 v[208:209], v224 offset:20480
    v_cvt_pk_bf16_f32 v191, v202, v203
    v_mfma_f32_16x16x32_bf16 v[200:203], a[128:131], a[0:3], 0
    v_exp_f32 v204, v204
    v_mfma_f32_16x16x32_bf16 v[200:203], a[212:215], a[4:7], v[200:203]
    s_waitcnt lgkmcnt(8)
    ds_read_b64_tr_b16 v[210:211], v224 offset:22528
    v_mfma_f32_16x16x32_bf16 v[200:203], a[216:219], a[8:11], v[200:203]
    s_waitcnt lgkmcnt(6)
    v_exp_f32 v205, v205
    v_mfma_f32_16x16x32_bf16 v[200:203], a[220:223], a[12:15], v[200:203]
    s_waitcnt lgkmcnt(3)
    ds_read_b64_tr_b16 v[212:213], v224 offset:20488
    v_cvt_pk_bf16_f32 v194, v204, v205
    v_mfma_f32_16x16x32_bf16 v[28:31], v[220:223], v[160:163], v[28:31]
    v_exp_f32 v206, v206
    v_mfma_f32_16x16x32_bf16 v[60:63], v[220:223], v[164:167], v[60:63]
    ds_read_b64_tr_b16 v[214:215], v224 offset:22536
    v_mfma_f32_16x16x32_bf16 v[92:95], v[220:223], v[168:171], v[92:95]
    v_exp_f32 v207, v207
    v_mfma_f32_16x16x32_bf16 v[124:127], v[220:223], v[172:175], v[124:127]
    ds_read_b64_tr_b16 v[216:217], v225 offset:20480
    v_cvt_pk_bf16_f32 v195, v206, v207
    v_mfma_f32_16x16x32_bf16 v[204:207], a[128:131], a[16:19], 0
    v_exp_f32 v200, v200
    v_mfma_f32_16x16x32_bf16 v[204:207], a[212:215], a[20:23], v[204:207]
    ds_read_b64_tr_b16 v[218:219], v225 offset:22528
    v_mfma_f32_16x16x32_bf16 v[204:207], a[216:219], a[24:27], v[204:207]
    v_exp_f32 v201, v201
    v_mfma_f32_16x16x32_bf16 v[204:207], a[220:223], a[28:31], v[204:207]
    s_waitcnt lgkmcnt(4)
    ds_read_b128 a[228:231], v229 offset:20480
    v_cvt_pk_bf16_f32 v160, v200, v201
    v_mfma_f32_16x16x32_bf16 v[0:3], v[208:211], v[180:183], v[0:3]
    v_exp_f32 v202, v202
    v_mfma_f32_16x16x32_bf16 v[32:35], v[208:211], v[184:187], v[32:35]
    ds_read_b128 a[232:235], v235 offset:20480
    v_mfma_f32_16x16x32_bf16 v[64:67], v[208:211], v[188:191], v[64:67]
    v_exp_f32 v203, v203
    v_mfma_f32_16x16x32_bf16 v[96:99], v[208:211], v[192:195], v[96:99]
    ds_read_b128 a[236:239], v231 offset:20480
    v_cvt_pk_bf16_f32 v161, v202, v203
    v_smfmac_f32_16x16x64_bf16 a[240:243], a[252:255], v[180:187], v233
    ds_read_b64_tr_b16 v[220:221], v225 offset:20488
    v_mfma_f32_16x16x32_bf16 v[200:203], a[128:131], a[32:35], 0
    v_exp_f32 v204, v204
    v_mfma_f32_16x16x32_bf16 v[200:203], a[212:215], a[36:39], v[200:203]
    ds_read_b64_tr_b16 v[222:223], v225 offset:22536
    v_mfma_f32_16x16x32_bf16 v[200:203], a[216:219], a[40:43], v[200:203]
    v_exp_f32 v205, v205
    v_mfma_f32_16x16x32_bf16 v[200:203], a[220:223], a[44:47], v[200:203]
    s_waitcnt lgkmcnt(7)
    v_exp_f32 v206, v206
    v_mfma_f32_16x16x32_bf16 v[4:7], v[212:215], v[180:183], v[4:7]
    v_exp_f32 v207, v207
    v_mfma_f32_16x16x32_bf16 v[36:39], v[212:215], v[184:187], v[36:39]
    v_cvt_pk_bf16_f32 v164, v204, v205
    v_cvt_pk_bf16_f32 v165, v206, v207
    v_mfma_f32_16x16x32_bf16 v[68:71], v[212:215], v[188:191], v[68:71]
    v_mfma_f32_16x16x32_bf16 v[100:103], v[212:215], v[192:195], v[100:103]
    ds_read_b64_tr_b16 v[208:209], v224 offset:53248
    v_mfma_f32_16x16x32_bf16 v[204:207], a[128:131], a[48:51], 0
    v_exp_f32 v200, v200
    v_mfma_f32_16x16x32_bf16 v[204:207], a[212:215], a[52:55], v[204:207]
    ds_read_b64_tr_b16 v[210:211], v224 offset:55296
    v_mfma_f32_16x16x32_bf16 v[204:207], a[216:219], a[56:59], v[204:207]
    v_exp_f32 v201, v201
    v_mfma_f32_16x16x32_bf16 v[204:207], a[220:223], a[60:63], v[204:207]
    s_waitcnt lgkmcnt(7)
    ds_read_b128 a[212:215], v229 offset:24576
    v_cvt_pk_bf16_f32 v168, v200, v201
    v_mfma_f32_16x16x32_bf16 v[8:11], v[216:219], v[180:183], v[8:11]
    v_exp_f32 v202, v202
    v_mfma_f32_16x16x32_bf16 v[40:43], v[216:219], v[184:187], v[40:43]
    ds_read_b128 a[216:219], v235 offset:24576
    v_mfma_f32_16x16x32_bf16 v[72:75], v[216:219], v[188:191], v[72:75]
    v_exp_f32 v203, v203
    v_mfma_f32_16x16x32_bf16 v[104:107], v[216:219], v[192:195], v[104:107]
    ds_read_b64_tr_b16 v[212:213], v224 offset:53256
    v_cvt_pk_bf16_f32 v169, v202, v203
    v_mfma_f32_16x16x32_bf16 v[200:203], a[132:135], a[0:3], 0
    s_waitcnt lgkmcnt(9)
    v_exp_f32 v204, v204
    v_mfma_f32_16x16x32_bf16 v[200:203], a[228:231], a[4:7], v[200:203]
    s_waitcnt lgkmcnt(8)
    ds_read_b64_tr_b16 v[214:215], v224 offset:55304
    v_mfma_f32_16x16x32_bf16 v[200:203], a[232:235], a[8:11], v[200:203]
    s_waitcnt lgkmcnt(8)
    v_exp_f32 v205, v205
    v_mfma_f32_16x16x32_bf16 v[200:203], a[236:239], a[12:15], v[200:203]
    s_waitcnt lgkmcnt(6)
    ds_read_b128 a[220:223], v231 offset:24576
    v_cvt_pk_bf16_f32 v172, v204, v205
    v_mfma_f32_16x16x32_bf16 v[12:15], v[220:223], v[180:183], v[12:15]
    v_exp_f32 v206, v206
    v_mfma_f32_16x16x32_bf16 v[44:47], v[220:223], v[184:187], v[44:47]
    v_exp_f32 v207, v207
    v_mfma_f32_16x16x32_bf16 v[76:79], v[220:223], v[188:191], v[76:79]
    v_cvt_pk_bf16_f32 v173, v206, v207
    v_mfma_f32_16x16x32_bf16 v[108:111], v[220:223], v[192:195], v[108:111]
    ds_read_b64_tr_b16 v[216:217], v225 offset:53248
    v_mfma_f32_16x16x32_bf16 v[204:207], a[132:135], a[16:19], 0
    v_exp_f32 v200, v200
    v_mfma_f32_16x16x32_bf16 v[204:207], a[228:231], a[20:23], v[204:207]
    ds_read_b64_tr_b16 v[218:219], v225 offset:55296
    v_mfma_f32_16x16x32_bf16 v[204:207], a[232:235], a[24:27], v[204:207]
    v_exp_f32 v201, v201
    v_mfma_f32_16x16x32_bf16 v[204:207], a[236:239], a[28:31], v[204:207]
    s_waitcnt lgkmcnt(7)
    v_exp_f32 v202, v202
    v_mfma_f32_16x16x32_bf16 v[16:19], v[208:211], v[180:183], v[16:19]
    v_exp_f32 v203, v203
    v_mfma_f32_16x16x32_bf16 v[48:51], v[208:211], v[184:187], v[48:51]
    v_cvt_pk_bf16_f32 v162, v200, v201
    v_cvt_pk_bf16_f32 v163, v202, v203
    v_mfma_f32_16x16x32_bf16 v[80:83], v[208:211], v[188:191], v[80:83]
    v_mfma_f32_16x16x32_bf16 v[112:115], v[208:211], v[192:195], v[112:115]
    ds_read_b64_tr_b16 v[220:221], v225 offset:53256
    v_smfmac_f32_16x16x64_bf16 a[244:247], a[252:255], v[188:195], v233
    ds_read_b64_tr_b16 v[222:223], v225 offset:55304
    v_mfma_f32_16x16x32_bf16 v[200:203], a[132:135], a[32:35], 0
    v_exp_f32 v204, v204
    v_mfma_f32_16x16x32_bf16 v[200:203], a[228:231], a[36:39], v[200:203]
    v_exp_f32 v205, v205
    v_mfma_f32_16x16x32_bf16 v[200:203], a[232:235], a[40:43], v[200:203]
    v_exp_f32 v206, v206
    v_mfma_f32_16x16x32_bf16 v[200:203], a[236:239], a[44:47], v[200:203]
    s_waitcnt lgkmcnt(5)
    v_exp_f32 v207, v207
    v_mfma_f32_16x16x32_bf16 v[20:23], v[212:215], v[180:183], v[20:23]
    v_cvt_pk_bf16_f32 v166, v204, v205
    v_cvt_pk_bf16_f32 v167, v206, v207
    v_mfma_f32_16x16x32_bf16 v[52:55], v[212:215], v[184:187], v[52:55]
    v_mfma_f32_16x16x32_bf16 v[84:87], v[212:215], v[188:191], v[84:87]
    v_mfma_f32_16x16x32_bf16 v[116:119], v[212:215], v[192:195], v[116:119]
    ds_read_b64_tr_b16 v[208:209], v224 offset:24576
    v_mfma_f32_16x16x32_bf16 v[204:207], a[132:135], a[48:51], 0
    v_exp_f32 v200, v200
    v_mfma_f32_16x16x32_bf16 v[204:207], a[228:231], a[52:55], v[204:207]
    ds_read_b64_tr_b16 v[210:211], v224 offset:26624
    v_mfma_f32_16x16x32_bf16 v[204:207], a[232:235], a[56:59], v[204:207]
    v_exp_f32 v201, v201
    v_mfma_f32_16x16x32_bf16 v[204:207], a[236:239], a[60:63], v[204:207]
    s_waitcnt lgkmcnt(4)
    ds_read_b128 a[228:231], v229 offset:28672
    v_cvt_pk_bf16_f32 v170, v200, v201
    v_mfma_f32_16x16x32_bf16 v[24:27], v[216:219], v[180:183], v[24:27]
    v_exp_f32 v202, v202
    v_mfma_f32_16x16x32_bf16 v[56:59], v[216:219], v[184:187], v[56:59]
    ds_read_b128 a[232:235], v235 offset:28672
    v_mfma_f32_16x16x32_bf16 v[88:91], v[216:219], v[188:191], v[88:91]
    v_exp_f32 v203, v203
    v_mfma_f32_16x16x32_bf16 v[120:123], v[216:219], v[192:195], v[120:123]
    ds_read_b64_tr_b16 v[212:213], v224 offset:24584
    v_cvt_pk_bf16_f32 v171, v202, v203
    v_mfma_f32_16x16x32_bf16 v[200:203], a[136:139], a[0:3], 0
    v_exp_f32 v204, v204
    v_mfma_f32_16x16x32_bf16 v[200:203], a[212:215], a[4:7], v[200:203]
    ds_read_b64_tr_b16 v[214:215], v224 offset:26632
    v_mfma_f32_16x16x32_bf16 v[200:203], a[216:219], a[8:11], v[200:203]
    v_exp_f32 v205, v205
    v_mfma_f32_16x16x32_bf16 v[200:203], a[220:223], a[12:15], v[200:203]
    s_waitcnt lgkmcnt(6)
    ds_read_b128 a[236:239], v231 offset:28672
    v_cvt_pk_bf16_f32 v174, v204, v205
    v_mfma_f32_16x16x32_bf16 v[28:31], v[220:223], v[180:183], v[28:31]
    v_exp_f32 v206, v206
    v_mfma_f32_16x16x32_bf16 v[60:63], v[220:223], v[184:187], v[60:63]
    v_exp_f32 v207, v207
    v_mfma_f32_16x16x32_bf16 v[92:95], v[220:223], v[188:191], v[92:95]
    v_cvt_pk_bf16_f32 v175, v206, v207
    v_mfma_f32_16x16x32_bf16 v[124:127], v[220:223], v[192:195], v[124:127]
    ds_read_b64_tr_b16 v[216:217], v225 offset:24576
    v_mfma_f32_16x16x32_bf16 v[204:207], a[136:139], a[16:19], 0
    v_exp_f32 v200, v200
    v_mfma_f32_16x16x32_bf16 v[204:207], a[212:215], a[20:23], v[204:207]
    ds_read_b64_tr_b16 v[218:219], v225 offset:26624
    v_mfma_f32_16x16x32_bf16 v[204:207], a[216:219], a[24:27], v[204:207]
    v_exp_f32 v201, v201
    v_mfma_f32_16x16x32_bf16 v[204:207], a[220:223], a[28:31], v[204:207]
    s_waitcnt lgkmcnt(7)
    v_exp_f32 v202, v202
    v_mfma_f32_16x16x32_bf16 v[0:3], v[208:211], v[160:163], v[0:3]
    v_exp_f32 v203, v203
    v_mfma_f32_16x16x32_bf16 v[32:35], v[208:211], v[164:167], v[32:35]
    v_cvt_pk_bf16_f32 v180, v200, v201
    v_cvt_pk_bf16_f32 v181, v202, v203
    v_mfma_f32_16x16x32_bf16 v[64:67], v[208:211], v[168:171], v[64:67]
    v_mfma_f32_16x16x32_bf16 v[96:99], v[208:211], v[172:175], v[96:99]
    ds_read_b64_tr_b16 v[220:221], v225 offset:24584
    v_smfmac_f32_16x16x64_bf16 a[240:243], a[252:255], v[160:167], v233
    ds_read_b64_tr_b16 v[222:223], v225 offset:26632
    v_mfma_f32_16x16x32_bf16 v[200:203], a[136:139], a[32:35], 0
    v_exp_f32 v204, v204
    v_mfma_f32_16x16x32_bf16 v[200:203], a[212:215], a[36:39], v[200:203]
    v_exp_f32 v205, v205
    v_mfma_f32_16x16x32_bf16 v[200:203], a[216:219], a[40:43], v[200:203]
    v_exp_f32 v206, v206
    v_mfma_f32_16x16x32_bf16 v[200:203], a[220:223], a[44:47], v[200:203]
    s_waitcnt lgkmcnt(5)
    v_exp_f32 v207, v207
    v_mfma_f32_16x16x32_bf16 v[4:7], v[212:215], v[160:163], v[4:7]
    v_cvt_pk_bf16_f32 v184, v204, v205
    v_cvt_pk_bf16_f32 v185, v206, v207
    v_mfma_f32_16x16x32_bf16 v[36:39], v[212:215], v[164:167], v[36:39]
    v_mfma_f32_16x16x32_bf16 v[68:71], v[212:215], v[168:171], v[68:71]
    v_mfma_f32_16x16x32_bf16 v[100:103], v[212:215], v[172:175], v[100:103]
    ds_read_b64_tr_b16 v[208:209], v224 offset:57344
    v_mfma_f32_16x16x32_bf16 v[204:207], a[136:139], a[48:51], 0
    v_exp_f32 v200, v200
    v_mfma_f32_16x16x32_bf16 v[204:207], a[212:215], a[52:55], v[204:207]
    ds_read_b64_tr_b16 v[210:211], v224 offset:59392
    v_mfma_f32_16x16x32_bf16 v[204:207], a[216:219], a[56:59], v[204:207]
    v_exp_f32 v201, v201
    v_mfma_f32_16x16x32_bf16 v[204:207], a[220:223], a[60:63], v[204:207]
    s_waitcnt lgkmcnt(4)
    s_barrier
    ds_read_b128 a[212:215], v229 offset:0
    v_cvt_pk_bf16_f32 v188, v200, v201
    v_mfma_f32_16x16x32_bf16 v[8:11], v[216:219], v[160:163], v[8:11]
    v_exp_f32 v202, v202
    v_mfma_f32_16x16x32_bf16 v[40:43], v[216:219], v[164:167], v[40:43]
    ds_write_b64 v228, a[160:161] offset:16384
    v_mfma_f32_16x16x32_bf16 v[72:75], v[216:219], v[168:171], v[72:75]
    v_exp_f32 v203, v203
    v_mfma_f32_16x16x32_bf16 v[104:107], v[216:219], v[172:175], v[104:107]
    ds_read_b64_tr_b16 v[212:213], v224 offset:57352
    v_cvt_pk_bf16_f32 v189, v202, v203
    v_mfma_f32_16x16x32_bf16 v[200:203], a[140:143], a[0:3], 0
    v_exp_f32 v204, v204
    v_mfma_f32_16x16x32_bf16 v[200:203], a[228:231], a[4:7], v[200:203]
    ds_write_b64 v228, a[162:163] offset:16392
    v_mfma_f32_16x16x32_bf16 v[200:203], a[232:235], a[8:11], v[200:203]
    v_exp_f32 v205, v205
    v_mfma_f32_16x16x32_bf16 v[200:203], a[236:239], a[12:15], v[200:203]
    s_waitcnt lgkmcnt(6)
    ds_read_b64_tr_b16 v[214:215], v224 offset:59400
    v_cvt_pk_bf16_f32 v192, v204, v205
    v_mfma_f32_16x16x32_bf16 v[12:15], v[220:223], v[160:163], v[12:15]
    v_exp_f32 v206, v206
    v_mfma_f32_16x16x32_bf16 v[44:47], v[220:223], v[164:167], v[44:47]
    ds_write_b64 v228, a[164:165] offset:20480
    v_mfma_f32_16x16x32_bf16 v[76:79], v[220:223], v[168:171], v[76:79]
    v_exp_f32 v207, v207
    v_mfma_f32_16x16x32_bf16 v[108:111], v[220:223], v[172:175], v[108:111]
    ds_read_b64_tr_b16 v[216:217], v225 offset:57344
    v_cvt_pk_bf16_f32 v193, v206, v207
    v_mfma_f32_16x16x32_bf16 v[204:207], a[140:143], a[16:19], 0
    v_exp_f32 v200, v200
    v_mfma_f32_16x16x32_bf16 v[204:207], a[228:231], a[20:23], v[204:207]
    ds_write_b64 v228, a[166:167] offset:20488
    v_mfma_f32_16x16x32_bf16 v[204:207], a[232:235], a[24:27], v[204:207]
    v_exp_f32 v201, v201
    v_mfma_f32_16x16x32_bf16 v[204:207], a[236:239], a[28:31], v[204:207]
    s_waitcnt lgkmcnt(8)
    ds_read_b64_tr_b16 v[218:219], v225 offset:59392
    v_cvt_pk_bf16_f32 v182, v200, v201
    v_mfma_f32_16x16x32_bf16 v[16:19], v[208:211], v[160:163], v[16:19]
    v_exp_f32 v202, v202
    v_mfma_f32_16x16x32_bf16 v[48:51], v[208:211], v[164:167], v[48:51]
    ds_write_b64 v228, a[168:169] offset:24576
    v_mfma_f32_16x16x32_bf16 v[80:83], v[208:211], v[168:171], v[80:83]
    v_exp_f32 v203, v203
    v_mfma_f32_16x16x32_bf16 v[112:115], v[208:211], v[172:175], v[112:115]
    ds_read_b128 a[216:219], v235 offset:0
    v_cvt_pk_bf16_f32 v183, v202, v203
    v_smfmac_f32_16x16x64_bf16 a[244:247], a[252:255], v[168:175], v233
    ds_write_b64 v228, a[170:171] offset:24584
    v_mfma_f32_16x16x32_bf16 v[200:203], a[140:143], a[32:35], 0
    v_exp_f32 v204, v204
    v_mfma_f32_16x16x32_bf16 v[200:203], a[228:231], a[36:39], v[200:203]
    ds_write_b64 v228, a[172:173] offset:28672
    v_mfma_f32_16x16x32_bf16 v[200:203], a[232:235], a[40:43], v[200:203]
    v_exp_f32 v205, v205
    v_mfma_f32_16x16x32_bf16 v[200:203], a[236:239], a[44:47], v[200:203]
    s_waitcnt lgkmcnt(8)
    ds_read_b128 a[220:223], v231 offset:0
    v_cvt_pk_bf16_f32 v186, v204, v205
    v_mfma_f32_16x16x32_bf16 v[20:23], v[212:215], v[160:163], v[20:23]
    v_exp_f32 v206, v206
    v_mfma_f32_16x16x32_bf16 v[52:55], v[212:215], v[164:167], v[52:55]
    ds_write_b64 v228, a[174:175] offset:28680
    v_mfma_f32_16x16x32_bf16 v[84:87], v[212:215], v[168:171], v[84:87]
    v_exp_f32 v207, v207
    v_mfma_f32_16x16x32_bf16 v[116:119], v[212:215], v[172:175], v[116:119]
    ds_read_b64_tr_b16 v[220:221], v225 offset:57352
    v_cvt_pk_bf16_f32 v187, v206, v207
    v_mfma_f32_16x16x32_bf16 v[204:207], a[140:143], a[48:51], 0
    v_exp_f32 v200, v200
    v_mfma_f32_16x16x32_bf16 v[204:207], a[228:231], a[52:55], v[204:207]
    ds_read_b64_tr_b16 v[222:223], v225 offset:59400
    v_mfma_f32_16x16x32_bf16 v[204:207], a[232:235], a[56:59], v[204:207]
    v_exp_f32 v201, v201
    v_mfma_f32_16x16x32_bf16 v[204:207], a[236:239], a[60:63], v[204:207]
    s_waitcnt lgkmcnt(8)
    ds_read_b64_tr_b16 v[208:209], v224 offset:28672
    v_cvt_pk_bf16_f32 v190, v200, v201
    v_mfma_f32_16x16x32_bf16 v[24:27], v[216:219], v[160:163], v[24:27]
    v_exp_f32 v202, v202
    v_mfma_f32_16x16x32_bf16 v[56:59], v[216:219], v[164:167], v[56:59]
    ds_read_b64_tr_b16 v[210:211], v224 offset:30720
    v_mfma_f32_16x16x32_bf16 v[88:91], v[216:219], v[168:171], v[88:91]
    v_exp_f32 v203, v203
    v_mfma_f32_16x16x32_bf16 v[120:123], v[216:219], v[172:175], v[120:123]
    ds_read_b64_tr_b16 v[212:213], v224 offset:28680
    v_cvt_pk_bf16_f32 v191, v202, v203
    v_mfma_f32_16x16x32_bf16 v[200:203], a[144:147], a[0:3], 0
    v_exp_f32 v204, v204
    v_mfma_f32_16x16x32_bf16 v[200:203], a[212:215], a[4:7], v[200:203]
    s_waitcnt lgkmcnt(9)
    ds_read_b64_tr_b16 v[214:215], v224 offset:30728
    v_mfma_f32_16x16x32_bf16 v[200:203], a[216:219], a[8:11], v[200:203]
    s_waitcnt lgkmcnt(7)
    v_exp_f32 v205, v205
    v_mfma_f32_16x16x32_bf16 v[200:203], a[220:223], a[12:15], v[200:203]
    s_waitcnt lgkmcnt(4)
    ds_read_b128 a[228:231], v229 offset:4096
    v_cvt_pk_bf16_f32 v194, v204, v205
    v_mfma_f32_16x16x32_bf16 v[28:31], v[220:223], v[160:163], v[28:31]
    v_exp_f32 v206, v206
    v_mfma_f32_16x16x32_bf16 v[60:63], v[220:223], v[164:167], v[60:63]
    ds_read_b128 a[232:235], v235 offset:4096
    v_mfma_f32_16x16x32_bf16 v[92:95], v[220:223], v[168:171], v[92:95]
    v_exp_f32 v207, v207
    v_mfma_f32_16x16x32_bf16 v[124:127], v[220:223], v[172:175], v[124:127]
    ds_read_b64_tr_b16 v[216:217], v225 offset:28672
    v_cvt_pk_bf16_f32 v195, v206, v207
    v_mfma_f32_16x16x32_bf16 v[204:207], a[144:147], a[16:19], 0
    v_exp_f32 v200, v200
    v_mfma_f32_16x16x32_bf16 v[204:207], a[212:215], a[20:23], v[204:207]
    ds_read_b64_tr_b16 v[218:219], v225 offset:30720
    v_mfma_f32_16x16x32_bf16 v[204:207], a[216:219], a[24:27], v[204:207]
    v_exp_f32 v201, v201
    v_mfma_f32_16x16x32_bf16 v[204:207], a[220:223], a[28:31], v[204:207]
    s_waitcnt lgkmcnt(6)
    ds_read_b128 a[236:239], v231 offset:4096
    v_cvt_pk_bf16_f32 v160, v200, v201
    v_mfma_f32_16x16x32_bf16 v[0:3], v[208:211], v[180:183], v[0:3]
    v_exp_f32 v202, v202
    v_mfma_f32_16x16x32_bf16 v[32:35], v[208:211], v[184:187], v[32:35]
    v_exp_f32 v203, v203
    v_mfma_f32_16x16x32_bf16 v[64:67], v[208:211], v[188:191], v[64:67]
    v_cvt_pk_bf16_f32 v161, v202, v203
    v_mfma_f32_16x16x32_bf16 v[96:99], v[208:211], v[192:195], v[96:99]
    ds_read_b64_tr_b16 v[220:221], v225 offset:28680
    v_smfmac_f32_16x16x64_bf16 a[240:243], a[252:255], v[180:187], v233
    ds_read_b64_tr_b16 v[222:223], v225 offset:30728
    v_mfma_f32_16x16x32_bf16 v[200:203], a[144:147], a[32:35], 0
    v_exp_f32 v204, v204
    v_mfma_f32_16x16x32_bf16 v[200:203], a[212:215], a[36:39], v[200:203]
    v_exp_f32 v205, v205
    v_mfma_f32_16x16x32_bf16 v[200:203], a[216:219], a[40:43], v[200:203]
    v_exp_f32 v206, v206
    v_mfma_f32_16x16x32_bf16 v[200:203], a[220:223], a[44:47], v[200:203]
    s_waitcnt lgkmcnt(7)
    v_exp_f32 v207, v207
    v_mfma_f32_16x16x32_bf16 v[4:7], v[212:215], v[180:183], v[4:7]
    v_cvt_pk_bf16_f32 v164, v204, v205
    v_cvt_pk_bf16_f32 v165, v206, v207
    v_mfma_f32_16x16x32_bf16 v[36:39], v[212:215], v[184:187], v[36:39]
    v_mfma_f32_16x16x32_bf16 v[68:71], v[212:215], v[188:191], v[68:71]
    v_mfma_f32_16x16x32_bf16 v[100:103], v[212:215], v[192:195], v[100:103]
    ds_read_b64_tr_b16 v[208:209], v224 offset:61440
    v_mfma_f32_16x16x32_bf16 v[204:207], a[144:147], a[48:51], 0
    v_exp_f32 v200, v200
    v_mfma_f32_16x16x32_bf16 v[204:207], a[212:215], a[52:55], v[204:207]
    ds_read_b64_tr_b16 v[210:211], v224 offset:63488
    v_mfma_f32_16x16x32_bf16 v[204:207], a[216:219], a[56:59], v[204:207]
    v_exp_f32 v201, v201
    v_mfma_f32_16x16x32_bf16 v[204:207], a[220:223], a[60:63], v[204:207]
    s_waitcnt lgkmcnt(5)
    ds_read_b128 a[212:215], v229 offset:8192
    v_cvt_pk_bf16_f32 v168, v200, v201
    v_mfma_f32_16x16x32_bf16 v[8:11], v[216:219], v[180:183], v[8:11]
    v_exp_f32 v202, v202
    v_mfma_f32_16x16x32_bf16 v[40:43], v[216:219], v[184:187], v[40:43]
    ds_read_b128 a[216:219], v235 offset:8192
    v_mfma_f32_16x16x32_bf16 v[72:75], v[216:219], v[188:191], v[72:75]
    v_exp_f32 v203, v203
    v_mfma_f32_16x16x32_bf16 v[104:107], v[216:219], v[192:195], v[104:107]
    ds_read_b64_tr_b16 v[212:213], v224 offset:61448
    v_cvt_pk_bf16_f32 v169, v202, v203
    v_mfma_f32_16x16x32_bf16 v[200:203], a[148:151], a[0:3], 0
    v_exp_f32 v204, v204
    v_mfma_f32_16x16x32_bf16 v[200:203], a[228:231], a[4:7], v[200:203]
    ds_read_b64_tr_b16 v[214:215], v224 offset:63496
    v_xor_b32 v224, 0x10000, v224
    v_mfma_f32_16x16x32_bf16 v[200:203], a[232:235], a[8:11], v[200:203]
    s_waitcnt lgkmcnt(8)
    v_exp_f32 v205, v205
    v_mfma_f32_16x16x32_bf16 v[200:203], a[236:239], a[12:15], v[200:203]
    s_waitcnt lgkmcnt(6)
    ds_read_b128 a[220:223], v231 offset:8192
    v_cvt_pk_bf16_f32 v172, v204, v205
    v_mfma_f32_16x16x32_bf16 v[12:15], v[220:223], v[180:183], v[12:15]
    v_exp_f32 v206, v206
    v_mfma_f32_16x16x32_bf16 v[44:47], v[220:223], v[184:187], v[44:47]
    v_exp_f32 v207, v207
    v_mfma_f32_16x16x32_bf16 v[76:79], v[220:223], v[188:191], v[76:79]
    v_cvt_pk_bf16_f32 v173, v206, v207
    v_mfma_f32_16x16x32_bf16 v[108:111], v[220:223], v[192:195], v[108:111]
    ds_read_b64_tr_b16 v[216:217], v225 offset:61440
    v_mfma_f32_16x16x32_bf16 v[204:207], a[148:151], a[16:19], 0
    v_exp_f32 v200, v200
    v_mfma_f32_16x16x32_bf16 v[204:207], a[228:231], a[20:23], v[204:207]
    ds_read_b64_tr_b16 v[218:219], v225 offset:63488
    v_mfma_f32_16x16x32_bf16 v[204:207], a[232:235], a[24:27], v[204:207]
    v_exp_f32 v201, v201
    v_mfma_f32_16x16x32_bf16 v[204:207], a[236:239], a[28:31], v[204:207]
    s_waitcnt lgkmcnt(7)
    v_exp_f32 v202, v202
    v_mfma_f32_16x16x32_bf16 v[16:19], v[208:211], v[180:183], v[16:19]
    v_exp_f32 v203, v203
    v_mfma_f32_16x16x32_bf16 v[48:51], v[208:211], v[184:187], v[48:51]
    v_cvt_pk_bf16_f32 v162, v200, v201
    v_cvt_pk_bf16_f32 v163, v202, v203
    v_mfma_f32_16x16x32_bf16 v[80:83], v[208:211], v[188:191], v[80:83]
    v_mfma_f32_16x16x32_bf16 v[112:115], v[208:211], v[192:195], v[112:115]
    ds_read_b64_tr_b16 v[220:221], v225 offset:61448
    v_smfmac_f32_16x16x64_bf16 a[244:247], a[252:255], v[188:195], v233
    ds_read_b64_tr_b16 v[222:223], v225 offset:63496
    v_xor_b32 v225, 0x10000, v225
    v_mfma_f32_16x16x32_bf16 v[200:203], a[148:151], a[32:35], 0
    v_exp_f32 v204, v204
    v_mfma_f32_16x16x32_bf16 v[200:203], a[228:231], a[36:39], v[200:203]
    v_exp_f32 v205, v205
    v_mfma_f32_16x16x32_bf16 v[200:203], a[232:235], a[40:43], v[200:203]
    v_exp_f32 v206, v206
    v_mfma_f32_16x16x32_bf16 v[200:203], a[236:239], a[44:47], v[200:203]
    s_waitcnt lgkmcnt(5)
    v_exp_f32 v207, v207
    v_mfma_f32_16x16x32_bf16 v[20:23], v[212:215], v[180:183], v[20:23]
    v_cvt_pk_bf16_f32 v166, v204, v205
    v_cvt_pk_bf16_f32 v167, v206, v207
    v_mfma_f32_16x16x32_bf16 v[52:55], v[212:215], v[184:187], v[52:55]
    v_mfma_f32_16x16x32_bf16 v[84:87], v[212:215], v[188:191], v[84:87]
    v_mfma_f32_16x16x32_bf16 v[116:119], v[212:215], v[192:195], v[116:119]
    ds_read_b64_tr_b16 v[208:209], v224 offset:0
    v_mfma_f32_16x16x32_bf16 v[204:207], a[148:151], a[48:51], 0
    v_exp_f32 v200, v200
    v_mfma_f32_16x16x32_bf16 v[204:207], a[228:231], a[52:55], v[204:207]
    ds_read_b64_tr_b16 v[210:211], v224 offset:2048
    v_mfma_f32_16x16x32_bf16 v[204:207], a[232:235], a[56:59], v[204:207]
    v_exp_f32 v201, v201
    v_mfma_f32_16x16x32_bf16 v[204:207], a[236:239], a[60:63], v[204:207]
    s_waitcnt lgkmcnt(4)
    ds_read_b128 a[228:231], v229 offset:12288
    v_cvt_pk_bf16_f32 v170, v200, v201
    v_mfma_f32_16x16x32_bf16 v[24:27], v[216:219], v[180:183], v[24:27]
    v_exp_f32 v202, v202
    v_mfma_f32_16x16x32_bf16 v[56:59], v[216:219], v[184:187], v[56:59]
    ds_read_b128 a[232:235], v235 offset:12288
    v_mfma_f32_16x16x32_bf16 v[88:91], v[216:219], v[188:191], v[88:91]
    v_exp_f32 v203, v203
    v_mfma_f32_16x16x32_bf16 v[120:123], v[216:219], v[192:195], v[120:123]
    ds_read_b64_tr_b16 v[212:213], v224 offset:8
    v_cvt_pk_bf16_f32 v171, v202, v203
    v_mfma_f32_16x16x32_bf16 v[200:203], a[152:155], a[0:3], 0
    v_exp_f32 v204, v204
    v_mfma_f32_16x16x32_bf16 v[200:203], a[212:215], a[4:7], v[200:203]
    ds_read_b64_tr_b16 v[214:215], v224 offset:2056
    v_mfma_f32_16x16x32_bf16 v[200:203], a[216:219], a[8:11], v[200:203]
    v_exp_f32 v205, v205
    v_mfma_f32_16x16x32_bf16 v[200:203], a[220:223], a[12:15], v[200:203]
    s_waitcnt lgkmcnt(6)
    ds_read_b128 a[236:239], v231 offset:12288
    v_cvt_pk_bf16_f32 v174, v204, v205
    v_mfma_f32_16x16x32_bf16 v[28:31], v[220:223], v[180:183], v[28:31]
L_pad12:
    s_cbranch_vccnz L_back
    v_exp_f32 v206, v206
    v_mfma_f32_16x16x32_bf16 v[60:63], v[220:223], v[184:187], v[60:63]
    v_exp_f32 v207, v207
    v_mfma_f32_16x16x32_bf16 v[92:95], v[220:223], v[188:191], v[92:95]
    v_cvt_pk_bf16_f32 v175, v206, v207
    v_mfma_f32_16x16x32_bf16 v[124:127], v[220:223], v[192:195], v[124:127]
    ds_read_b64_tr_b16 v[216:217], v225 offset:0
    v_mfma_f32_16x16x32_bf16 v[204:207], a[152:155], a[16:19], 0
    v_exp_f32 v200, v200
    v_mfma_f32_16x16x32_bf16 v[204:207], a[212:215], a[20:23], v[204:207]
    ds_read_b64_tr_b16 v[218:219], v225 offset:2048
    v_mfma_f32_16x16x32_bf16 v[204:207], a[216:219], a[24:27], v[204:207]
    v_exp_f32 v201, v201
    v_mfma_f32_16x16x32_bf16 v[204:207], a[220:223], a[28:31], v[204:207]
    s_waitcnt lgkmcnt(7)
    v_exp_f32 v202, v202
    v_mfma_f32_16x16x32_bf16 v[0:3], v[208:211], v[160:163], v[0:3]
    v_exp_f32 v203, v203
    v_mfma_f32_16x16x32_bf16 v[32:35], v[208:211], v[164:167], v[32:35]
    v_cvt_pk_bf16_f32 v180, v200, v201
    v_cvt_pk_bf16_f32 v181, v202, v203
    v_mfma_f32_16x16x32_bf16 v[64:67], v[208:211], v[168:171], v[64:67]
    v_mfma_f32_16x16x32_bf16 v[96:99], v[208:211], v[172:175], v[96:99]
    ds_read_b64_tr_b16 v[220:221], v225 offset:8
    v_smfmac_f32_16x16x64_bf16 a[240:243], a[252:255], v[160:167], v233
    ds_read_b64_tr_b16 v[222:223], v225 offset:2056
    v_mfma_f32_16x16x32_bf16 v[200:203], a[152:155], a[32:35], 0
    v_exp_f32 v204, v204
    v_mfma_f32_16x16x32_bf16 v[200:203], a[212:215], a[36:39], v[200:203]
    v_exp_f32 v205, v205
    v_mfma_f32_16x16x32_bf16 v[200:203], a[216:219], a[40:43], v[200:203]
    v_exp_f32 v206, v206
    v_mfma_f32_16x16x32_bf16 v[200:203], a[220:223], a[44:47], v[200:203]
    s_waitcnt lgkmcnt(5)
    v_exp_f32 v207, v207
    v_mfma_f32_16x16x32_bf16 v[4:7], v[212:215], v[160:163], v[4:7]
    v_cvt_pk_bf16_f32 v184, v204, v205
    v_cvt_pk_bf16_f32 v185, v206, v207
    v_mfma_f32_16x16x32_bf16 v[36:39], v[212:215], v[164:167], v[36:39]
    v_mfma_f32_16x16x32_bf16 v[68:71], v[212:215], v[168:171], v[68:71]
    v_mfma_f32_16x16x32_bf16 v[100:103], v[212:215], v[172:175], v[100:103]
    ds_read_b64_tr_b16 v[208:209], v224 offset:32768
    v_mfma_f32_16x16x32_bf16 v[204:207], a[152:155], a[48:51], 0
    v_exp_f32 v200, v200
    v_mfma_f32_16x16x32_bf16 v[204:207], a[212:215], a[52:55], v[204:207]
    ds_read_b64_tr_b16 v[210:211], v224 offset:34816
    v_mfma_f32_16x16x32_bf16 v[204:207], a[216:219], a[56:59], v[204:207]
    v_exp_f32 v201, v201
    v_mfma_f32_16x16x32_bf16 v[204:207], a[220:223], a[60:63], v[204:207]
    s_waitcnt lgkmcnt(4)
    s_barrier
    ds_read_b128 a[212:215], v229 offset:16384
    v_cvt_pk_bf16_f32 v188, v200, v201
    v_mfma_f32_16x16x32_bf16 v[8:11], v[216:219], v[160:163], v[8:11]
    v_exp_f32 v202, v202
    v_mfma_f32_16x16x32_bf16 v[40:43], v[216:219], v[164:167], v[40:43]
    ds_write_b64 v228, a[176:177] offset:0
    v_mfma_f32_16x16x32_bf16 v[72:75], v[216:219], v[168:171], v[72:75]
    v_exp_f32 v203, v203
    v_mfma_f32_16x16x32_bf16 v[104:107], v[216:219], v[172:175], v[104:107]
    ds_read_b64_tr_b16 v[212:213], v224 offset:32776
    v_cvt_pk_bf16_f32 v189, v202, v203
    v_mfma_f32_16x16x32_bf16 v[200:203], a[156:159], a[0:3], 0
    v_exp_f32 v204, v204
    v_mfma_f32_16x16x32_bf16 v[200:203], a[228:231], a[4:7], v[200:203]
    ds_write_b64 v228, a[178:179] offset:8
    v_mfma_f32_16x16x32_bf16 v[200:203], a[232:235], a[8:11], v[200:203]
    v_exp_f32 v205, v205
    v_mfma_f32_16x16x32_bf16 v[200:203], a[236:239], a[12:15], v[200:203]
    s_waitcnt lgkmcnt(6)
    ds_read_b64_tr_b16 v[214:215], v224 offset:34824
    v_cvt_pk_bf16_f32 v192, v204, v205
    v_mfma_f32_16x16x32_bf16 v[12:15], v[220:223], v[160:163], v[12:15]
    v_exp_f32 v206, v206
    v_mfma_f32_16x16x32_bf16 v[44:47], v[220:223], v[164:167], v[44:47]
    ds_write_b64 v228, a[180:181] offset:4096
    v_mfma_f32_16x16x32_bf16 v[76:79], v[220:223], v[168:171], v[76:79]
    v_exp_f32 v207, v207
    v_mfma_f32_16x16x32_bf16 v[108:111], v[220:223], v[172:175], v[108:111]
    ds_read_b64_tr_b16 v[216:217], v225 offset:32768
    v_cvt_pk_bf16_f32 v193, v206, v207
    v_mfma_f32_16x16x32_bf16 v[204:207], a[156:159], a[16:19], 0
    v_exp_f32 v200, v200
    v_mfma_f32_16x16x32_bf16 v[204:207], a[228:231], a[20:23], v[204:207]
    ds_write_b64 v228, a[182:183] offset:4104
    v_mfma_f32_16x16x32_bf16 v[204:207], a[232:235], a[24:27], v[204:207]
    v_exp_f32 v201, v201
    v_mfma_f32_16x16x32_bf16 v[204:207], a[236:239], a[28:31], v[204:207]
    s_waitcnt lgkmcnt(8)
    ds_read_b64_tr_b16 v[218:219], v225 offset:34816
    v_cvt_pk_bf16_f32 v182, v200, v201
    v_mfma_f32_16x16x32_bf16 v[16:19], v[208:211], v[160:163], v[16:19]
    v_exp_f32 v202, v202
    v_mfma_f32_16x16x32_bf16 v[48:51], v[208:211], v[164:167], v[48:51]
    ds_write_b64 v228, a[184:185] offset:8192
    v_mfma_f32_16x16x32_bf16 v[80:83], v[208:211], v[168:171], v[80:83]
    v_exp_f32 v203, v203
    v_mfma_f32_16x16x32_bf16 v[112:115], v[208:211], v[172:175], v[112:115]
    ds_read_b128 a[216:219], v235 offset:16384
    v_cvt_pk_bf16_f32 v183, v202, v203
    v_smfmac_f32_16x16x64_bf16 a[244:247], a[252:255], v[168:175], v233
    ds_write_b64 v228, a[186:187] offset:8200
    v_mfma_f32_16x16x32_bf16 v[200:203], a[156:159], a[32:35], 0
    v_exp_f32 v204, v204
    v_mfma_f32_16x16x32_bf16 v[200:203], a[228:231], a[36:39], v[200:203]
    ds_write_b64 v228, a[188:189] offset:12288
    v_mfma_f32_16x16x32_bf16 v[200:203], a[232:235], a[40:43], v[200:203]
    v_exp_f32 v205, v205
    v_mfma_f32_16x16x32_bf16 v[200:203], a[236:239], a[44:47], v[200:203]
    s_waitcnt lgkmcnt(8)
    ds_read_b128 a[220:223], v231 offset:16384
    v_cvt_pk_bf16_f32 v186, v204, v205
    v_mfma_f32_16x16x32_bf16 v[20:23], v[212:215], v[160:163], v[20:23]
    v_exp_f32 v206, v206
    v_mfma_f32_16x16x32_bf16 v[52:55], v[212:215], v[164:167], v[52:55]
    ds_write_b64 v228, a[190:191] offset:12296
    v_mfma_f32_16x16x32_bf16 v[84:87], v[212:215], v[168:171], v[84:87]
    v_exp_f32 v207, v207
    v_mfma_f32_16x16x32_bf16 v[116:119], v[212:215], v[172:175], v[116:119]
    ds_read_b64_tr_b16 v[220:221], v225 offset:32776
    v_cvt_pk_bf16_f32 v187, v206, v207
    v_mfma_f32_16x16x32_bf16 v[204:207], a[156:159], a[48:51], 0
    v_exp_f32 v200, v200
    v_mfma_f32_16x16x32_bf16 v[204:207], a[228:231], a[52:55], v[204:207]
    ds_read_b64_tr_b16 v[222:223], v225 offset:34824
    v_mfma_f32_16x16x32_bf16 v[204:207], a[232:235], a[56:59], v[204:207]
    v_exp_f32 v201, v201
    v_mfma_f32_16x16x32_bf16 v[204:207], a[236:239], a[60:63], v[204:207]
    s_waitcnt lgkmcnt(8)
    ds_read_b64_tr_b16 v[208:209], v224 offset:4096
    v_cvt_pk_bf16_f32 v190, v200, v201
    v_mfma_f32_16x16x32_bf16 v[24:27], v[216:219], v[160:163], v[24:27]
    v_exp_f32 v202, v202
    v_mfma_f32_16x16x32_bf16 v[56:59], v[216:219], v[164:167], v[56:59]
    ds_read_b64_tr_b16 v[210:211], v224 offset:6144
    v_mfma_f32_16x16x32_bf16 v[88:91], v[216:219], v[168:171], v[88:91]
    v_exp_f32 v203, v203
    v_mfma_f32_16x16x32_bf16 v[120:123], v[216:219], v[172:175], v[120:123]
    ds_read_b64_tr_b16 v[212:213], v224 offset:4104
    v_cvt_pk_bf16_f32 v191, v202, v203
    v_mfma_f32_16x16x32_bf16 v[200:203], a[160:163], a[0:3], 0
    s_branch L_loop
L_tail:
    v_exp_f32 v204, v204
    v_mfma_f32_16x16x32_bf16 v[200:203], a[212:215], a[36:39], v[200:203]
    s_waitcnt vmcnt(7)
    s_lshl_b32 s45, s24, 12
    s_add_u32 s45, s45, 131072
    ds_read_b64_tr_b16 v[214:215], v224 offset:30728
    v_mbcnt_lo_u32_b32 v178, -1, 0
    v_mfma_f32_16x16x32_bf16 v[200:203], a[216:219], a[40:43], v[200:203]
    v_exp_f32 v205, v205
    v_mfma_f32_16x16x32_bf16 v[200:203], a[220:223], a[44:47], v[200:203]
    s_waitcnt lgkmcnt(7)
    ds_read_b128 a[236:239], v231 offset:4096
    v_cvt_pk_bf16_f32 v194, v204, v205
    v_mfma_f32_16x16x32_bf16 v[28:31], v[220:223], v[160:163], v[28:31]
    v_exp_f32 v206, v206
    v_mfma_f32_16x16x32_bf16 v[60:63], v[220:223], v[164:167], v[60:63]
    v_exp_f32 v207, v207
    v_mfma_f32_16x16x32_bf16 v[92:95], v[220:223], v[168:171], v[92:95]
    v_cvt_pk_bf16_f32 v195, v206, v207
    v_mbcnt_hi_u32_b32 v178, -1, v178
    v_mfma_f32_16x16x32_bf16 v[124:127], v[220:223], v[172:175], v[124:127]
    s_waitcnt lgkmcnt(5)
    ds_read_b64_tr_b16 v[216:217], v225 offset:28672
    v_lshrrev_b32 v176, 3, v178
    v_mfma_f32_16x16x32_bf16 v[0:3], v[208:211], v[180:183], v[0:3]
    ds_read_b64_tr_b16 v[218:219], v225 offset:30720
    v_xor_b32 v177, v176, v178
    v_mfma_f32_16x16x32_bf16 v[32:35], v[208:211], v[184:187], v[32:35]
    v_and_b32 v177, 7, v177
    v_lshlrev_b32 v177, 4, v177
    v_mfma_f32_16x16x32_bf16 v[64:67], v[208:211], v[188:191], v[64:67]
    v_lshl_add_u32 v179, v176, 8, v177
    v_lshrrev_b32 v176, 4, v178
    v_mfma_f32_16x16x32_bf16 v[96:99], v[208:211], v[192:195], v[96:99]
    ds_read_b64_tr_b16 v[220:221], v225 offset:28680
    v_xor_b32 v176, v176, v178
    v_smfmac_f32_16x16x64_bf16 a[240:243], a[252:255], v[180:187], v233
    ds_read_b64_tr_b16 v[222:223], v225 offset:30728
    v_and_b32 v176, 7, v176
    v_mfma_f32_16x16x32_bf16 v[204:207], a[80:83], a[48:51], 0
    v_exp_f32 v200, v200
    v_mfma_f32_16x16x32_bf16 v[204:207], a[212:215], a[52:55], v[204:207]
    ds_read_b128 a[212:215], v229 offset:8192
    v_and_b32 v177, 15, v178
    v_mfma_f32_16x16x32_bf16 v[204:207], a[216:219], a[56:59], v[204:207]
    v_exp_f32 v201, v201
    v_mfma_f32_16x16x32_bf16 v[204:207], a[220:223], a[60:63], v[204:207]
    s_waitcnt lgkmcnt(6)
    ds_read_b128 a[216:219], v235 offset:8192
    v_cvt_pk_bf16_f32 v168, v200, v201
    v_mfma_f32_16x16x32_bf16 v[4:7], v[212:215], v[180:183], v[4:7]
    v_exp_f32 v202, v202
    v_mfma_f32_16x16x32_bf16 v[36:39], v[212:215], v[184:187], v[36:39]
    ds_read_b128 a[220:223], v231 offset:8192
    v_accvgpr_read_b32 v253, a240
    v_mfma_f32_16x16x32_bf16 v[68:71], v[212:215], v[188:191], v[68:71]
    v_exp_f32 v203, v203
    v_mfma_f32_16x16x32_bf16 v[100:103], v[212:215], v[192:195], v[100:103]
    s_waitcnt lgkmcnt(5)
    ds_read_b64_tr_b16 v[208:209], v224 offset:61440
    v_accvgpr_read_b32 v254, a241
    v_mfma_f32_16x16x32_bf16 v[8:11], v[216:219], v[180:183], v[8:11]
    ds_read_b64_tr_b16 v[210:211], v224 offset:63488
    v_add_f32 v253, v253, v254
    v_mfma_f32_16x16x32_bf16 v[40:43], v[216:219], v[184:187], v[40:43]
    v_rcp_f32 v248, v253
    v_mfma_f32_16x16x32_bf16 v[72:75], v[216:219], v[188:191], v[72:75]
    v_accvgpr_read_b32 v232, a242
    v_accvgpr_read_b32 v254, a243
    v_mfma_f32_16x16x32_bf16 v[104:107], v[216:219], v[192:195], v[104:107]
    ds_read_b64_tr_b16 v[212:213], v224 offset:61448
    v_add_f32 v232, v232, v254
    v_cvt_pk_bf16_f32 v169, v202, v203
    v_mfma_f32_16x16x32_bf16 v[200:203], a[84:87], a[32:35], 0
    v_rcp_f32 v249, v232
    v_mfma_f32_16x16x32_bf16 v[200:203], a[228:231], a[36:39], v[200:203]
    ds_read_b64_tr_b16 v[214:215], v224 offset:63496
    v_max3_u32 v226, v226, v253, v232
    v_mfma_f32_16x16x32_bf16 v[200:203], a[232:235], a[40:43], v[200:203]
    v_exp_f32 v204, v204
    v_mfma_f32_16x16x32_bf16 v[200:203], a[236:239], a[44:47], v[200:203]
    s_waitcnt lgkmcnt(7)
    v_min3_u32 v227, v227, v253, v232
    v_xor_b32 v224, 0x10000, v224
    v_mfma_f32_16x16x32_bf16 v[12:15], v[220:223], v[180:183], v[12:15]
    v_exp_f32 v205, v205
    v_mfma_f32_16x16x32_bf16 v[44:47], v[220:223], v[184:187], v[44:47]
    v_exp_f32 v206, v206
    v_mfma_f32_16x16x32_bf16 v[76:79], v[220:223], v[188:191], v[76:79]
    v_exp_f32 v207, v207
    v_mfma_f32_16x16x32_bf16 v[108:111], v[220:223], v[192:195], v[108:111]
    s_waitcnt lgkmcnt(2)
    ds_read_b64_tr_b16 v[216:217], v225 offset:61440
    v_cvt_pk_bf16_f32 v172, v204, v205
    v_mfma_f32_16x16x32_bf16 v[16:19], v[208:211], v[180:183], v[16:19]
    ds_read_b64_tr_b16 v[218:219], v225 offset:63488
    v_cvt_pk_bf16_f32 v173, v206, v207
    v_mfma_f32_16x16x32_bf16 v[48:51], v[208:211], v[184:187], v[48:51]
    v_lshlrev_b32 v177, 3, v177
    v_add_lshl_u32 v176, v176, v177, 4
    v_mfma_f32_16x16x32_bf16 v[80:83], v[208:211], v[188:191], v[80:83]
    v_add_u32 v176, s45, v176
    v_xor_b32 v177, 64, v176
    v_mfma_f32_16x16x32_bf16 v[112:115], v[208:211], v[192:195], v[112:115]
    ds_read_b64_tr_b16 v[220:221], v225 offset:61448
    v_lshl_add_u32 v178, v178, 4, s45
    v_mfma_f32_16x16x32_bf16 v[204:207], a[84:87], a[48:51], 0
    v_exp_f32 v200, v200
    v_mfma_f32_16x16x32_bf16 v[204:207], a[228:231], a[52:55], v[204:207]
    ds_read_b64_tr_b16 v[222:223], v225 offset:63496
    v_xor_b32 v225, 0x10000, v225
    v_mfma_f32_16x16x32_bf16 v[204:207], a[232:235], a[56:59], v[204:207]
    v_exp_f32 v201, v201
    v_mul_f32 v0, v0, v248
    v_mul_f32 v1, v1, v248
    v_mul_f32 v2, v2, v248
    v_mul_f32 v3, v3, v248
    v_cvt_pk_bf16_f32 v128, v0, v1
    v_cvt_pk_bf16_f32 v129, v2, v3
    v_mul_f32 v4, v4, v248
    v_mul_f32 v5, v5, v248
    v_mul_f32 v6, v6, v248
    v_mul_f32 v7, v7, v248
    v_cvt_pk_bf16_f32 v130, v4, v5
    v_cvt_pk_bf16_f32 v131, v6, v7
    buffer_store_dwordx4 v[128:131], v230, s[20:23], s30 offen offset:0
    v_mfma_f32_16x16x32_bf16 v[204:207], a[236:239], a[60:63], v[204:207]
    s_waitcnt lgkmcnt(4)
    ds_read_b128 a[228:231], v229 offset:12288
    v_cvt_pk_bf16_f32 v170, v200, v201
    v_mfma_f32_16x16x32_bf16 v[20:23], v[212:215], v[180:183], v[20:23]
    v_exp_f32 v202, v202
    v_mfma_f32_16x16x32_bf16 v[52:55], v[212:215], v[184:187], v[52:55]
    ds_read_b128 a[232:235], v235 offset:12288
    v_mul_f32 v32, v32, v249
    v_mfma_f32_16x16x32_bf16 v[84:87], v[212:215], v[188:191], v[84:87]
    v_exp_f32 v203, v203
    v_mfma_f32_16x16x32_bf16 v[116:119], v[212:215], v[192:195], v[116:119]
    s_waitcnt lgkmcnt(4)
    ds_read_b128 a[236:239], v231 offset:12288
    v_cvt_pk_bf16_f32 v171, v202, v203
    v_mfma_f32_16x16x32_bf16 v[24:27], v[216:219], v[180:183], v[24:27]
    ds_read_b64_tr_b16 v[208:209], v224 offset:0
    v_mul_f32 v33, v33, v249
    v_mfma_f32_16x16x32_bf16 v[56:59], v[216:219], v[184:187], v[56:59]
    ds_read_b64_tr_b16 v[210:211], v224 offset:2048
    v_mul_f32 v34, v34, v249
    v_mfma_f32_16x16x32_bf16 v[88:91], v[216:219], v[188:191], v[88:91]
    ds_read_b64_tr_b16 v[212:213], v224 offset:8
    v_mul_f32 v35, v35, v249
    v_mfma_f32_16x16x32_bf16 v[120:123], v[216:219], v[192:195], v[120:123]
    ds_read_b64_tr_b16 v[214:215], v224 offset:2056
    v_cvt_pk_bf16_f32 v132, v32, v33
    v_smfmac_f32_16x16x64_bf16 a[244:247], a[252:255], v[188:195], v233
    ds_read_b64_tr_b16 v[216:217], v225 offset:0
    v_cvt_pk_bf16_f32 v133, v34, v35
    v_mfma_f32_16x16x32_bf16 v[200:203], a[88:91], a[32:35], 0
    v_exp_f32 v204, v204
    v_mfma_f32_16x16x32_bf16 v[200:203], a[212:215], a[36:39], v[200:203]
    ds_read_b64_tr_b16 v[218:219], v225 offset:2048
    v_mul_f32 v36, v36, v249
    v_mul_f32 v37, v37, v249
    v_mul_f32 v38, v38, v249
    v_mul_f32 v39, v39, v249
    v_cvt_pk_bf16_f32 v134, v36, v37
    v_cvt_pk_bf16_f32 v135, v38, v39
    buffer_store_dwordx4 v[132:135], v230, s[20:23], s31 offen offset:0
    v_mfma_f32_16x16x32_bf16 v[200:203], a[216:219], a[40:43], v[200:203]
    v_exp_f32 v205, v205
    v_mfma_f32_16x16x32_bf16 v[200:203], a[220:223], a[44:47], v[200:203]
    s_waitcnt lgkmcnt(9)
    ds_write_b64 v228, a[100:101] offset:20480
    v_mfma_f32_16x16x32_bf16 v[28:31], v[220:223], v[180:183], v[28:31]
    ds_write_b64 v228, a[102:103] offset:20488
    v_mfma_f32_16x16x32_bf16 v[60:63], v[220:223], v[184:187], v[60:63]
    v_exp_f32 v206, v206
    v_mfma_f32_16x16x32_bf16 v[92:95], v[220:223], v[188:191], v[92:95]
    v_exp_f32 v207, v207
    v_mfma_f32_16x16x32_bf16 v[124:127], v[220:223], v[192:195], v[124:127]
    ds_read_b64_tr_b16 v[220:221], v225 offset:8
    v_cvt_pk_bf16_f32 v174, v204, v205
    v_cvt_pk_bf16_f32 v175, v206, v207
    v_mfma_f32_16x16x32_bf16 v[204:207], a[88:91], a[48:51], 0
    v_exp_f32 v200, v200
    v_mfma_f32_16x16x32_bf16 v[204:207], a[212:215], a[52:55], v[204:207]
    ds_read_b64_tr_b16 v[222:223], v225 offset:2056
    v_mul_f32 v8, v8, v248
    v_mfma_f32_16x16x32_bf16 v[204:207], a[216:219], a[56:59], v[204:207]
    v_exp_f32 v201, v201
    v_mfma_f32_16x16x32_bf16 v[204:207], a[220:223], a[60:63], v[204:207]
    s_waitcnt lgkmcnt(2)
    s_barrier
    ds_read_b128 a[212:215], v229 offset:16384
    v_cvt_pk_bf16_f32 v188, v200, v201
    v_mfma_f32_16x16x32_bf16 v[64:67], v[208:211], v[168:171], v[64:67]
    v_exp_f32 v202, v202
    v_mfma_f32_16x16x32_bf16 v[96:99], v[208:211], v[172:175], v[96:99]
    ds_read_b64_tr_b16 v[208:209], v224 offset:32768
    v_mul_f32 v9, v9, v248
    v_mul_f32 v10, v10, v248
    v_mul_f32 v11, v11, v248
    v_cvt_pk_bf16_f32 v136, v8, v9
    v_cvt_pk_bf16_f32 v137, v10, v11
    v_mul_f32 v12, v12, v248
    v_mul_f32 v13, v13, v248
    v_mul_f32 v14, v14, v248
    v_mul_f32 v15, v15, v248
    v_cvt_pk_bf16_f32 v138, v12, v13
    v_cvt_pk_bf16_f32 v139, v14, v15
    buffer_store_dwordx4 v[136:139], v230, s[20:23], s30 offen offset:64
    v_mfma_f32_16x16x32_bf16 v[68:71], v[212:215], v[168:171], v[68:71]
    v_exp_f32 v203, v203
    v_mfma_f32_16x16x32_bf16 v[100:103], v[212:215], v[172:175], v[100:103]
    ds_read_b64_tr_b16 v[210:211], v224 offset:34816
    v_cvt_pk_bf16_f32 v189, v202, v203
    v_smfmac_f32_16x16x64_bf16 a[244:247], a[252:255], v[168:175], v233
    ds_read_b64_tr_b16 v[212:213], v224 offset:32776
    v_mul_f32 v40, v40, v249
    v_mfma_f32_16x16x32_bf16 v[200:203], a[92:95], a[32:35], 0
    v_exp_f32 v204, v204
    v_mfma_f32_16x16x32_bf16 v[200:203], a[228:231], a[36:39], v[200:203]
    ds_read_b64_tr_b16 v[214:215], v224 offset:34824
    v_mul_f32 v41, v41, v249
    v_mfma_f32_16x16x32_bf16 v[200:203], a[232:235], a[40:43], v[200:203]
    v_exp_f32 v205, v205
    v_mfma_f32_16x16x32_bf16 v[200:203], a[236:239], a[44:47], v[200:203]
    ds_read_b128 a[216:219], v235 offset:16384
    v_cvt_pk_bf16_f32 v192, v204, v205
    v_mfma_f32_16x16x32_bf16 v[72:75], v[216:219], v[168:171], v[72:75]
    v_exp_f32 v206, v206
    v_mfma_f32_16x16x32_bf16 v[104:107], v[216:219], v[172:175], v[104:107]
    s_waitcnt lgkmcnt(6)
    ds_read_b128 a[220:223], v231 offset:16384
    v_mul_f32 v42, v42, v249
    v_mfma_f32_16x16x32_bf16 v[76:79], v[220:223], v[168:171], v[76:79]
    v_exp_f32 v207, v207
    v_mfma_f32_16x16x32_bf16 v[108:111], v[220:223], v[172:175], v[108:111]
    ds_read_b64_tr_b16 v[216:217], v225 offset:32768
    v_cvt_pk_bf16_f32 v193, v206, v207
    v_mfma_f32_16x16x32_bf16 v[204:207], a[92:95], a[48:51], 0
    v_exp_f32 v200, v200
    v_mul_f32 v43, v43, v249
    v_cvt_pk_bf16_f32 v140, v40, v41
    v_cvt_pk_bf16_f32 v141, v42, v43
    v_mul_f32 v44, v44, v249
    v_mul_f32 v45, v45, v249
    v_mul_f32 v46, v46, v249
    v_mul_f32 v47, v47, v249
    v_cvt_pk_bf16_f32 v142, v44, v45
    v_cvt_pk_bf16_f32 v143, v46, v47
    buffer_store_dwordx4 v[140:143], v230, s[20:23], s31 offen offset:64
    v_mfma_f32_16x16x32_bf16 v[204:207], a[228:231], a[52:55], v[204:207]
    ds_read_b64_tr_b16 v[218:219], v225 offset:34816
    v_mul_f32 v16, v16, v248
    v_mfma_f32_16x16x32_bf16 v[204:207], a[232:235], a[56:59], v[204:207]
    v_exp_f32 v201, v201
    v_mfma_f32_16x16x32_bf16 v[204:207], a[236:239], a[60:63], v[204:207]
    s_waitcnt lgkmcnt(6)
    ds_read_b64_tr_b16 v[220:221], v225 offset:32776
    v_cvt_pk_bf16_f32 v190, v200, v201
    v_mfma_f32_16x16x32_bf16 v[80:83], v[208:211], v[168:171], v[80:83]
    v_exp_f32 v202, v202
    v_mfma_f32_16x16x32_bf16 v[112:115], v[208:211], v[172:175], v[112:115]
    s_waitcnt lgkmcnt(5)
    ds_read_b64_tr_b16 v[222:223], v225 offset:34824
    v_mul_f32 v17, v17, v248
    v_mfma_f32_16x16x32_bf16 v[84:87], v[212:215], v[168:171], v[84:87]
    v_exp_f32 v203, v203
    v_mfma_f32_16x16x32_bf16 v[116:119], v[212:215], v[172:175], v[116:119]
    ds_read_b64_tr_b16 v[208:209], v224 offset:4096
    v_cvt_pk_bf16_f32 v191, v202, v203
    v_mfma_f32_16x16x32_bf16 v[200:203], a[96:99], a[32:35], 0
    v_exp_f32 v204, v204
    v_mfma_f32_16x16x32_bf16 v[200:203], a[212:215], a[36:39], v[200:203]
    s_waitcnt lgkmcnt(6)
    ds_read_b64_tr_b16 v[210:211], v224 offset:6144
    v_mul_f32 v18, v18, v248
    v_mfma_f32_16x16x32_bf16 v[200:203], a[216:219], a[40:43], v[200:203]
    s_waitcnt lgkmcnt(6)
    v_exp_f32 v205, v205
    v_mfma_f32_16x16x32_bf16 v[200:203], a[220:223], a[44:47], v[200:203]
    s_waitcnt lgkmcnt(4)
    ds_read_b64_tr_b16 v[212:213], v224 offset:4104
    v_cvt_pk_bf16_f32 v194, v204, v205
    v_mfma_f32_16x16x32_bf16 v[88:91], v[216:219], v[168:171], v[88:91]
    v_exp_f32 v206, v206
    v_mul_f32 v19, v19, v248
    v_cvt_pk_bf16_f32 v144, v16, v17
    v_cvt_pk_bf16_f32 v145, v18, v19
    v_mul_f32 v20, v20, v248
    v_mul_f32 v21, v21, v248
    v_mul_f32 v22, v22, v248
    v_mul_f32 v23, v23, v248
    v_cvt_pk_bf16_f32 v146, v20, v21
    v_cvt_pk_bf16_f32 v147, v22, v23
    buffer_store_dwordx4 v[144:147], v230, s[20:23], s30 offen offset:128
    v_mfma_f32_16x16x32_bf16 v[120:123], v[216:219], v[172:175], v[120:123]
    s_waitcnt lgkmcnt(3)
    ds_read_b64_tr_b16 v[214:215], v224 offset:6152
    v_mul_f32 v48, v48, v249
    v_mfma_f32_16x16x32_bf16 v[92:95], v[220:223], v[168:171], v[92:95]
    v_exp_f32 v207, v207
    v_mfma_f32_16x16x32_bf16 v[124:127], v[220:223], v[172:175], v[124:127]
    ds_read_b128 a[228:231], v229 offset:20480
    v_cvt_pk_bf16_f32 v195, v206, v207
    v_mfma_f32_16x16x32_bf16 v[204:207], a[96:99], a[48:51], 0
    v_exp_f32 v200, v200
    v_mfma_f32_16x16x32_bf16 v[204:207], a[212:215], a[52:55], v[204:207]
    ds_read_b128 a[232:235], v235 offset:20480
    v_mul_f32 v49, v49, v249
    v_mfma_f32_16x16x32_bf16 v[204:207], a[216:219], a[56:59], v[204:207]
    ds_read_b128 a[236:239], v231 offset:20480
    v_exp_f32 v201, v201
    v_mfma_f32_16x16x32_bf16 v[204:207], a[220:223], a[60:63], v[204:207]
    s_waitcnt lgkmcnt(5)
    ds_read_b64_tr_b16 v[216:217], v225 offset:4096
    v_cvt_pk_bf16_f32 v168, v200, v201
    v_mfma_f32_16x16x32_bf16 v[64:67], v[208:211], v[188:191], v[64:67]
    v_exp_f32 v202, v202
    v_mfma_f32_16x16x32_bf16 v[96:99], v[208:211], v[192:195], v[96:99]
    s_waitcnt lgkmcnt(4)
    ds_read_b64_tr_b16 v[218:219], v225 offset:6144
    v_mul_f32 v50, v50, v249
    v_mfma_f32_16x16x32_bf16 v[68:71], v[212:215], v[188:191], v[68:71]
    v_exp_f32 v203, v203
    v_mfma_f32_16x16x32_bf16 v[100:103], v[212:215], v[192:195], v[100:103]
    ds_read_b64_tr_b16 v[220:221], v225 offset:4104
    v_cvt_pk_bf16_f32 v169, v202, v203
    v_smfmac_f32_16x16x64_bf16 a[244:247], a[252:255], v[188:195], v233
    ds_read_b64_tr_b16 v[222:223], v225 offset:6152
    v_mul_f32 v51, v51, v249
    v_cvt_pk_bf16_f32 v148, v48, v49
    v_cvt_pk_bf16_f32 v149, v50, v51
    v_mul_f32 v52, v52, v249
    v_mul_f32 v53, v53, v249
    v_mul_f32 v54, v54, v249
    v_mul_f32 v55, v55, v249
    v_cvt_pk_bf16_f32 v150, v52, v53
    v_cvt_pk_bf16_f32 v151, v54, v55
    buffer_store_dwordx4 v[148:151], v230, s[20:23], s31 offen offset:128
    v_mfma_f32_16x16x32_bf16 v[200:203], a[100:103], a[32:35], 0
    s_waitcnt lgkmcnt(6)
    v_exp_f32 v204, v204
    v_mfma_f32_16x16x32_bf16 v[200:203], a[228:231], a[36:39], v[200:203]
    s_waitcnt lgkmcnt(5)
    ds_read_b64_tr_b16 v[208:209], v224 offset:36864
    v_mul_f32 v24, v24, v248
    v_mfma_f32_16x16x32_bf16 v[200:203], a[232:235], a[40:43], v[200:203]
    s_waitcnt lgkmcnt(5)
    v_exp_f32 v205, v205
    v_mfma_f32_16x16x32_bf16 v[200:203], a[236:239], a[44:47], v[200:203]
    s_waitcnt lgkmcnt(3)
    ds_read_b64_tr_b16 v[210:211], v224 offset:38912
    v_cvt_pk_bf16_f32 v172, v204, v205
    v_mfma_f32_16x16x32_bf16 v[72:75], v[216:219], v[188:191], v[72:75]
    v_exp_f32 v206, v206
    v_mfma_f32_16x16x32_bf16 v[104:107], v[216:219], v[192:195], v[104:107]
    s_waitcnt lgkmcnt(2)
    ds_read_b64_tr_b16 v[212:213], v224 offset:36872
    v_mul_f32 v25, v25, v248
    v_mfma_f32_16x16x32_bf16 v[76:79], v[220:223], v[188:191], v[76:79]
    ds_read_b64_tr_b16 v[214:215], v224 offset:38920
    v_exp_f32 v207, v207
    v_mfma_f32_16x16x32_bf16 v[108:111], v[220:223], v[192:195], v[108:111]
    ds_read_b64_tr_b16 v[216:217], v225 offset:36864
    v_cvt_pk_bf16_f32 v173, v206, v207
    v_mfma_f32_16x16x32_bf16 v[204:207], a[100:103], a[48:51], 0
    ds_read_b64_tr_b16 v[218:219], v225 offset:38912
    v_exp_f32 v200, v200
    v_mfma_f32_16x16x32_bf16 v[204:207], a[228:231], a[52:55], v[204:207]
    ds_read_b64_tr_b16 v[220:221], v225 offset:36872
    v_mul_f32 v26, v26, v248
    v_mfma_f32_16x16x32_bf16 v[204:207], a[232:235], a[56:59], v[204:207]
    ds_read_b64_tr_b16 v[222:223], v225 offset:38920
    v_exp_f32 v201, v201
    v_mfma_f32_16x16x32_bf16 v[204:207], a[236:239], a[60:63], v[204:207]
    s_waitcnt lgkmcnt(6)
    v_mul_f32 v27, v27, v248
    v_cvt_pk_bf16_f32 v152, v24, v25
    v_cvt_pk_bf16_f32 v153, v26, v27
    v_mul_f32 v28, v28, v248
    v_mul_f32 v29, v29, v248
    v_mul_f32 v30, v30, v248
    v_mul_f32 v31, v31, v248
    v_cvt_pk_bf16_f32 v154, v28, v29
    v_cvt_pk_bf16_f32 v155, v30, v31
    buffer_store_dwordx4 v[152:155], v230, s[20:23], s30 offen offset:192
    v_mfma_f32_16x16x32_bf16 v[80:83], v[208:211], v[188:191], v[80:83]
    v_exp_f32 v202, v202
    v_mfma_f32_16x16x32_bf16 v[112:115], v[208:211], v[192:195], v[112:115]
    s_waitcnt lgkmcnt(4)
    ds_read_b64_tr_b16 v[208:209], v224 offset:8192
    v_mul_f32 v56, v56, v249
    v_mfma_f32_16x16x32_bf16 v[84:87], v[212:215], v[188:191], v[84:87]
    ds_read_b64_tr_b16 v[210:211], v224 offset:10240
    v_exp_f32 v203, v203
    v_mfma_f32_16x16x32_bf16 v[116:119], v[212:215], v[192:195], v[116:119]
    s_waitcnt lgkmcnt(4)
    ds_read_b64_tr_b16 v[212:213], v224 offset:8200
    v_mul_f32 v57, v57, v249
    v_mfma_f32_16x16x32_bf16 v[88:91], v[216:219], v[188:191], v[88:91]
    ds_read_b64_tr_b16 v[214:215], v224 offset:10248
    v_exp_f32 v204, v204
    v_mul_f32 v58, v58, v249
    v_mul_f32 v59, v59, v249
    v_cvt_pk_bf16_f32 v156, v56, v57
    v_cvt_pk_bf16_f32 v157, v58, v59
    v_mul_f32 v60, v60, v249
    v_mul_f32 v61, v61, v249
    v_mul_f32 v62, v62, v249
    v_mul_f32 v63, v63, v249
    v_cvt_pk_bf16_f32 v158, v60, v61
    v_cvt_pk_bf16_f32 v159, v62, v63
    buffer_store_dwordx4 v[156:159], v230, s[20:23], s31 offen offset:192
    v_mfma_f32_16x16x32_bf16 v[120:123], v[216:219], v[192:195], v[120:123]
    s_waitcnt lgkmcnt(4)
    ds_read_b64_tr_b16 v[216:217], v225 offset:8192
    v_exp_f32 v205, v205
    v_mfma_f32_16x16x32_bf16 v[92:95], v[220:223], v[188:191], v[92:95]
    ds_read_b64_tr_b16 v[218:219], v225 offset:10240
    v_exp_f32 v206, v206
    v_mfma_f32_16x16x32_bf16 v[124:127], v[220:223], v[192:195], v[124:127]
    s_waitcnt lgkmcnt(4)
    ds_read_b64_tr_b16 v[220:221], v225 offset:8200
    v_exp_f32 v207, v207
    v_cvt_pk_bf16_f32 v170, v200, v201
    v_cvt_pk_bf16_f32 v171, v202, v203
    s_nop 1
    v_mfma_f32_16x16x32_bf16 v[64:67], v[208:211], v[168:171], v[64:67]
    ds_read_b64_tr_b16 v[222:223], v225 offset:10248
    v_cvt_pk_bf16_f32 v174, v204, v205
    v_cvt_pk_bf16_f32 v175, v206, v207
    s_nop 1
    v_mfma_f32_16x16x32_bf16 v[96:99], v[208:211], v[172:175], v[96:99]
    ds_read_b64_tr_b16 v[208:209], v224 offset:40960
    v_add_u32 v234, s49, v228
    v_smfmac_f32_16x16x64_bf16 a[244:247], a[252:255], v[168:175], v233
    s_waitcnt lgkmcnt(5)
    ds_read_b64_tr_b16 v[210:211], v224 offset:43008
    v_mfma_f32_16x16x32_bf16 v[68:71], v[212:215], v[168:171], v[68:71]
    ds_read_b128 a[208:211], v234 offset:0
    v_mfma_f32_16x16x32_bf16 v[100:103], v[212:215], v[172:175], v[100:103]
    s_waitcnt lgkmcnt(5)
    ds_read_b64_tr_b16 v[212:213], v224 offset:40968
    v_mfma_f32_16x16x32_bf16 v[72:75], v[216:219], v[168:171], v[72:75]
    ds_read_b64_tr_b16 v[214:215], v224 offset:43016
    v_mfma_f32_16x16x32_bf16 v[104:107], v[216:219], v[172:175], v[104:107]
    s_waitcnt lgkmcnt(5)
    ds_read_b64_tr_b16 v[216:217], v225 offset:40960
    v_mfma_f32_16x16x32_bf16 v[76:79], v[220:223], v[168:171], v[76:79]
    ds_read_b64_tr_b16 v[218:219], v225 offset:43008
    v_mfma_f32_16x16x32_bf16 v[108:111], v[220:223], v[172:175], v[108:111]
    s_waitcnt lgkmcnt(5)
    ds_read_b64_tr_b16 v[220:221], v225 offset:40968
    v_accvgpr_read_b32 v253, a244
    v_mfma_f32_16x16x32_bf16 v[80:83], v[208:211], v[168:171], v[80:83]
    ds_read_b64_tr_b16 v[222:223], v225 offset:43016
    v_accvgpr_read_b32 v254, a245
    v_mfma_f32_16x16x32_bf16 v[112:115], v[208:211], v[172:175], v[112:115]
    s_waitcnt lgkmcnt(4)
    ds_read_b128 a[212:215], v234 offset:1024
    v_add_f32 v253, v253, v254
    v_mfma_f32_16x16x32_bf16 v[84:87], v[212:215], v[168:171], v[84:87]
    ds_read_b128 a[216:219], v234 offset:2048
    v_accvgpr_read_b32 v232, a246
    v_mfma_f32_16x16x32_bf16 v[116:119], v[212:215], v[172:175], v[116:119]
    s_waitcnt lgkmcnt(4)
    ds_read_b128 a[220:223], v234 offset:3072
    v_accvgpr_read_b32 v254, a247
    v_mfma_f32_16x16x32_bf16 v[88:91], v[216:219], v[168:171], v[88:91]
    ds_read_b128 a[224:227], v234 offset:4096
    v_add_f32 v232, v232, v254
    v_mfma_f32_16x16x32_bf16 v[120:123], v[216:219], v[172:175], v[120:123]
    s_waitcnt lgkmcnt(4)
    ds_read_b128 a[228:231], v234 offset:5120
    v_max3_u32 v226, v226, v253, v232
    v_mfma_f32_16x16x32_bf16 v[92:95], v[220:223], v[168:171], v[92:95]
L_pad13:
    s_cbranch_vccnz L_back
    ds_read_b128 a[232:235], v234 offset:6144
    v_min3_u32 v227, v227, v253, v232
    v_mfma_f32_16x16x32_bf16 v[124:127], v[220:223], v[172:175], v[124:127]
    ds_read_b128 a[236:239], v234 offset:7168
    v_rcp_f32 v250, v253
    v_rcp_f32 v251, v232
    s_nop 0
    v_pk_mul_f32 v[64:65], v[64:65], v[250:251] op_sel:[0,0] op_sel_hi:[1,0]
    v_pk_mul_f32 v[66:67], v[66:67], v[250:251] op_sel:[0,0] op_sel_hi:[1,0]
    v_cvt_pk_bf16_f32 v64, v64, v65
    v_cvt_pk_bf16_f32 v65, v66, v67
    v_pk_mul_f32 v[68:69], v[68:69], v[250:251] op_sel:[0,0] op_sel_hi:[1,0]
    v_pk_mul_f32 v[70:71], v[70:71], v[250:251] op_sel:[0,0] op_sel_hi:[1,0]
    v_cvt_pk_bf16_f32 v66, v68, v69
    v_cvt_pk_bf16_f32 v67, v70, v71
    ds_write_b128 v176, v[64:67] offset:0
    v_pk_mul_f32 v[72:73], v[72:73], v[250:251] op_sel:[0,0] op_sel_hi:[1,0]
    v_pk_mul_f32 v[74:75], v[74:75], v[250:251] op_sel:[0,0] op_sel_hi:[1,0]
    v_cvt_pk_bf16_f32 v72, v72, v73
    v_cvt_pk_bf16_f32 v73, v74, v75
    v_pk_mul_f32 v[76:77], v[76:77], v[250:251] op_sel:[0,0] op_sel_hi:[1,0]
    v_pk_mul_f32 v[78:79], v[78:79], v[250:251] op_sel:[0,0] op_sel_hi:[1,0]
    v_cvt_pk_bf16_f32 v74, v76, v77
    v_cvt_pk_bf16_f32 v75, v78, v79
    ds_write_b128 v177, v[72:75] offset:0
    ds_read_b128 v[160:163], v178 offset:0
    ds_read_b128 v[164:167], v178 offset:1024
    v_pk_mul_f32 v[96:97], v[96:97], v[250:251] op_sel:[0,1] op_sel_hi:[1,1]
    v_pk_mul_f32 v[98:99], v[98:99], v[250:251] op_sel:[0,1] op_sel_hi:[1,1]
    v_cvt_pk_bf16_f32 v96, v96, v97
    v_cvt_pk_bf16_f32 v97, v98, v99
    v_pk_mul_f32 v[100:101], v[100:101], v[250:251] op_sel:[0,1] op_sel_hi:[1,1]
    v_pk_mul_f32 v[102:103], v[102:103], v[250:251] op_sel:[0,1] op_sel_hi:[1,1]
    v_cvt_pk_bf16_f32 v98, v100, v101
    v_cvt_pk_bf16_f32 v99, v102, v103
    ds_write_b128 v176, v[96:99] offset:2048
    v_pk_mul_f32 v[104:105], v[104:105], v[250:251] op_sel:[0,1] op_sel_hi:[1,1]
    v_pk_mul_f32 v[106:107], v[106:107], v[250:251] op_sel:[0,1] op_sel_hi:[1,1]
    v_cvt_pk_bf16_f32 v104, v104, v105
    v_cvt_pk_bf16_f32 v105, v106, v107
    v_pk_mul_f32 v[108:109], v[108:109], v[250:251] op_sel:[0,1] op_sel_hi:[1,1]
    v_pk_mul_f32 v[110:111], v[110:111], v[250:251] op_sel:[0,1] op_sel_hi:[1,1]
    v_cvt_pk_bf16_f32 v106, v108, v109
    v_cvt_pk_bf16_f32 v107, v110, v111
    ds_write_b128 v177, v[104:107] offset:2048
    ds_read_b128 v[180:183], v178 offset:2048
    ds_read_b128 v[184:187], v178 offset:3072
    s_waitcnt lgkmcnt(5)
    buffer_store_dwordx4 v[160:163], v179, s[20:23], s32 offen offset:0
    s_waitcnt lgkmcnt(4)
    buffer_store_dwordx4 v[164:167], v179, s[20:23], s32 offen offset:2048
    v_pk_mul_f32 v[80:81], v[80:81], v[250:251] op_sel:[0,0] op_sel_hi:[1,0]
    v_pk_mul_f32 v[82:83], v[82:83], v[250:251] op_sel:[0,0] op_sel_hi:[1,0]
    v_cvt_pk_bf16_f32 v80, v80, v81
    v_cvt_pk_bf16_f32 v81, v82, v83
    v_pk_mul_f32 v[84:85], v[84:85], v[250:251] op_sel:[0,0] op_sel_hi:[1,0]
    v_pk_mul_f32 v[86:87], v[86:87], v[250:251] op_sel:[0,0] op_sel_hi:[1,0]
    v_cvt_pk_bf16_f32 v82, v84, v85
    v_cvt_pk_bf16_f32 v83, v86, v87
    ds_write_b128 v176, v[80:83] offset:0
    v_pk_mul_f32 v[88:89], v[88:89], v[250:251] op_sel:[0,0] op_sel_hi:[1,0]
    v_pk_mul_f32 v[90:91], v[90:91], v[250:251] op_sel:[0,0] op_sel_hi:[1,0]
    v_cvt_pk_bf16_f32 v88, v88, v89
    v_cvt_pk_bf16_f32 v89, v90, v91
    v_pk_mul_f32 v[92:93], v[92:93], v[250:251] op_sel:[0,0] op_sel_hi:[1,0]
    v_pk_mul_f32 v[94:95], v[94:95], v[250:251] op_sel:[0,0] op_sel_hi:[1,0]
    v_cvt_pk_bf16_f32 v90, v92, v93
    v_cvt_pk_bf16_f32 v91, v94, v95
    ds_write_b128 v177, v[88:91] offset:0
    ds_read_b128 v[160:163], v178 offset:0
    ds_read_b128 v[164:167], v178 offset:1024
    s_waitcnt lgkmcnt(5)
    buffer_store_dwordx4 v[180:183], v179, s[20:23], s33 offen offset:0
    s_waitcnt lgkmcnt(4)
    buffer_store_dwordx4 v[184:187], v179, s[20:23], s33 offen offset:2048
    v_pk_mul_f32 v[112:113], v[112:113], v[250:251] op_sel:[0,1] op_sel_hi:[1,1]
    v_pk_mul_f32 v[114:115], v[114:115], v[250:251] op_sel:[0,1] op_sel_hi:[1,1]
    v_cvt_pk_bf16_f32 v112, v112, v113
    v_cvt_pk_bf16_f32 v113, v114, v115
    v_pk_mul_f32 v[116:117], v[116:117], v[250:251] op_sel:[0,1] op_sel_hi:[1,1]
    v_pk_mul_f32 v[118:119], v[118:119], v[250:251] op_sel:[0,1] op_sel_hi:[1,1]
    v_cvt_pk_bf16_f32 v114, v116, v117
    v_cvt_pk_bf16_f32 v115, v118, v119
    ds_write_b128 v176, v[112:115] offset:2048
    v_pk_mul_f32 v[120:121], v[120:121], v[250:251] op_sel:[0,1] op_sel_hi:[1,1]
    v_pk_mul_f32 v[122:123], v[122:123], v[250:251] op_sel:[0,1] op_sel_hi:[1,1]
    v_cvt_pk_bf16_f32 v120, v120, v121
    v_cvt_pk_bf16_f32 v121, v122, v123
    v_pk_mul_f32 v[124:125], v[124:125], v[250:251] op_sel:[0,1] op_sel_hi:[1,1]
    v_pk_mul_f32 v[126:127], v[126:127], v[250:251] op_sel:[0,1] op_sel_hi:[1,1]
    v_cvt_pk_bf16_f32 v122, v124, v125
    v_cvt_pk_bf16_f32 v123, v126, v127
    ds_write_b128 v177, v[120:123] offset:2048
    ds_read_b128 v[180:183], v178 offset:2048
    ds_read_b128 v[184:187], v178 offset:3072
    s_waitcnt lgkmcnt(5)
    buffer_store_dwordx4 v[160:163], v179, s[20:23], s32 offen offset:128
    s_waitcnt lgkmcnt(4)
    buffer_store_dwordx4 v[164:167], v179, s[20:23], s32 offen offset:2176
    s_waitcnt lgkmcnt(1)
    buffer_store_dwordx4 v[180:183], v179, s[20:23], s33 offen offset:128
    s_waitcnt lgkmcnt(0)
    buffer_store_dwordx4 v[184:187], v179, s[20:23], s33 offen offset:2176
    v_mfma_f32_16x16x32_bf16 a[248:251], a[208:211], a[208:211], 0
    ds_read_b128 a[208:211], v234 offset:8192
    v_mfma_f32_16x16x32_bf16 a[248:251], a[212:215], a[212:215], a[248:251]
    ds_read_b128 a[212:215], v234 offset:9216
    v_mfma_f32_16x16x32_bf16 a[248:251], a[216:219], a[216:219], a[248:251]
    ds_read_b128 a[216:219], v234 offset:10240
    v_mfma_f32_16x16x32_bf16 a[248:251], a[220:223], a[220:223], a[248:251]
    ds_read_b128 a[220:223], v234 offset:11264
    v_mfma_f32_16x16x32_bf16 a[248:251], a[224:227], a[224:227], a[248:251]
    ds_read_b128 a[224:227], v234 offset:12288
    v_mfma_f32_16x16x32_bf16 a[248:251], a[228:231], a[228:231], a[248:251]
    ds_read_b128 a[228:231], v234 offset:13312
    v_mfma_f32_16x16x32_bf16 a[248:251], a[232:235], a[232:235], a[248:251]
    ds_read_b128 a[232:235], v234 offset:14336
    v_mfma_f32_16x16x32_bf16 a[248:251], a[236:239], a[236:239], a[248:251]
    s_waitcnt lgkmcnt(6)
    ds_read_b128 a[236:239], v234 offset:15360
    v_mfma_f32_16x16x32_bf16 a[248:251], a[208:211], a[208:211], a[248:251]
    s_waitcnt lgkmcnt(6)
    ds_read_b128 a[208:211], v234 offset:16384
    v_mfma_f32_16x16x32_bf16 a[248:251], a[212:215], a[212:215], a[248:251]
    s_waitcnt lgkmcnt(6)
    ds_read_b128 a[212:215], v234 offset:17408
    v_mfma_f32_16x16x32_bf16 a[248:251], a[216:219], a[216:219], a[248:251]
    s_waitcnt lgkmcnt(6)
    ds_read_b128 a[216:219], v234 offset:18432
    v_mfma_f32_16x16x32_bf16 a[248:251], a[220:223], a[220:223], a[248:251]
    s_waitcnt lgkmcnt(6)
    ds_read_b128 a[220:223], v234 offset:19456
    v_mfma_f32_16x16x32_bf16 a[248:251], a[224:227], a[224:227], a[248:251]
    s_waitcnt lgkmcnt(6)
    ds_read_b128 a[224:227], v234 offset:20480
    v_mfma_f32_16x16x32_bf16 a[248:251], a[228:231], a[228:231], a[248:251]
    s_waitcnt lgkmcnt(6)
    ds_read_b128 a[228:231], v234 offset:21504
    v_mfma_f32_16x16x32_bf16 a[248:251], a[232:235], a[232:235], a[248:251]
    s_waitcnt lgkmcnt(6)
    ds_read_b128 a[232:235], v234 offset:22528
    v_mfma_f32_16x16x32_bf16 a[248:251], a[236:239], a[236:239], a[248:251]
    s_waitcnt lgkmcnt(6)
    ds_read_b128 a[236:239], v234 offset:23552
    v_mfma_f32_16x16x32_bf16 a[248:251], a[208:211], a[208:211], a[248:251]
    s_waitcnt lgkmcnt(6)
    ds_read_b128 a[208:211], v234 offset:24576
    v_mfma_f32_16x16x32_bf16 a[248:251], a[212:215], a[212:215], a[248:251]
    s_waitcnt lgkmcnt(6)
    ds_read_b128 a[212:215], v234 offset:25600
    v_mfma_f32_16x16x32_bf16 a[248:251], a[216:219], a[216:219], a[248:251]
    s_waitcnt lgkmcnt(6)
    ds_read_b128 a[216:219], v234 offset:26624
    v_mfma_f32_16x16x32_bf16 a[248:251], a[220:223], a[220:223], a[248:251]
    s_waitcnt lgkmcnt(6)
    ds_read_b128 a[220:223], v234 offset:27648
    v_mfma_f32_16x16x32_bf16 a[248:251], a[224:227], a[224:227], a[248:251]
    s_waitcnt lgkmcnt(6)
    ds_read_b128 a[224:227], v234 offset:28672
    v_mfma_f32_16x16x32_bf16 a[248:251], a[228:231], a[228:231], a[248:251]
    s_waitcnt lgkmcnt(6)
    ds_read_b128 a[228:231], v234 offset:29696
    v_mfma_f32_16x16x32_bf16 a[248:251], a[232:235], a[232:235], a[248:251]
    s_waitcnt lgkmcnt(6)
    ds_read_b128 a[232:235], v234 offset:30720
    v_mfma_f32_16x16x32_bf16 a[248:251], a[236:239], a[236:239], a[248:251]
    s_waitcnt lgkmcnt(6)
    ds_read_b128 a[236:239], v234 offset:31744
    v_mfma_f32_16x16x32_bf16 a[248:251], a[208:211], a[208:211], a[248:251]
    s_waitcnt lgkmcnt(6)
    v_mfma_f32_16x16x32_bf16 a[248:251], a[212:215], a[212:215], a[248:251]
    s_waitcnt lgkmcnt(5)
    v_mfma_f32_16x16x32_bf16 a[248:251], a[216:219], a[216:219], a[248:251]
    s_waitcnt lgkmcnt(4)
    v_mfma_f32_16x16x32_bf16 a[248:251], a[220:223], a[220:223], a[248:251]
    s_waitcnt lgkmcnt(3)
    v_mfma_f32_16x16x32_bf16 a[248:251], a[224:227], a[224:227], a[248:251]
    s_waitcnt lgkmcnt(2)
    v_mfma_f32_16x16x32_bf16 a[248:251], a[228:231], a[228:231], a[248:251]
    s_waitcnt lgkmcnt(1)
    v_mfma_f32_16x16x32_bf16 a[248:251], a[232:235], a[232:235], a[248:251]
    s_waitcnt lgkmcnt(0)
    v_mfma_f32_16x16x32_bf16 a[248:251], a[236:239], a[236:239], a[248:251]
    s_nop 7
    v_accvgpr_read_b32 v0, a248
    v_accvgpr_read_b32 v1, a249
    v_accvgpr_read_b32 v2, a250
    v_accvgpr_read_b32 v3, a251
    v_and_b32 v0, 0x7fffffff, v0
    v_and_b32 v1, 0x7fffffff, v1
    v_and_b32 v2, 0x7fffffff, v2
    v_and_b32 v3, 0x7fffffff, v3
    v_max_u32 v0, v0, v1
    v_max3_u32 v0, v0, v2, v3
    v_cmp_le_u32 vcc, 0x5d800000, v0
    v_cmp_gt_u32 s[6:7], 1.0, v227
    s_nop 0
    s_cmp_lg_u64 vcc, 0
    s_cselect_b32 s49, 1, 0
    v_cmp_lt_u32 vcc, 0x6f800000, v226
    s_nop 1
    s_or_b64 vcc, vcc, s[6:7]
    s_cselect_b32 s27, 1, s27
    s_or_b32 s27, s27, s49
    s_waitcnt vmcnt(0)
    s_barrier
    s_cmp_eq_u32 s27, 0
    s_cbranch_scc1 L_end
    s_waitcnt vmcnt(0)
    v_and_b32 v224, 0xffff, v224
    v_and_b32 v225, 0xffff, v225
    s_cmp_lg_u32 s49, 0
    s_cselect_b32 s3, 0, s24
    s_cselect_b32 s4, 3, s24
L_fb_wave:
    s_mov_b32 s27, 0x1fffff
    s_lshl_b32 s34, s3, 12
    s_add_u32 s34, s34, 327680
L_fb_next:
    s_ff1_i32_b32 s43, s27
    s_bitset0_b32 s27, s43
    s_cmp_gt_u32 s43, 4
    s_cselect_b32 s45, 1, 0
    s_sub_u32 s45, s43, s45
    s_lshr_b32 s44, s45, 2
    s_lshl_b32 s44, s44, 16
    s_and_b32 s45, s45, 3
    s_lshl_b32 s45, s45, 12
    s_add_u32 s44, s44, s45
    s_lshl_b32 s45, s3, 14
    s_add_u32 s44, s44, s45
    s_cmp_eq_u32 s43, 4
    s_cselect_b32 s44, s34, s44
    buffer_load_dwordx4 v[0:3], v230, s[8:11], s44 offen offset:0
    buffer_load_dwordx4 v[4:7], v230, s[8:11], s44 offen offset:64
    buffer_load_dwordx4 v[8:11], v230, s[8:11], s44 offen offset:128
    buffer_load_dwordx4 v[12:15], v230, s[8:11], s44 offen offset:192
    v_mov_b32 v16, 0xff800000
    s_mov_b32 s45, 0
L_fb_max:
    buffer_load_dwordx4 v[20:23], v230, s[12:15], s45 offen offset:0
    buffer_load_dwordx4 v[24:27], v230, s[12:15], s45 offen offset:64
    buffer_load_dwordx4 v[28:31], v230, s[12:15], s45 offen offset:128
    buffer_load_dwordx4 v[32:35], v230, s[12:15], s45 offen offset:192
    s_waitcnt vmcnt(0)
    v_mfma_f32_16x16x32_bf16 v[36:39], v[20:23], v[0:3], 0
    v_mfma_f32_16x16x32_bf16 v[36:39], v[24:27], v[4:7], v[36:39]
    v_mfma_f32_16x16x32_bf16 v[36:39], v[28:31], v[8:11], v[36:39]
    v_mfma_f32_16x16x32_bf16 v[36:39], v[32:35], v[12:15], v[36:39]
    s_add_u32 s45, s45, 4096
    s_nop 9
    v_max3_f32 v16, v16, v36, v37
    v_max3_f32 v16, v16, v38, v39
    s_cmp_lt_u32 s45, 131072
    s_cbranch_scc1 L_fb_max
    v_mov_b32 v17, v16
    s_nop 1
    v_permlane16_swap_b32 v16, v17
    s_nop 1
    v_max_f32 v16, v16, v17
    v_mov_b32 v17, v16
    s_nop 1
    v_permlane32_swap_b32 v16, v17
    s_nop 1
    v_max_f32 v16, v16, v17
    v_mul_f32 v17, s25, v16
    v_mov_b32 v18, 0
    v_mov_b32 v64, 0
    v_mov_b32 v65, 0
    v_mov_b32 v66, 0
    v_mov_b32 v67, 0
    v_mov_b32 v68, 0
    v_mov_b32 v69, 0
    v_mov_b32 v70, 0
    v_mov_b32 v71, 0
    v_mov_b32 v72, 0
    v_mov_b32 v73, 0
    v_mov_b32 v74, 0
    v_mov_b32 v75, 0
    v_mov_b32 v76, 0
    v_mov_b32 v77, 0
    v_mov_b32 v78, 0
    v_mov_b32 v79, 0
    v_mov_b32 v80, 0
    v_mov_b32 v81, 0
    v_mov_b32 v82, 0
    v_mov_b32 v83, 0
    v_mov_b32 v84, 0
    v_mov_b32 v85, 0
    v_mov_b32 v86, 0
    v_mov_b32 v87, 0
    v_mov_b32 v88, 0
    v_mov_b32 v89, 0
    v_mov_b32 v90, 0
    v_mov_b32 v91, 0
    v_mov_b32 v92, 0
    v_mov_b32 v93, 0
    v_mov_b32 v94, 0
    v_mov_b32 v95, 0
    s_mov_b32 s45, 0
    s_mov_b32 s40, 0
L_fb_pv:
    buffer_load_dwordx4 v[20:23], v230, s[12:15], s45 offen offset:0
    buffer_load_dwordx4 v[24:27], v230, s[12:15], s45 offen offset:64
    buffer_load_dwordx4 v[28:31], v230, s[12:15], s45 offen offset:128
    buffer_load_dwordx4 v[32:35], v230, s[12:15], s45 offen offset:192
    s_waitcnt vmcnt(0)
    v_mfma_f32_16x16x32_bf16 v[36:39], v[20:23], v[0:3], 0
    v_mfma_f32_16x16x32_bf16 v[36:39], v[24:27], v[4:7], v[36:39]
    v_mfma_f32_16x16x32_bf16 v[36:39], v[28:31], v[8:11], v[36:39]
    v_mfma_f32_16x16x32_bf16 v[36:39], v[32:35], v[12:15], v[36:39]
    s_add_u32 s45, s45, 4096
    s_nop 9
    buffer_load_dwordx4 v[20:23], v230, s[12:15], s45 offen offset:0
    buffer_load_dwordx4 v[24:27], v230, s[12:15], s45 offen offset:64
    buffer_load_dwordx4 v[28:31], v230, s[12:15], s45 offen offset:128
    buffer_load_dwordx4 v[32:35], v230, s[12:15], s45 offen offset:192
    s_waitcnt vmcnt(0)
    v_mfma_f32_16x16x32_bf16 v[40:43], v[20:23], v[0:3], 0
    v_mfma_f32_16x16x32_bf16 v[40:43], v[24:27], v[4:7], v[40:43]
    v_mfma_f32_16x16x32_bf16 v[40:43], v[28:31], v[8:11], v[40:43]
    v_mfma_f32_16x16x32_bf16 v[40:43], v[32:35], v[12:15], v[40:43]
    s_add_u32 s45, s45, 4096
    s_nop 9
    v_fma_f32 v36, v36, s25, -v17
    v_fma_f32 v37, v37, s25, -v17
    v_fma_f32 v38, v38, s25, -v17
    v_fma_f32 v39, v39, s25, -v17
    v_fma_f32 v40, v40, s25, -v17
    v_fma_f32 v41, v41, s25, -v17
    v_fma_f32 v42, v42, s25, -v17
    v_fma_f32 v43, v43, s25, -v17
    v_exp_f32 v36, v36
    v_exp_f32 v37, v37
    v_exp_f32 v38, v38
    v_exp_f32 v39, v39
    v_exp_f32 v40, v40
    v_exp_f32 v41, v41
    v_exp_f32 v42, v42
    v_exp_f32 v43, v43
    s_nop 0
    v_add_f32 v18, v18, v36
    v_add_f32 v18, v18, v37
    v_add_f32 v18, v18, v38
    v_add_f32 v18, v18, v39
    v_add_f32 v18, v18, v40
    v_add_f32 v18, v18, v41
    v_add_f32 v18, v18, v42
    v_add_f32 v18, v18, v43
    v_cvt_pk_bf16_f32 v44, v36, v37
    v_cvt_pk_bf16_f32 v45, v38, v39
    v_cvt_pk_bf16_f32 v46, v40, v41
    v_cvt_pk_bf16_f32 v47, v42, v43
    v_add_u32 v52, s40, v224
    v_add_u32 v53, s40, v225
    ds_read_b64_tr_b16 v[48:49], v52 offset:0
    ds_read_b64_tr_b16 v[50:51], v52 offset:2048
    s_waitcnt lgkmcnt(0)
    v_mfma_f32_16x16x32_bf16 v[64:67], v[48:51], v[44:47], v[64:67]
    ds_read_b64_tr_b16 v[48:49], v52 offset:8
    ds_read_b64_tr_b16 v[50:51], v52 offset:2056
    s_waitcnt lgkmcnt(0)
    v_mfma_f32_16x16x32_bf16 v[68:71], v[48:51], v[44:47], v[68:71]
    ds_read_b64_tr_b16 v[48:49], v53 offset:0
    ds_read_b64_tr_b16 v[50:51], v53 offset:2048
    s_waitcnt lgkmcnt(0)
    v_mfma_f32_16x16x32_bf16 v[72:75], v[48:51], v[44:47], v[72:75]
    ds_read_b64_tr_b16 v[48:49], v53 offset:8
    ds_read_b64_tr_b16 v[50:51], v53 offset:2056
    s_waitcnt lgkmcnt(0)
    v_mfma_f32_16x16x32_bf16 v[76:79], v[48:51], v[44:47], v[76:79]
    ds_read_b64_tr_b16 v[48:49], v52 offset:32768
    ds_read_b64_tr_b16 v[50:51], v52 offset:34816
    s_waitcnt lgkmcnt(0)
    v_mfma_f32_16x16x32_bf16 v[80:83], v[48:51], v[44:47], v[80:83]
    ds_read_b64_tr_b16 v[48:49], v52 offset:32776
    ds_read_b64_tr_b16 v[50:51], v52 offset:34824
    s_waitcnt lgkmcnt(0)
    v_mfma_f32_16x16x32_bf16 v[84:87], v[48:51], v[44:47], v[84:87]
    ds_read_b64_tr_b16 v[48:49], v53 offset:32768
    ds_read_b64_tr_b16 v[50:51], v53 offset:34816
    s_waitcnt lgkmcnt(0)
    v_mfma_f32_16x16x32_bf16 v[88:91], v[48:51], v[44:47], v[88:91]
    ds_read_b64_tr_b16 v[48:49], v53 offset:32776
    ds_read_b64_tr_b16 v[50:51], v53 offset:34824
    s_waitcnt lgkmcnt(0)
    v_mfma_f32_16x16x32_bf16 v[92:95], v[48:51], v[44:47], v[92:95]
    s_add_u32 s40, s40, 4096
    s_cmp_eq_u32 s40, 32768
    s_cselect_b32 s40, 65536, s40
    s_cmp_lt_u32 s45, 131072
    s_cbranch_scc1 L_fb_pv
    v_mov_b32 v17, v18
    s_nop 1
    v_permlane16_swap_b32 v18, v17
    s_nop 1
    v_add_f32 v18, v18, v17
    v_mov_b32 v17, v18
    s_nop 1
    v_permlane32_swap_b32 v18, v17
    s_nop 1
    v_add_f32 v18, v18, v17
    v_rcp_f32 v18, v18
    s_nop 7
    v_mul_f32 v64, v64, v18
    v_mul_f32 v65, v65, v18
    v_mul_f32 v66, v66, v18
    v_mul_f32 v67, v67, v18
    v_mul_f32 v68, v68, v18
    v_mul_f32 v69, v69, v18
    v_mul_f32 v70, v70, v18
    v_mul_f32 v71, v71, v18
    v_mul_f32 v72, v72, v18
    v_mul_f32 v73, v73, v18
    v_mul_f32 v74, v74, v18
    v_mul_f32 v75, v75, v18
    v_mul_f32 v76, v76, v18
    v_mul_f32 v77, v77, v18
    v_mul_f32 v78, v78, v18
    v_mul_f32 v79, v79, v18
    v_mul_f32 v80, v80, v18
    v_mul_f32 v81, v81, v18
    v_mul_f32 v82, v82, v18
    v_mul_f32 v83, v83, v18
    v_mul_f32 v84, v84, v18
    v_mul_f32 v85, v85, v18
    v_mul_f32 v86, v86, v18
    v_mul_f32 v87, v87, v18
    v_mul_f32 v88, v88, v18
    v_mul_f32 v89, v89, v18
    v_mul_f32 v90, v90, v18
    v_mul_f32 v91, v91, v18
    v_mul_f32 v92, v92, v18
    v_mul_f32 v93, v93, v18
    v_mul_f32 v94, v94, v18
    v_mul_f32 v95, v95, v18
    v_cvt_pk_bf16_f32 v96, v64, v65
    v_cvt_pk_bf16_f32 v97, v66, v67
    v_cvt_pk_bf16_f32 v98, v68, v69
    v_cvt_pk_bf16_f32 v99, v70, v71
    v_cvt_pk_bf16_f32 v100, v72, v73
    v_cvt_pk_bf16_f32 v101, v74, v75
    v_cvt_pk_bf16_f32 v102, v76, v77
    v_cvt_pk_bf16_f32 v103, v78, v79
    v_cvt_pk_bf16_f32 v104, v80, v81
    v_cvt_pk_bf16_f32 v105, v82, v83
    v_cvt_pk_bf16_f32 v106, v84, v85
    v_cvt_pk_bf16_f32 v107, v86, v87
    v_cvt_pk_bf16_f32 v108, v88, v89
    v_cvt_pk_bf16_f32 v109, v90, v91
    v_cvt_pk_bf16_f32 v110, v92, v93
    v_cvt_pk_bf16_f32 v111, v94, v95
    s_nop 1
    buffer_store_dwordx4 v[96:99], v230, s[20:23], s44 offen offset:0
    buffer_store_dwordx4 v[100:103], v230, s[20:23], s44 offen offset:64
    buffer_store_dwordx4 v[104:107], v230, s[20:23], s44 offen offset:128
    buffer_store_dwordx4 v[108:111], v230, s[20:23], s44 offen offset:192
    s_waitcnt vmcnt(0)
    s_cmp_lg_u32 s27, 0
    s_cbranch_scc1 L_fb_next
    s_add_u32 s3, s3, 1
    s_cmp_le_u32 s3, s4
    s_cbranch_scc1 L_fb_wave

L_end:
    s_endpgm
.section .rodata,"a"
.p2align 6
.amdhsa_kernel standalone__mha_softmax__near_ridge_kernel
  .amdhsa_next_free_vgpr 512
  .amdhsa_next_free_sgpr 102
  .amdhsa_accum_offset 256
  .amdhsa_group_segment_fixed_size 0
  .amdhsa_kernarg_size 48
  .amdhsa_user_sgpr_count 2
  .amdhsa_user_sgpr_kernarg_segment_ptr 1
  .amdhsa_system_sgpr_workgroup_id_x 1
.end_amdhsa_kernel
```
